```python
import torch

def _softmax(x, axis=-1):
    return torch.softmax(x, dim=axis)
def _gelu(x):
    return torch.nn.functional.gelu(x, approximate="tanh")
def _silu(x):
    return torch.nn.functional.silu(x)
def _sigmoid(x):
    return torch.sigmoid(x)
def _layernorm(x, axis=-1, eps=1e-5):
    m = x.mean(dim=axis, keepdim=True)
    v = x.var(dim=axis, keepdim=True, unbiased=False)
    return (x - m) / torch.sqrt(v + eps)
def _scatter_add(tgt, idx, src, axis=0):
    return tgt.clone().index_add_(axis, idx, src)
def _segment_sum(src, seg, n):
    out = torch.zeros((n,) + src.shape[1:], dtype=src.dtype)
    return out.index_add_(0, seg, src)
def _pad(x, pw):
    flat = tuple(v for pair in reversed(pw) for v in pair)
    return torch.nn.functional.pad(x, flat)

kernel_name = 'interleave_layers__spectral_fnet__moe_arch_mod__prompt'

def setup_inputs():

    _w = (lambda a: (lambda t: t.to(torch.bfloat16) if t.is_floating_point() else t)(torch.as_tensor(a)))
    def _A_setup():
        B, S, D = 1, 2048, 640
        ns = torch.arange(S)[:, None] * torch.arange(S)[None, :]
        nd = torch.arange(D)[:, None] * torch.arange(D)[None, :]
        Ws_re = torch.cos(-2.0 * torch.pi * ns / S).to(float)
        Ws_im = torch.sin(-2.0 * torch.pi * ns / S).to(float)
        Wd_re = torch.cos(-2.0 * torch.pi * nd / D).to(float)
        Wd_im = torch.sin(-2.0 * torch.pi * nd / D).to(float)
        return {
            "x": _w((lambda *s: torch.randn(*s, dtype=torch.bfloat16) * 0.1)(B, S, D)),
            "dft_seq_re": _w(Ws_re),
            "dft_seq_im": _w(Ws_im),
            "dft_hid_re": _w(Wd_re),
            "dft_hid_im": _w(Wd_im),
        }
    _A_in = _A_setup()

    def _B_setup():
        B, S, D, F, C = 1, 2048, 640, 1728, 8
        return {
            "x": _w((lambda *s: torch.randn(*s, dtype=torch.bfloat16) * 0.1)(B, S, D)),
            "w_r": _w((lambda *s: torch.randn(*s, dtype=torch.bfloat16) * 1.6)(D)),
            "w_gate": _w((lambda *s: torch.randn(*s, dtype=torch.bfloat16) * 0.4)(D, F)),
            "w_up": _w((lambda *s: torch.randn(*s, dtype=torch.bfloat16) * 0.4)(D, F)),
            "w_down": _w((lambda *s: torch.randn(*s, dtype=torch.bfloat16) * 0.4)(F, D)),
        }
    _B_in = _B_setup()

    return {
        "A_x": _A_in["x"],
        "A_dft_seq_re": _A_in["dft_seq_re"],
        "A_dft_seq_im": _A_in["dft_seq_im"],
        "A_dft_hid_re": _A_in["dft_hid_re"],
        "A_dft_hid_im": _A_in["dft_hid_im"],
        "B_x": _B_in["x"],
        "B_w_r": _B_in["w_r"],
        "B_w_gate": _B_in["w_gate"],
        "B_w_up": _B_in["w_up"],
        "B_w_down": _B_in["w_down"],
    }

def reference(A_x, A_dft_seq_re, A_dft_seq_im, A_dft_hid_re, A_dft_hid_im, B_x, B_w_r, B_w_gate, B_w_up, B_w_down):
    def _A_ref(x, dft_seq_re, dft_seq_im, dft_hid_re, dft_hid_im):
        a = torch.einsum("bsd,ed->bse", x, dft_hid_re)
        b = torch.einsum("bsd,ed->bse", x, dft_hid_im)
        y = torch.einsum("ts,bse->bte", dft_seq_re, a) - torch.einsum("ts,bse->bte", dft_seq_im, b)
        return y

    def _B_ref(x, w_r, w_gate, w_up, w_down):
        B, S, D = x.shape
        C = 8
        r = x @ w_r
        idx = torch.argsort(-r, axis=-1)[:, :C]
        idx_e = (lambda x, n, axis: torch.repeat_interleave(x, n, dim=axis))(idx.reshape(B, C, 1), D, axis=2)
        x_sel = (lambda x, i, axis: torch.take_along_dim(x, i, dim=axis))(x, idx_e, axis=1)
        g = _silu(x_sel @ w_gate)
        u = x_sel @ w_up
        y = (g * u) @ w_down
        r_sel = _sigmoid((lambda x, i, axis: torch.take_along_dim(x, i, dim=axis))(r, idx, axis=1))
        y = y * r_sel.reshape(B, C, 1)
        b_off = (torch.arange(B) * S).reshape(B, 1)
        flat_idx = (idx + b_off).reshape(B * C)
        zero = (x * 0.0).reshape(B * S, D)
        upd = _scatter_add(zero, flat_idx, y.reshape(B * C, D), axis=0)
        return x + upd.reshape(B, S, D)

    x = A_x
    x = x + _A_ref(_layernorm(x, axis=-1), A_dft_seq_re, A_dft_seq_im, A_dft_hid_re, A_dft_hid_im)
    x = x + _B_ref(_layernorm(x, axis=-1), B_w_r, B_w_gate, B_w_up, B_w_down)
    x = x + _A_ref(_layernorm(x, axis=-1), A_dft_seq_re, A_dft_seq_im, A_dft_hid_re, A_dft_hid_im)
    x = x + _B_ref(_layernorm(x, axis=-1), B_w_r, B_w_gate, B_w_up, B_w_down)
    return x
```

```asm
; @launch grid=(256,1,1) block=(512,1,1) lds=130912
.amdgcn_target "amdgcn-amd-amdhsa--gfx950"
.text
.globl interleave_layers__spectral_fnet__moe_arch_mod__prompt_kernel
.p2align 8
.type interleave_layers__spectral_fnet__moe_arch_mod__prompt_kernel,@function
interleave_layers__spectral_fnet__moe_arch_mod__prompt_kernel:
    s_load_dwordx2 s[4:5], s[0:1], 0
    s_load_dwordx2 s[20:21], s[0:1], 96
    s_load_dwordx8 s[8:15], s[0:1], 48
    s_load_dwordx4 s[16:19], s[0:1], 80
    s_cmp_ge_u32 s2, 128
    s_cbranch_scc1 L_F
    v_lshrrev_b32 v54, 5, v0
    v_and_b32 v53, 31, v0
    v_lshl_add_u32 v55, v54, 7, s2
    v_mul_u32_u24 v252, 1280, v55
    v_lshl_add_u32 v253, v53, 3, v252
    v_lshl_add_u32 v252, v53, 4, v252
    s_waitcnt lgkmcnt(0)
    global_load_dwordx4 v[224:227], v252, s[4:5] offset:0
    global_load_dwordx4 v[228:231], v252, s[4:5] offset:512
    global_load_dwordx2 v[232:233], v253, s[4:5] offset:1024
    v_and_b32 v1, 63, v0
    v_lshrrev_b32 v8, 6, v0
    v_lshrrev_b32 v2, 4, v1
    v_readfirstlane_b32 s22, v8
    v_and_b32 v3, 15, v0
    v_mov_b32 v4, 0x00030003
    s_mov_b32 s30, 0x00020002
    s_mov_b32 s82, 0x42000000
    s_and_b32 s23, s2, 127
    s_getpc_b64 s[34:35]
    s_add_u32 s34, s34, dft_tbl@rel32@lo+4
    s_addc_u32 s35, s35, dft_tbl@rel32@hi+12
    s_cmp_lg_u32 s22, 7
    s_cbranch_scc1 L_pf_1
    s_getpc_b64 s[84:85]
    s_add_u32 s84, s84, interleave_layers__spectral_fnet__moe_arch_mod__prompt_kernel@rel32@lo+4
    s_addc_u32 s85, s85, interleave_layers__spectral_fnet__moe_arch_mod__prompt_kernel@rel32@hi+12
    s_lshr_b32 s64, s2, 3
    s_mul_i32 s64, s64, 6
    v_min_u32 v8, 5, v1
    v_add_u32 v8, s64, v8
    v_min_u32 v8, 179, v8
    v_lshlrev_b32 v8, 7, v8
    global_load_dword v8, v8, s[84:85]
    s_nop 0
L_pf_1:
    v_lshlrev_b32 v245, 4, v1
    s_lshl_b32 s64, s22, 10
    v_add_u32 v56, s64, v245
    s_mul_i32 s64, s22, 160
    v_min_u32 v61, 39, v1
    v_lshl_add_u32 v240, v61, 2, s64
    v_mov_b32 v241, 0
    v_mul_u32_u24 v57, 1280, v54
    v_lshl_add_u32 v55, v53, 3, v57
    v_lshl_add_u32 v57, v53, 4, v57
    v_mul_u32_u24 v58, 320, v2
    v_and_b32 v61, 3, v3
    v_lshl_add_u32 v58, v61, 3, v58
    s_mul_i32 s64, s22, 2560
    v_bfe_u32 v61, v3, 2, 1
    v_lshlrev_b32 v61, 5, v61
    v_add3_u32 v59, v61, v58, s64
    v_lshrrev_b32 v61, 2, v3
    v_lshlrev_b32 v61, 5, v61
    v_add3_u32 v58, v61, v58, s64
    v_mul_u32_u24 v235, 2592, v2
    v_and_b32 v61, 7, v3
    v_lshl_add_u32 v60, v61, 3, v235
    v_lshrrev_b32 v61, 3, v3
    v_lshl_add_u32 v60, v61, 2, v60
    s_mul_i32 s64, s22, 160
    v_add_u32 v60, s64, v60
    v_lshrrev_b32 v61, 3, v1
    v_mul_u32_u24 v236, 344064, v61
    v_lshlrev_b32 v247, 4, v61
    v_and_b32 v61, 7, v1
    v_lshl_add_u32 v236, v61, 4, v236
    s_lshl_b32 s64, s22, 14
    s_lshl_b32 s65, s23, 7
    s_add_u32 s64, s64, s65
    v_add_u32 v236, s64, v236
    s_mul_i32 s64, s22, 3264
    s_add_u32 s64, s64, 104800
    v_lshl_add_u32 v246, v2, 4, v245
    v_add_u32 v246, s64, v246
    v_bfe_u32 v61, v1, 2, 1
    v_lshl_add_u32 v247, v61, 7, v247
    v_and_b32 v61, 3, v1
    v_mul_u32_u24 v61, 272, v61
    v_add3_u32 v247, v247, v61, s64
    v_mul_u32_u24 v234, 80, v3
    v_lshl_add_u32 v234, v2, 4, v234
    s_min_u32 s64, s22, 5
    s_lshl_b32 s64, s64, 10
    v_add_u32 v62, s64, v245
    global_load_dwordx4 v[208:211], v62, s[34:35]
    s_add_u32 s86, s34, 0x1800
    s_addc_u32 s87, s35, 0
    global_load_dwordx4 v[184:187], v56, s[86:87]
    s_add_u32 s88, s34, 0x3800
    s_addc_u32 s89, s35, 0
    global_load_dwordx4 v[192:195], v56, s[88:89]
    s_add_u32 s90, s34, 0x5800
    s_addc_u32 s91, s35, 0
    global_load_dwordx4 v[200:203], v56, s[90:91]
    s_waitcnt lgkmcnt(0)
    global_load_dword v241, v241, s[20:21]
    global_load_dword v242, v240, s[8:9]
    v_add_u32 v62, 98656, v62
    v_add_u32 v63, 98656, v245
    s_add_u32 s38, s20, 0x100000
    s_addc_u32 s39, s21, 0
    s_add_u32 s40, s20, 0x700000
    s_addc_u32 s41, s21, 0
    s_mov_b32 s73, 0
    s_waitcnt vmcnt(6)
    v_lshlrev_b32 v64, 16, v224
    v_and_b32 v65, 0xffff0000, v224
    v_lshlrev_b32 v66, 16, v225
    v_and_b32 v67, 0xffff0000, v225
    v_lshlrev_b32 v68, 16, v226
    v_and_b32 v69, 0xffff0000, v226
    v_lshlrev_b32 v70, 16, v227
    v_and_b32 v71, 0xffff0000, v227
    v_lshlrev_b32 v72, 16, v228
    v_and_b32 v73, 0xffff0000, v228
    v_lshlrev_b32 v74, 16, v229
    v_and_b32 v75, 0xffff0000, v229
    v_lshlrev_b32 v76, 16, v230
    v_and_b32 v77, 0xffff0000, v230
    v_lshlrev_b32 v78, 16, v231
    v_and_b32 v79, 0xffff0000, v231
    v_lshlrev_b32 v80, 16, v232
    v_and_b32 v81, 0xffff0000, v232
    v_lshlrev_b32 v82, 16, v233
    v_and_b32 v83, 0xffff0000, v233
    v_add_f32 v84, v64, v65
    v_mul_f32 v85, v64, v64
    v_fmac_f32 v85, v65, v65
    v_add_f32 v84, v84, v66
    v_fmac_f32 v85, v66, v66
    v_add_f32 v84, v84, v67
    v_fmac_f32 v85, v67, v67
    v_add_f32 v84, v84, v68
    v_fmac_f32 v85, v68, v68
    v_add_f32 v84, v84, v69
    v_fmac_f32 v85, v69, v69
    v_add_f32 v84, v84, v70
    v_fmac_f32 v85, v70, v70
    v_add_f32 v84, v84, v71
    v_fmac_f32 v85, v71, v71
    v_add_f32 v84, v84, v72
    v_fmac_f32 v85, v72, v72
    v_add_f32 v84, v84, v73
    v_fmac_f32 v85, v73, v73
    v_add_f32 v84, v84, v74
    v_fmac_f32 v85, v74, v74
    v_add_f32 v84, v84, v75
    v_fmac_f32 v85, v75, v75
    v_add_f32 v84, v84, v76
    v_fmac_f32 v85, v76, v76
    v_add_f32 v84, v84, v77
    v_fmac_f32 v85, v77, v77
    v_add_f32 v84, v84, v78
    v_fmac_f32 v85, v78, v78
    v_add_f32 v84, v84, v79
    v_fmac_f32 v85, v79, v79
    v_add_f32 v84, v84, v80
    v_fmac_f32 v85, v80, v80
    v_add_f32 v84, v84, v81
    v_fmac_f32 v85, v81, v81
    v_add_f32 v84, v84, v82
    v_fmac_f32 v85, v82, v82
    v_add_f32 v84, v84, v83
    v_fmac_f32 v85, v83, v83
    s_nop 1
    v_permlane16_swap_b32 v84, v85
    v_add_f32 v84, v84, v85
    s_nop 1
    v_add_f32_dpp v84, v84, v84 row_ror:8 row_mask:0xf bank_mask:0xf
    s_nop 1
    v_add_f32_dpp v84, v84, v84 row_ror:4 row_mask:0xf bank_mask:0xf
    s_nop 1
    v_add_f32_dpp v84, v84, v84 row_ror:2 row_mask:0xf bank_mask:0xf
    s_nop 1
    v_add_f32_dpp v84, v84, v84 row_ror:1 row_mask:0xf bank_mask:0xf
    v_mov_b32 v85, v84
    s_nop 1
    v_permlane16_swap_b32 v84, v85
    v_mul_f32 v86, 0x3acccccd, v84
    v_mul_f32 v87, 0x3acccccd, v85
    v_fma_f32 v87, -v86, v86, v87
    v_max_f32 v87, 0, v87
    v_cvt_pk_bf16_f32 v91, v87, v87
    v_and_b32 v91, 0xffff0000, v91
    v_cvt_pk_bf16_f32 v88, v86, v86
    v_and_b32 v88, 0xffff0000, v88
    v_add_f32 v91, 0x3727c5ac, v91
    v_cvt_pk_bf16_f32 v91, v91, v91
    v_and_b32 v91, 0xffff0000, v91
    v_sqrt_f32 v91, v91
    s_nop 0
    v_cvt_pk_bf16_f32 v89, v91, v91
    v_and_b32 v89, 0xffff0000, v89
    v_rcp_f32 v90, v89
    s_nop 0
    v_and_b32 v90, 0xffffff00, v90
    v_mul_f32_e64 v88, -v88, v90
    v_fma_f32 v64, v64, v90, v88
    v_fma_f32 v65, v65, v90, v88
    v_fma_f32 v66, v66, v90, v88
    v_fma_f32 v67, v67, v90, v88
    v_cvt_pk_f16_f32 v92, v64, v65
    v_cvt_pk_f16_f32 v93, v66, v67
    v_fma_f32 v68, v68, v90, v88
    v_fma_f32 v69, v69, v90, v88
    v_fma_f32 v70, v70, v90, v88
    v_fma_f32 v71, v71, v90, v88
    v_cvt_pk_f16_f32 v94, v68, v69
    v_cvt_pk_f16_f32 v95, v70, v71
    ds_write_b128 v57, v[92:95] offset:47744
    v_fma_f32 v72, v72, v90, v88
    v_fma_f32 v73, v73, v90, v88
    v_fma_f32 v74, v74, v90, v88
    v_fma_f32 v75, v75, v90, v88
    v_cvt_pk_f16_f32 v96, v72, v73
    v_cvt_pk_f16_f32 v97, v74, v75
    v_fma_f32 v76, v76, v90, v88
    v_fma_f32 v77, v77, v90, v88
    v_fma_f32 v78, v78, v90, v88
    v_fma_f32 v79, v79, v90, v88
    v_cvt_pk_f16_f32 v98, v76, v77
    v_cvt_pk_f16_f32 v99, v78, v79
    ds_write_b128 v57, v[96:99] offset:48256
    v_fma_f32 v80, v80, v90, v88
    v_fma_f32 v81, v81, v90, v88
    v_fma_f32 v82, v82, v90, v88
    v_fma_f32 v83, v83, v90, v88
    v_cvt_pk_f16_f32 v100, v80, v81
    v_cvt_pk_f16_f32 v101, v82, v83
    ds_write_b64 v55, v[100:101] offset:48768
    s_waitcnt vmcnt(5)
    ds_write_b128 v62, v[208:211]
    s_waitcnt lgkmcnt(0)
    s_barrier
    ds_read_b128 v[156:159], v63 offset:0
    ds_read_b128 v[160:163], v63 offset:1024
    ds_read_b128 v[164:167], v63 offset:2048
    ds_read_b128 v[168:171], v63 offset:3072
    ds_read_b64 v[172:173], v63 offset:4096
    ds_read_b64_tr_b16 v[64:65], v58 offset:47744
    ds_read_b64_tr_b16 v[66:67], v58 offset:47872
    ds_read_b64_tr_b16 v[68:69], v59 offset:48000
    ds_read_b64_tr_b16 v[72:73], v58 offset:49024
    ds_read_b64_tr_b16 v[74:75], v58 offset:49152
    ds_read_b64_tr_b16 v[76:77], v59 offset:49280
    ds_read_b128 v[176:179], v63 offset:5120
    s_waitcnt lgkmcnt(4)
    v_mfma_f32_16x16x32_f16 v[80:83], v[156:159], v[64:67], 0
    v_mfma_f32_16x16x32_f16 v[84:87], v[160:163], v[64:67], 0
    v_mfma_f32_16x16x32_f16 v[88:91], v[164:167], v[64:67], 0
    v_mfma_f32_16x16x16_f16 v[80:83], v[168:169], v[68:69], v[80:83]
    v_mfma_f32_16x16x16_f16 v[84:87], v[170:171], v[68:69], v[84:87]
    v_mfma_f32_16x16x16_f16 v[88:91], v[172:173], v[68:69], v[88:91]
    s_waitcnt lgkmcnt(1)
    v_mfma_f32_16x16x32_f16 v[92:95], v[156:159], v[72:75], 0
    v_mfma_f32_16x16x32_f16 v[96:99], v[160:163], v[72:75], 0
    v_mfma_f32_16x16x32_f16 v[100:103], v[164:167], v[72:75], 0
    v_mfma_f32_16x16x16_f16 v[92:95], v[168:169], v[76:77], v[92:95]
    v_mfma_f32_16x16x16_f16 v[96:99], v[170:171], v[76:77], v[96:99]
    v_mfma_f32_16x16x16_f16 v[100:103], v[172:173], v[76:77], v[100:103]
    s_waitcnt vmcnt(2) lgkmcnt(0)
    s_mov_b32 s64, 0x3c00bc00
    v_pk_mul_f16 v188, v184, s64 op_sel:[1,0] op_sel_hi:[0,1]
    v_pk_mul_f16 v189, v185, s64 op_sel:[1,0] op_sel_hi:[0,1]
    v_pk_mul_f16 v190, v186, s64 op_sel:[1,0] op_sel_hi:[0,1]
    v_pk_mul_f16 v191, v187, s64 op_sel:[1,0] op_sel_hi:[0,1]
    s_mov_b32 s64, 0x3c00bc00
    v_pk_mul_f16 v196, v192, s64 op_sel:[1,0] op_sel_hi:[0,1]
    v_pk_mul_f16 v197, v193, s64 op_sel:[1,0] op_sel_hi:[0,1]
    v_pk_mul_f16 v198, v194, s64 op_sel:[1,0] op_sel_hi:[0,1]
    v_pk_mul_f16 v199, v195, s64 op_sel:[1,0] op_sel_hi:[0,1]
    s_cmp_le_u32 s22, 4
    s_cselect_b32 s64, 0, 0x80008000
    s_xor_b32 s64, s64, 0x3c00bc00
    v_pk_mul_f16 v204, v200, s64 op_sel:[1,0] op_sel_hi:[0,1]
    v_pk_mul_f16 v205, v201, s64 op_sel:[1,0] op_sel_hi:[0,1]
    v_pk_mul_f16 v206, v202, s64 op_sel:[1,0] op_sel_hi:[0,1]
    v_pk_mul_f16 v207, v203, s64 op_sel:[1,0] op_sel_hi:[0,1]
    v_xor_b32 v180, 0x80008000, v178
    v_mov_b32 v182, v176
    v_xor_b32 v181, 0x80008000, v179
    v_mov_b32 v183, v177
    v_cvt_pk_f16_f32 v104, v80, v81
    ds_write_b32 v60, v104 offset:16640
    v_cvt_pk_f16_f32 v105, v82, v83
    ds_write_b32 v60, v105 offset:17936
    v_cvt_pk_f16_f32 v106, v84, v85
    ds_write_b32 v60, v106 offset:27008
    v_cvt_pk_f16_f32 v107, v86, v87
    ds_write_b32 v60, v107 offset:28304
    v_cvt_pk_f16_f32 v108, v88, v89
    ds_write_b32 v60, v108 offset:37376
    v_cvt_pk_f16_f32 v109, v90, v91
    ds_write_b32 v60, v109 offset:38672
    v_cvt_pk_f16_f32 v110, v92, v93
    ds_write_b32 v60, v110 offset:16720
    v_cvt_pk_f16_f32 v111, v94, v95
    ds_write_b32 v60, v111 offset:18016
    v_cvt_pk_f16_f32 v104, v96, v97
    ds_write_b32 v60, v104 offset:27088
    v_cvt_pk_f16_f32 v105, v98, v99
    ds_write_b32 v60, v105 offset:28384
    v_cvt_pk_f16_f32 v106, v100, v101
    ds_write_b32 v60, v106 offset:37456
    v_cvt_pk_f16_f32 v107, v102, v103
    ds_write_b32 v60, v107 offset:38752
    s_waitcnt vmcnt(0)
    v_readfirstlane_b32 s25, v241
    s_nop 0
    s_and_b32 s64, s25, 0xffff
    s_lshr_b32 s65, s25, 16
    s_add_u32 s24, s64, 1
    s_and_b32 s24, s24, 0xbfff
    s_add_u32 s66, s64, 2
    s_and_b32 s66, s66, 0xbfff
    s_cmp_eq_u32 s24, s65
    s_cselect_b32 s24, s66, s24
    s_lshl_b32 s83, s24, 16
    s_bfe_u32 s64, s24, 0x20000
    s_bfe_u32 s65, s24, 0x20002
    s_lshl_b32 s65, s65, 16
    s_or_b32 s26, s64, s65
    s_bfe_u32 s64, s24, 0x20004
    s_bfe_u32 s65, s24, 0x20006
    s_lshl_b32 s65, s65, 16
    s_or_b32 s27, s64, s65
    s_bfe_u32 s64, s24, 0x20008
    s_bfe_u32 s65, s24, 0x2000a
    s_lshl_b32 s65, s65, 16
    s_or_b32 s28, s64, s65
    s_xor_b32 s29, s26, 0x00030003
    s_waitcnt lgkmcnt(0)
    s_barrier
    s_getpc_b64 s[36:37]
    s_add_u32 s36, s36, L_ret_2-.
    s_addc_u32 s37, s37, 0
L_rowtail:
    s_mul_i32 s64, s22, 1296
    v_add_u32 v52, s64, v234
    ds_read_b128 v[56:59], v52 offset:16640
    ds_read_b128 v[60:63], v52 offset:27008
    ds_read_b128 v[64:67], v52 offset:37376
    v_add_u32 v53, 131072, v236
    v_add_u32 v54, 262144, v236
    s_waitcnt lgkmcnt(2)
    v_mfma_f32_16x16x32_f16 v[68:71], v[56:59], v[184:187], 0
    v_mfma_f32_16x16x32_f16 v[72:75], v[56:59], v[188:191], 0
    s_waitcnt lgkmcnt(1)
    v_mfma_f32_16x16x32_f16 v[76:79], v[60:63], v[192:195], 0
    v_mfma_f32_16x16x32_f16 v[80:83], v[60:63], v[196:199], 0
    s_waitcnt lgkmcnt(0)
    v_mfma_f32_16x16x32_f16 v[84:87], v[64:67], v[200:203], 0
    v_mfma_f32_16x16x32_f16 v[88:91], v[64:67], v[204:207], 0
    s_nop 0
    v_cvt_pk_f16_f32 v56, v68, v69
    v_cvt_pk_f16_f32 v57, v70, v71
    v_cvt_pk_f16_f32 v58, v72, v73
    v_cvt_pk_f16_f32 v59, v74, v75
    s_nop 1
    v_mfma_f32_16x16x32_f16 v[92:95], v[56:59], v[176:179], 0
    v_mfma_f32_16x16x32_f16 v[96:99], v[56:59], v[180:183], 0
    v_cvt_pk_f16_f32 v60, v76, v77
    v_cvt_pk_f16_f32 v61, v78, v79
    v_cvt_pk_f16_f32 v62, v80, v81
    v_cvt_pk_f16_f32 v63, v82, v83
    s_nop 1
    v_mfma_f32_16x16x32_f16 v[100:103], v[60:63], v[176:179], 0
    v_mfma_f32_16x16x32_f16 v[104:107], v[60:63], v[180:183], 0
    v_cvt_pk_f16_f32 v64, v84, v85
    v_cvt_pk_f16_f32 v65, v86, v87
    v_cvt_pk_f16_f32 v66, v88, v89
    v_cvt_pk_f16_f32 v67, v90, v91
    s_nop 1
    v_mfma_f32_16x16x32_f16 v[108:111], v[64:67], v[176:179], 0
    v_mfma_f32_16x16x32_f16 v[112:115], v[64:67], v[180:183], 0
    v_cvt_pkrtz_f16_f32 v68, v92, v93
    v_add_u32 v68, s30, v68
    v_cvt_pkrtz_f16_f32 v69, v94, v95
    v_add_u32 v69, s30, v69
    v_cvt_pkrtz_f16_f32 v70, v96, v97
    v_add_u32 v70, s30, v70
    v_cvt_pkrtz_f16_f32 v71, v98, v99
    v_add_u32 v71, s30, v71
    v_bfi_b32 v68, v4, s26, v68
    v_bfi_b32 v69, v4, s27, v69
    v_bfi_b32 v70, v4, s28, v70
    v_bfi_b32 v71, v4, s29, v71
    ds_write_b128 v246, v[68:71] offset:0
    ds_read_b128 v[56:59], v247 offset:0
    v_cvt_pkrtz_f16_f32 v72, v100, v101
    v_add_u32 v72, s30, v72
    v_cvt_pkrtz_f16_f32 v73, v102, v103
    v_add_u32 v73, s30, v73
    v_cvt_pkrtz_f16_f32 v74, v104, v105
    v_add_u32 v74, s30, v74
    v_cvt_pkrtz_f16_f32 v75, v106, v107
    v_add_u32 v75, s30, v75
    v_bfi_b32 v72, v4, s26, v72
    v_bfi_b32 v73, v4, s27, v73
    v_bfi_b32 v74, v4, s28, v74
    v_bfi_b32 v75, v4, s29, v75
    ds_write_b128 v246, v[72:75] offset:1088
    ds_read_b128 v[60:63], v247 offset:1088
    s_waitcnt lgkmcnt(2)
    global_store_dwordx4 v236, v[56:59], s[38:39] sc1
    v_cvt_pkrtz_f16_f32 v76, v108, v109
    v_add_u32 v76, s30, v76
    v_cvt_pkrtz_f16_f32 v77, v110, v111
    v_add_u32 v77, s30, v77
    v_cvt_pkrtz_f16_f32 v78, v112, v113
    v_add_u32 v78, s30, v78
    v_cvt_pkrtz_f16_f32 v79, v114, v115
    v_add_u32 v79, s30, v79
    v_bfi_b32 v76, v4, s26, v76
    v_bfi_b32 v77, v4, s27, v77
    v_bfi_b32 v78, v4, s28, v78
    v_bfi_b32 v79, v4, s29, v79
    ds_write_b128 v246, v[76:79] offset:2176
    ds_read_b128 v[64:67], v247 offset:2176
    s_waitcnt lgkmcnt(2)
    global_store_dwordx4 v53, v[60:63], s[38:39] sc1
    s_cmp_gt_u32 s22, 4
    s_waitcnt lgkmcnt(0)
    s_cbranch_scc1 L_rowtail_ret
    global_store_dwordx4 v54, v[64:67], s[38:39] sc1
    s_nop 1
L_rowtail_ret:
    s_setpc_b64 s[36:37]
L_ret_2:
    s_cmp_lg_u32 s22, 4
    s_cbranch_scc1 L_sp_3
    v_mul_u32_u24 v112, 58, v1
    v_add3_u32 v112, v112, s23, 9
    v_and_b32 v112, 127, v112
    v_lshlrev_b32 v112, 10, v112
    v_lshl_add_u32 v112, v1, 7, v112
    v_add_u32 v112, 0x60000, v112
    s_lshl_b32 s64, s23, 9
    s_add_u32 s64, s64, 0x1000
    v_writelane_b32 v112, s64, 2
    v_mov_b32 v113, s24
    s_mov_b64 exec, 7
    global_store_dword v112, v113, s[20:21] sc1
    s_mov_b64 exec, -1
L_sp_3:
    v_lshrrev_b32 v52, 5, v1
    v_and_b32 v53, 31, v1
    s_lshl_b32 s64, s22, 1
    v_add_u32 v54, s64, v52
    v_mul_u32_u24 v60, 1304, v54
    v_add_u32 v60, 68288, v60
    v_lshlrev_b32 v61, 3, v53
    v_mul_u32_u24 v62, 410, v61
    v_lshrrev_b32 v62, 16, v62
    v_lshl_add_u32 v61, v61, 1, v60
    v_lshl_add_u32 v249, v62, 2, v61
    ds_write2_b32 v249, v224, v225 offset0:0 offset1:1
    ds_write2_b32 v249, v226, v227 offset0:2 offset1:3
    v_lshlrev_b32 v61, 3, v53
    v_add_u32 v61, 256, v61
    v_mul_u32_u24 v62, 410, v61
    v_lshrrev_b32 v62, 16, v62
    v_lshl_add_u32 v61, v61, 1, v60
    v_lshl_add_u32 v250, v62, 2, v61
    ds_write2_b32 v250, v228, v229 offset0:0 offset1:1
    ds_write2_b32 v250, v230, v231 offset0:2 offset1:3
    v_lshlrev_b32 v61, 2, v53
    v_add_u32 v61, 512, v61
    v_mul_u32_u24 v62, 410, v61
    v_lshrrev_b32 v62, 16, v62
    v_lshl_add_u32 v61, v61, 1, v60
    v_lshl_add_u32 v251, v62, 2, v61
    ds_write2_b32 v251, v232, v233 offset0:0 offset1:1
    s_lshr_b32 s64, s22, 1
    s_lshl_b32 s64, s64, 2
    s_add_u32 s64, s64, 89152
    v_add_u32 v240, s64, v240
    ds_write_b32 v240, v242
    s_and_b32 s71, s23, 7
    s_lshr_b32 s72, s23, 3
    s_mul_i32 s64, s71, 21
    s_add_u32 s64, s64, s72
    s_lshl_b32 s64, s64, 14
    v_lshl_add_u32 v44, v0, 4, s64
    v_bfe_u32 v52, v0, 2, 1
    v_mul_u32_u24 v45, 8256, v52
    v_bfe_u32 v52, v0, 3, 1
    v_lshl_add_u32 v45, v52, 12, v45
    v_lshrrev_b32 v52, 4, v0
    v_lshl_add_u32 v45, v52, 6, v45
    v_and_b32 v52, 3, v0
    v_lshl_add_u32 v45, v52, 4, v45
    s_lshr_b32 s65, s22, 2
    s_and_b32 s66, s22, 3
    s_mul_i32 s64, s65, 8256
    v_lshrrev_b32 v52, 1, v2
    v_lshlrev_b32 v53, 9, v52
    v_lshrrev_b32 v54, 2, v3
    v_lshl_add_u32 v53, v54, 6, v53
    v_and_b32 v54, 3, v3
    v_lshl_add_u32 v53, v54, 4, v53
    v_and_b32 v55, 1, v2
    v_lshl_add_u32 v53, v55, 3, v53
    v_add_u32 v46, s64, v53
    s_lshl_b32 s65, s65, 3
    s_add_u32 s65, s65, s71
    s_lshl_b32 s66, s66, 1
    v_lshrrev_b32 v53, 3, v3
    v_add_u32 v53, s66, v53
    v_and_b32 v54, 7, v3
    v_lshl_add_u32 v56, v53, 4, s65
    v_mul_u32_u24 v47, 20480, v56
    s_lshl_b32 s64, s72, 9
    v_lshl_add_u32 v57, v2, 7, s64
    v_lshl_add_u32 v57, v54, 4, v57
    v_add_u32 v47, v47, v57
    v_lshl_add_u32 v56, v54, 7, v56
    v_sub_u32 v57, 0, v56
    v_and_b32 v57, 0x3ff, v57
    v_and_b32 v53, 127, v57
    v_mul_u32_u24 v48, 20480, v53
    v_lshrrev_b32 v57, 7, v57
    v_lshl_add_u32 v48, v57, 4, v48
    s_sub_u32 s64, 40, s72
    s_lshl_b32 s64, s64, 9
    s_add_u32 s64, s64, 384
    v_lshlrev_b32 v57, 7, v2
    v_sub_u32 v57, s64, v57
    v_add_u32 v48, v48, v57
    v_cmp_eq_u32 s[74:75], 0, v56
    v_cvt_f32_u32 v57, v56
    v_mul_f32 v57, 0x3a000000, v57
    v_cvt_f32_u32 v52, v52
    v_cvt_f32_u32 v55, v55
    v_mul_f32 v52, 0x41800000, v52
    v_mul_f32 v55, 0xbe800000, v55
    v_fma_f32 v56, v52, v57, v55
    v_cos_f32 v54, v57
    v_mul_f32 v53, 0x42000000, v57
    v_add_f32 v54, v54, v54
    v_add_f32 v55, v56, v57
    v_cos_f32 v60, v56
    v_cos_f32 v61, v55
    v_add_f32 v56, v56, v53
    v_add_f32 v55, v56, v57
    v_cos_f32 v76, v56
    v_cos_f32 v77, v55
    v_add_f32 v56, v56, v53
    v_fma_f32 v62, v54, v61, -v60
    v_fma_f32 v78, v54, v77, -v76
    v_fma_f32 v63, v54, v62, -v61
    v_fma_f32 v79, v54, v78, -v77
    v_cvt_pk_f16_f32 v12, v60, v62
    v_cvt_pk_f16_f32 v28, v61, v63
    v_cvt_pk_f16_f32 v16, v76, v78
    v_cvt_pk_f16_f32 v32, v77, v79
    v_fma_f32 v64, v54, v63, -v62
    v_fma_f32 v80, v54, v79, -v78
    v_fma_f32 v65, v54, v64, -v63
    v_fma_f32 v81, v54, v80, -v79
    v_fma_f32 v66, v54, v65, -v64
    v_fma_f32 v82, v54, v81, -v80
    v_fma_f32 v67, v54, v66, -v65
    v_fma_f32 v83, v54, v82, -v81
    v_cvt_pk_f16_f32 v13, v64, v66
    v_cvt_pk_f16_f32 v29, v65, v67
    v_cvt_pk_f16_f32 v17, v80, v82
    v_cvt_pk_f16_f32 v33, v81, v83
    v_fma_f32 v68, v54, v67, -v66
    v_fma_f32 v84, v54, v83, -v82
    v_fma_f32 v69, v54, v68, -v67
    v_fma_f32 v85, v54, v84, -v83
    v_fma_f32 v70, v54, v69, -v68
    v_fma_f32 v86, v54, v85, -v84
    v_fma_f32 v71, v54, v70, -v69
    v_fma_f32 v87, v54, v86, -v85
    v_cvt_pk_f16_f32 v14, v68, v70
    v_cvt_pk_f16_f32 v30, v69, v71
    v_cvt_pk_f16_f32 v18, v84, v86
    v_cvt_pk_f16_f32 v34, v85, v87
    v_fma_f32 v72, v54, v71, -v70
    v_fma_f32 v88, v54, v87, -v86
    v_fma_f32 v73, v54, v72, -v71
    v_fma_f32 v89, v54, v88, -v87
    v_fma_f32 v74, v54, v73, -v72
    v_fma_f32 v90, v54, v89, -v88
    v_fma_f32 v75, v54, v74, -v73
    v_fma_f32 v91, v54, v90, -v89
    v_cvt_pk_f16_f32 v15, v72, v74
    v_cvt_pk_f16_f32 v31, v73, v75
    v_cvt_pk_f16_f32 v19, v88, v90
    v_cvt_pk_f16_f32 v35, v89, v91
    v_add_f32 v55, v56, v57
    v_cos_f32 v60, v56
    v_cos_f32 v61, v55
    v_add_f32 v56, v56, v53
    v_add_f32 v55, v56, v57
    v_cos_f32 v76, v56
    v_cos_f32 v77, v55
    v_add_f32 v56, v56, v53
    v_fma_f32 v62, v54, v61, -v60
    v_fma_f32 v78, v54, v77, -v76
    v_fma_f32 v63, v54, v62, -v61
    v_fma_f32 v79, v54, v78, -v77
    v_cvt_pk_f16_f32 v20, v60, v62
    v_cvt_pk_f16_f32 v36, v61, v63
    v_cvt_pk_f16_f32 v24, v76, v78
    v_cvt_pk_f16_f32 v40, v77, v79
    v_fma_f32 v64, v54, v63, -v62
    v_fma_f32 v80, v54, v79, -v78
    v_fma_f32 v65, v54, v64, -v63
    v_fma_f32 v81, v54, v80, -v79
    v_fma_f32 v66, v54, v65, -v64
    v_fma_f32 v82, v54, v81, -v80
    v_fma_f32 v67, v54, v66, -v65
    v_fma_f32 v83, v54, v82, -v81
    v_cvt_pk_f16_f32 v21, v64, v66
    v_cvt_pk_f16_f32 v37, v65, v67
    v_cvt_pk_f16_f32 v25, v80, v82
    v_cvt_pk_f16_f32 v41, v81, v83
    v_fma_f32 v68, v54, v67, -v66
    v_fma_f32 v84, v54, v83, -v82
    v_fma_f32 v69, v54, v68, -v67
    v_fma_f32 v85, v54, v84, -v83
    v_fma_f32 v70, v54, v69, -v68
    v_fma_f32 v86, v54, v85, -v84
    v_fma_f32 v71, v54, v70, -v69
    v_fma_f32 v87, v54, v86, -v85
    v_cvt_pk_f16_f32 v22, v68, v70
    v_cvt_pk_f16_f32 v38, v69, v71
    v_cvt_pk_f16_f32 v26, v84, v86
    v_cvt_pk_f16_f32 v42, v85, v87
    v_fma_f32 v72, v54, v71, -v70
    v_fma_f32 v88, v54, v87, -v86
    v_fma_f32 v73, v54, v72, -v71
    v_fma_f32 v89, v54, v88, -v87
    v_fma_f32 v74, v54, v73, -v72
    v_fma_f32 v90, v54, v89, -v88
    v_fma_f32 v75, v54, v74, -v73
    v_fma_f32 v91, v54, v90, -v89
    v_cvt_pk_f16_f32 v23, v72, v74
    v_cvt_pk_f16_f32 v39, v73, v75
    v_cvt_pk_f16_f32 v27, v88, v90
    v_cvt_pk_f16_f32 v43, v89, v91
    v_mul_u32_u24 v54, 80, v3
    s_lshl_b32 s64, s22, 3
    v_add3_u32 v235, v235, v54, s64
    s_mul_i32 s64, s23, 20480
    s_lshl_b32 s65, s22, 9
    s_add_u32 s65, s65, s64
    v_and_b32 v54, 7, v3
    v_lshlrev_b32 v237, 4, v54
    v_lshl_add_u32 v237, v2, 7, v237
    v_lshrrev_b32 v54, 3, v3
    v_lshl_add_u32 v237, v54, 3, v237
    v_add_u32 v237, s65, v237
    v_cmp_lt_u32 vcc, 7, v3
    v_mov_b32 v240, s26
    v_mov_b32 v241, s27
    v_mov_b32 v54, s28
    v_mov_b32 v55, s29
    v_cndmask_b32 v240, v240, v54, vcc
    v_cndmask_b32 v241, v241, v55, vcc
    s_mul_i32 s65, s22, 2560
    s_add_u32 s65, s65, s64
    v_lshlrev_b32 v238, 6, v3
    v_lshl_add_u32 v238, v2, 4, v238
    v_lshrrev_b32 v239, 1, v238
    v_add_u32 v238, s65, v238
    v_add_u32 v239, s65, v239
    v_lshl_add_u32 v248, v3, 7, s23
    s_lshl_b32 s64, s22, 8
    s_add_u32 s64, s64, 90464
    v_lshl_add_u32 v244, v1, 2, s64
    s_lshl_b32 s51, s23, 9
    s_add_u32 s51, s51, 0x11000
    s_waitcnt lgkmcnt(0)
    v_mul_u32_u24 v243, 1304, v3
    v_mul_u32_u24 v224, 324, v2
    s_lshl_b32 s64, s22, 1
    s_add_u32 s64, s64, 68288
    v_add_u32 v224, s64, v224
    v_add_u32 v243, v243, v224
    v_add_u32 v224, 20864, v224
    v_mov_b32 v116, 0
    v_mov_b32 v136, 0
    v_mov_b32 v117, 0
    v_mov_b32 v137, 0
    v_mov_b32 v118, 0
    v_mov_b32 v138, 0
    v_mov_b32 v119, 0
    v_mov_b32 v139, 0
    v_mov_b32 v120, 0
    v_mov_b32 v140, 0
    v_mov_b32 v121, 0
    v_mov_b32 v141, 0
    v_mov_b32 v122, 0
    v_mov_b32 v142, 0
    v_mov_b32 v123, 0
    v_mov_b32 v143, 0
    v_mov_b32 v124, 0
    v_mov_b32 v144, 0
    v_mov_b32 v125, 0
    v_mov_b32 v145, 0
    v_mov_b32 v126, 0
    v_mov_b32 v146, 0
    v_mov_b32 v127, 0
    v_mov_b32 v147, 0
    v_mov_b32 v128, 0
    v_mov_b32 v148, 0
    v_mov_b32 v129, 0
    v_mov_b32 v149, 0
    v_mov_b32 v130, 0
    v_mov_b32 v150, 0
    v_mov_b32 v131, 0
    v_mov_b32 v151, 0
    v_mov_b32 v132, 0
    v_mov_b32 v152, 0
    v_mov_b32 v133, 0
    v_mov_b32 v153, 0
    v_mov_b32 v134, 0
    v_mov_b32 v154, 0
    v_mov_b32 v135, 0
    v_mov_b32 v155, 0
    s_nop 1
    s_getpc_b64 s[36:37]
    s_add_u32 s36, s36, L_ret_4-.
    s_addc_u32 s37, s37, 0
L_cola:
    v_add_u32 v52, 8192, v44
    s_mov_b32 s70, 20000
    s_nop 0
L_rt_5:
    global_load_dwordx4 v[56:59], v44, s[38:39] sc1
    global_load_dwordx4 v[60:63], v52, s[38:39] sc1
    s_waitcnt vmcnt(0)
    v_xor_b32 v56, s26, v56
    v_xor_b32 v57, s27, v57
    v_xor_b32 v58, s28, v58
    v_xor_b32 v59, s29, v59
    v_xor_b32 v60, s26, v60
    v_xor_b32 v61, s27, v61
    v_xor_b32 v62, s28, v62
    v_xor_b32 v63, s29, v63
    v_or3_b32 v53, v56, v57, v58
    v_or3_b32 v53, v53, v59, v60
    v_or3_b32 v53, v53, v61, v62
    v_or_b32 v53, v53, v63
    v_and_b32 v53, v4, v53
    v_cmp_ne_u32 vcc, 0, v53
    s_cbranch_vccz L_rd_6
    s_sub_u32 s70, s70, 1
    s_cmp_lg_u32 s70, 0
    s_cbranch_scc1 L_rt_5
    s_nop 0
L_rd_6:
    ds_write_b128 v45, v[56:59] offset:0
    ds_write_b128 v45, v[60:63] offset:2048
    s_waitcnt lgkmcnt(0)
    s_barrier
    s_setpc_b64 s[36:37]
L_ret_4:
    s_getpc_b64 s[36:37]
    s_add_u32 s36, s36, L_ret_7-.
    s_addc_u32 s37, s37, 0
L_colb:
    ds_read_b64_tr_b16 v[64:65], v46 offset:0
    ds_read_b64_tr_b16 v[66:67], v46 offset:256
    ds_read_b64_tr_b16 v[68:69], v46 offset:4096
    ds_read_b64_tr_b16 v[70:71], v46 offset:4352
    ds_read_b64_tr_b16 v[72:73], v46 offset:1024
    ds_read_b64_tr_b16 v[74:75], v46 offset:1280
    ds_read_b64_tr_b16 v[76:77], v46 offset:5120
    ds_read_b64_tr_b16 v[78:79], v46 offset:5376
    ds_read_b64_tr_b16 v[80:81], v46 offset:2048
    ds_read_b64_tr_b16 v[82:83], v46 offset:2304
    ds_read_b64_tr_b16 v[84:85], v46 offset:6144
    ds_read_b64_tr_b16 v[86:87], v46 offset:6400
    s_waitcnt lgkmcnt(10)
    v_mfma_f32_16x16x32_f16 v[56:59], v[64:67], v[12:15], 0
    ds_read_b64_tr_b16 v[88:89], v46 offset:3072
    ds_read_b64_tr_b16 v[90:91], v46 offset:3328
    s_waitcnt lgkmcnt(10)
    v_mfma_f32_16x16x32_f16 v[60:63], v[68:71], v[28:31], 0
    ds_read_b64_tr_b16 v[92:93], v46 offset:7168
    ds_read_b64_tr_b16 v[94:95], v46 offset:7424
    s_waitcnt lgkmcnt(10)
    v_mfma_f32_16x16x32_f16 v[56:59], v[72:75], v[16:19], v[56:59]
    s_waitcnt lgkmcnt(8)
    v_mfma_f32_16x16x32_f16 v[60:63], v[76:79], v[32:35], v[60:63]
    s_waitcnt lgkmcnt(6)
    v_mfma_f32_16x16x32_f16 v[56:59], v[80:83], v[20:23], v[56:59]
    s_waitcnt lgkmcnt(4)
    v_mfma_f32_16x16x32_f16 v[60:63], v[84:87], v[36:39], v[60:63]
    s_waitcnt lgkmcnt(2)
    v_mfma_f32_16x16x32_f16 v[56:59], v[88:91], v[24:27], v[56:59]
    s_waitcnt lgkmcnt(0)
    v_mfma_f32_16x16x32_f16 v[60:63], v[92:95], v[40:43], v[60:63]
    s_nop 7
    v_add_f32 v64, v56, v60
    v_sub_f32 v68, v56, v60
    v_add_f32 v65, v57, v61
    v_sub_f32 v69, v57, v61
    v_add_f32 v66, v58, v62
    v_sub_f32 v70, v58, v62
    v_add_f32 v67, v59, v63
    v_sub_f32 v71, v59, v63
    v_cvt_pkrtz_f16_f32 v72, v64, v65
    v_add_u32 v72, s30, v72
    v_cvt_pkrtz_f16_f32 v73, v66, v67
    v_add_u32 v73, s30, v73
    v_cvt_pkrtz_f16_f32 v74, v68, v69
    v_add_u32 v74, s30, v74
    v_cvt_pkrtz_f16_f32 v75, v70, v71
    v_add_u32 v75, s30, v75
    v_alignbit_b32 v80, v72, v72, 16
    v_alignbit_b32 v81, v73, v73, 16
    v_alignbit_b32 v82, v74, v74, 16
    v_alignbit_b32 v83, v75, v75, 16
    v_bfi_b32 v72, v4, s26, v72
    v_bfi_b32 v73, v4, s27, v73
    v_bfi_b32 v74, v4, s28, v74
    v_bfi_b32 v75, v4, s29, v75
    global_store_dwordx4 v47, v[72:75], s[40:41] sc1
    s_sub_u32 s64, s72, 1
    s_cmp_ge_u32 s64, 19
    s_cbranch_scc1 L_colpass_ret
    v_cndmask_b32 v76, v83, v81, s[74:75]
    v_cndmask_b32 v77, v82, v80, s[74:75]
    v_cndmask_b32 v78, v81, v83, s[74:75]
    v_cndmask_b32 v79, v80, v82, s[74:75]
    v_bfi_b32 v76, v4, s26, v76
    v_bfi_b32 v77, v4, s27, v77
    v_bfi_b32 v78, v4, s28, v78
    v_bfi_b32 v79, v4, s29, v79
    global_store_dwordx4 v48, v[76:79], s[40:41] sc1
    s_nop 1
L_colpass_ret:
    s_setpc_b64 s[36:37]
L_ret_7:
    s_cmp_lg_u32 s22, 7
    s_cbranch_scc1 L_sp_8
    v_mul_u32_u24 v112, 58, v1
    v_add3_u32 v112, v112, s23, 9
    v_and_b32 v112, 127, v112
    v_lshlrev_b32 v112, 10, v112
    v_lshl_add_u32 v112, v1, 7, v112
    v_add_u32 v112, 0x60100, v112
    v_mov_b32 v113, s24
    s_mov_b64 exec, 3
    global_store_dword v112, v113, s[20:21] sc1
    s_mov_b64 exec, -1
L_sp_8:
    s_lshl_b32 s64, s22, 10
    v_add_u32 v52, s64, v245
    s_add_u32 s90, s34, 0x7800
    s_addc_u32 s91, s35, 0
    global_load_dwordx4 v[208:211], v52, s[90:91]
    s_add_u32 s92, s34, 0x9800
    s_addc_u32 s93, s35, 0
    global_load_dwordx4 v[216:219], v52, s[92:93]
    s_waitcnt lgkmcnt(4)
    ds_read_u16_d16_hi v116, v243 offset:0
    ds_read_u16_d16_hi v120, v243 offset:16
    ds_read_u16_d16_hi v124, v243 offset:32
    ds_read_u16_d16_hi v128, v243 offset:48
    ds_read_u16_d16_hi v132, v243 offset:64
    ds_read_u16_d16_hi v117, v243 offset:80
    ds_read_u16_d16_hi v121, v243 offset:96
    ds_read_u16_d16_hi v125, v243 offset:112
    ds_read_u16_d16_hi v129, v243 offset:128
    ds_read_u16_d16_hi v133, v243 offset:144
    s_waitcnt lgkmcnt(4)
    ds_read_u16_d16_hi v118, v243 offset:160
    ds_read_u16_d16_hi v122, v243 offset:176
    ds_read_u16_d16_hi v126, v243 offset:192
    ds_read_u16_d16_hi v130, v243 offset:208
    ds_read_u16_d16_hi v134, v243 offset:224
    ds_read_u16_d16_hi v119, v243 offset:240
    ds_read_u16_d16_hi v123, v243 offset:256
    ds_read_u16_d16_hi v127, v243 offset:272
    ds_read_u16_d16_hi v131, v243 offset:288
    ds_read_u16_d16_hi v135, v243 offset:304
    s_waitcnt lgkmcnt(4)
    ds_read_u16_d16_hi v136, v224 offset:0
    ds_read_u16_d16_hi v140, v224 offset:16
    ds_read_u16_d16_hi v144, v224 offset:32
    ds_read_u16_d16_hi v148, v224 offset:48
    ds_read_u16_d16_hi v152, v224 offset:64
    ds_read_u16_d16_hi v137, v224 offset:80
    ds_read_u16_d16_hi v141, v224 offset:96
    ds_read_u16_d16_hi v145, v224 offset:112
    ds_read_u16_d16_hi v149, v224 offset:128
    ds_read_u16_d16_hi v153, v224 offset:144
    s_waitcnt lgkmcnt(4)
    ds_read_u16_d16_hi v138, v224 offset:160
    ds_read_u16_d16_hi v142, v224 offset:176
    ds_read_u16_d16_hi v146, v224 offset:192
    ds_read_u16_d16_hi v150, v224 offset:208
    ds_read_u16_d16_hi v154, v224 offset:224
    ds_read_u16_d16_hi v139, v224 offset:240
    ds_read_u16_d16_hi v143, v224 offset:256
    ds_read_u16_d16_hi v147, v224 offset:272
    ds_read_u16_d16_hi v151, v224 offset:288
    ds_read_u16_d16_hi v155, v224 offset:304
    s_waitcnt lgkmcnt(0)
    v_add_f32 v242, v136, v137
    v_add_f32 v242, v242, v138
    v_add_f32 v242, v242, v139
    v_add_f32 v242, v242, v140
    v_add_f32 v242, v242, v141
    v_add_f32 v242, v242, v142
    v_add_f32 v242, v242, v143
    v_add_f32 v242, v242, v144
    v_add_f32 v242, v242, v145
    v_add_f32 v242, v242, v146
    v_add_f32 v242, v242, v147
    v_add_f32 v242, v242, v148
    v_add_f32 v242, v242, v149
    v_add_f32 v242, v242, v150
    v_add_f32 v242, v242, v151
    v_add_f32 v242, v242, v152
    v_add_f32 v242, v242, v153
    v_add_f32 v242, v242, v154
    v_add_f32 v242, v242, v155
    s_add_u32 s44, s20, 0x28000
    s_addc_u32 s45, s21, 0
    s_add_u32 s46, s20, 0x30000
    s_addc_u32 s47, s21, 0
    s_add_u32 s42, s20, 0xd00000
    s_addc_u32 s43, s21, 0
    s_add_u32 s38, s20, 0x400000
    s_addc_u32 s39, s21, 0
    s_mov_b32 s66, s51
    s_lshl_b32 s51, s23, 10
    s_add_u32 s51, s51, 0x60100
    s_cmp_lg_u32 s22, 0
    s_cbranch_scc1 L_wm_9
    v_lshrrev_b32 v52, 5, v1
    v_mul_u32_u24 v52, 128, v52
    v_add_u32 v52, s51, v52
    s_mov_b32 s70, 20000
    s_nop 0
L_wt_10:
    global_load_dword v53, v52, s[20:21] offset:0 sc1
    s_waitcnt vmcnt(0)
    v_and_b32 v53, 0xffff, v53
    v_cmp_ne_u32 vcc, s24, v53
    s_cbranch_vccz L_wm_9
    s_sleep 1
    s_sub_u32 s70, s70, 1
    s_cmp_lg_u32 s70, 0
    s_cbranch_scc1 L_wt_10
L_wm_9:
    s_barrier
    s_mov_b32 s51, s66
    s_add_u32 s92, s40, 0x2000
    s_addc_u32 s93, s41, 0
    s_add_u32 s94, s40, 0x4000
    s_addc_u32 s95, s41, 0
    s_mov_b32 s70, 20000
L_rt_11:
    global_load_dwordx2 v[62:63], v237, s[40:41] sc1
    global_load_dwordx2 v[64:65], v237, s[92:93] offset:-4096 sc1
    global_load_dwordx2 v[66:67], v237, s[92:93] sc1
    global_load_dwordx2 v[68:69], v237, s[94:95] offset:-4096 sc1
    global_load_dwordx2 v[70:71], v237, s[94:95] sc1
    s_waitcnt vmcnt(0)
    v_xor_b32 v62, v240, v62
    v_xor_b32 v63, v241, v63
    v_xor_b32 v64, v240, v64
    v_xor_b32 v65, v241, v65
    v_xor_b32 v66, v240, v66
    v_xor_b32 v67, v241, v67
    v_xor_b32 v68, v240, v68
    v_xor_b32 v69, v241, v69
    v_xor_b32 v70, v240, v70
    v_xor_b32 v71, v241, v71
    v_or3_b32 v60, v62, v63, v64
    v_or3_b32 v60, v60, v65, v66
    v_or3_b32 v60, v60, v67, v68
    v_or3_b32 v60, v60, v69, v70
    v_or_b32 v60, v60, v71
    v_and_b32 v60, v4, v60
    v_cmp_ne_u32 vcc, 0, v60
    s_cbranch_vccz L_rd_12
    s_sub_u32 s70, s70, 1
    s_cmp_lg_u32 s70, 0
    s_cbranch_scc1 L_rt_11
    s_nop 0
L_rd_12:
    v_fma_mix_f32 v116, v62, s82, v116 op_sel:[0,0,0] op_sel_hi:[1,0,0]
    v_fma_mix_f32 v117, v62, s82, v117 op_sel:[1,0,0] op_sel_hi:[1,0,0]
    v_fma_mix_f32 v118, v63, s82, v118 op_sel:[0,0,0] op_sel_hi:[1,0,0]
    v_fma_mix_f32 v119, v63, s82, v119 op_sel:[1,0,0] op_sel_hi:[1,0,0]
    v_fma_mix_f32 v120, v64, s82, v120 op_sel:[0,0,0] op_sel_hi:[1,0,0]
    v_fma_mix_f32 v121, v64, s82, v121 op_sel:[1,0,0] op_sel_hi:[1,0,0]
    v_fma_mix_f32 v122, v65, s82, v122 op_sel:[0,0,0] op_sel_hi:[1,0,0]
    v_fma_mix_f32 v123, v65, s82, v123 op_sel:[1,0,0] op_sel_hi:[1,0,0]
    v_fma_mix_f32 v124, v66, s82, v124 op_sel:[0,0,0] op_sel_hi:[1,0,0]
    v_fma_mix_f32 v125, v66, s82, v125 op_sel:[1,0,0] op_sel_hi:[1,0,0]
    v_fma_mix_f32 v126, v67, s82, v126 op_sel:[0,0,0] op_sel_hi:[1,0,0]
    v_fma_mix_f32 v127, v67, s82, v127 op_sel:[1,0,0] op_sel_hi:[1,0,0]
    v_fma_mix_f32 v128, v68, s82, v128 op_sel:[0,0,0] op_sel_hi:[1,0,0]
    v_fma_mix_f32 v129, v68, s82, v129 op_sel:[1,0,0] op_sel_hi:[1,0,0]
    v_fma_mix_f32 v130, v69, s82, v130 op_sel:[0,0,0] op_sel_hi:[1,0,0]
    v_fma_mix_f32 v131, v69, s82, v131 op_sel:[1,0,0] op_sel_hi:[1,0,0]
    v_fma_mix_f32 v132, v70, s82, v132 op_sel:[0,0,0] op_sel_hi:[1,0,0]
    v_fma_mix_f32 v133, v70, s82, v133 op_sel:[1,0,0] op_sel_hi:[1,0,0]
    v_fma_mix_f32 v134, v71, s82, v134 op_sel:[0,0,0] op_sel_hi:[1,0,0]
    v_fma_mix_f32 v135, v71, s82, v135 op_sel:[1,0,0] op_sel_hi:[1,0,0]
    v_add_f32 v52, v116, v117
    v_mul_f32 v53, v116, v116
    v_mul_f32 v54, v116, v136
    v_fmac_f32 v53, v117, v117
    v_fmac_f32 v54, v117, v137
    v_add_f32 v52, v52, v118
    v_fmac_f32 v53, v118, v118
    v_fmac_f32 v54, v118, v138
    v_add_f32 v52, v52, v119
    v_fmac_f32 v53, v119, v119
    v_fmac_f32 v54, v119, v139
    v_add_f32 v52, v52, v120
    v_fmac_f32 v53, v120, v120
    v_fmac_f32 v54, v120, v140
    v_add_f32 v52, v52, v121
    v_fmac_f32 v53, v121, v121
    v_fmac_f32 v54, v121, v141
    v_add_f32 v52, v52, v122
    v_fmac_f32 v53, v122, v122
    v_fmac_f32 v54, v122, v142
    v_add_f32 v52, v52, v123
    v_fmac_f32 v53, v123, v123
    v_fmac_f32 v54, v123, v143
    v_add_f32 v52, v52, v124
    v_fmac_f32 v53, v124, v124
    v_fmac_f32 v54, v124, v144
    v_add_f32 v52, v52, v125
    v_fmac_f32 v53, v125, v125
    v_fmac_f32 v54, v125, v145
    v_add_f32 v52, v52, v126
    v_fmac_f32 v53, v126, v126
    v_fmac_f32 v54, v126, v146
    v_add_f32 v52, v52, v127
    v_fmac_f32 v53, v127, v127
    v_fmac_f32 v54, v127, v147
    v_add_f32 v52, v52, v128
    v_fmac_f32 v53, v128, v128
    v_fmac_f32 v54, v128, v148
    v_add_f32 v52, v52, v129
    v_fmac_f32 v53, v129, v129
    v_fmac_f32 v54, v129, v149
    v_add_f32 v52, v52, v130
    v_fmac_f32 v53, v130, v130
    v_fmac_f32 v54, v130, v150
    v_add_f32 v52, v52, v131
    v_fmac_f32 v53, v131, v131
    v_fmac_f32 v54, v131, v151
    v_add_f32 v52, v52, v132
    v_fmac_f32 v53, v132, v132
    v_fmac_f32 v54, v132, v152
    v_add_f32 v52, v52, v133
    v_fmac_f32 v53, v133, v133
    v_fmac_f32 v54, v133, v153
    v_add_f32 v52, v52, v134
    v_fmac_f32 v53, v134, v134
    v_fmac_f32 v54, v134, v154
    v_add_f32 v52, v52, v135
    v_fmac_f32 v53, v135, v135
    v_fmac_f32 v54, v135, v155
    v_mov_b32 v55, v242
    v_permlane32_swap_b32 v52, v53
    s_nop 0
    v_permlane32_swap_b32 v54, v55
    v_add_f32 v52, v52, v53
    v_add_f32 v54, v54, v55
    s_nop 1
    v_permlane16_swap_b32 v52, v54
    v_add_f32 v52, v52, v54
    ds_write_b32 v244, v52 offset:0
    v_lshlrev_b32 v53, 2, v1
    v_add_u32 v53, 90464, v53
    s_waitcnt lgkmcnt(0)
    s_barrier
    ds_read2st64_b32 v[64:65], v53 offset0:0 offset1:1
    ds_read2st64_b32 v[66:67], v53 offset0:2 offset1:3
    ds_read2st64_b32 v[68:69], v53 offset0:4 offset1:5
    ds_read2st64_b32 v[70:71], v53 offset0:6 offset1:7
    s_waitcnt lgkmcnt(2)
    v_add_f32 v64, v64, v65
    v_add_f32 v66, v66, v67
    s_waitcnt lgkmcnt(0)
    v_add_f32 v68, v68, v69
    v_add_f32 v70, v70, v71
    v_add_f32 v64, v64, v66
    v_add_f32 v68, v68, v70
    v_add_f32 v52, v64, v68
    v_add_f32 v54, v64, v68
    s_nop 1
    v_permlane16_swap_b32 v52, v54
    v_mov_b32 v53, v52
    v_mov_b32 v55, v54
    s_nop 0
    v_permlane32_swap_b32 v52, v53
    v_permlane32_swap_b32 v54, v55
    v_mul_f32 v56, 0x3acccccd, v52
    v_mul_f32 v57, 0x3acccccd, v53
    v_fma_f32 v57, -v56, v56, v57
    v_max_f32 v57, 0, v57
    v_cvt_pk_bf16_f32 v61, v57, v57
    v_and_b32 v61, 0xffff0000, v61
    v_cvt_pk_bf16_f32 v58, v56, v56
    v_and_b32 v58, 0xffff0000, v58
    v_add_f32 v61, 0x3727c5ac, v61
    v_cvt_pk_bf16_f32 v61, v61, v61
    v_and_b32 v61, 0xffff0000, v61
    v_sqrt_f32 v61, v61
    s_nop 0
    v_cvt_pk_bf16_f32 v59, v61, v61
    v_and_b32 v59, 0xffff0000, v59
    v_rcp_f32 v60, v59
    s_nop 0
    v_and_b32 v60, 0xffffff00, v60
    s_cmp_lg_u32 s22, 0
    s_cbranch_scc1 L_key_13
    v_fma_f32 v64, -v58, v55, v54
    v_mul_f32 v64, v64, v60
    v_cvt_pk_bf16_f32 v70, v64, v64
    v_and_b32 v70, 0xffff0000, v70
    v_ashrrev_i32 v65, 31, v70
    v_or_b32 v65, 0x80000000, v65
    v_xor_b32 v65, v65, v70
    v_and_b32 v65, 0xffff0000, v65
    v_or_b32 v65, s24, v65
    s_lshl_b32 s64, s23, 6
    v_lshl_add_u32 v66, v3, 2, s64
    s_mov_b64 exec, 0xffff
    global_store_dword v66, v65, s[44:45] sc1
    v_or_b32 v68, s24, v58
    v_or_b32 v69, s24, v59
    v_or_b32 v70, s24, v70
    v_mov_b32 v71, s24
    v_lshlrev_b32 v66, 2, v66
    global_store_dwordx4 v66, v[68:71], s[46:47] sc1
    s_lshl_b32 s64, s23, 9
    s_add_u32 s64, s64, 0x1000 + 128
    v_mov_b32 v67, s64
    s_mov_b64 exec, 1
    global_store_dword v67, v71, s[20:21] sc1
    s_mov_b64 exec, -1
L_key_13:
    v_mul_f32_e64 v62, -v58, v60
    v_fma_f32 v72, v116, v60, v62
    v_fma_f32 v73, v117, v60, v62
    v_fma_f32 v74, v118, v60, v62
    v_fma_f32 v75, v119, v60, v62
    v_cvt_pkrtz_f16_f32 v92, v72, v73
    v_add_u32 v92, s30, v92
    v_cvt_pkrtz_f16_f32 v93, v74, v75
    v_add_u32 v93, s30, v93
    v_bfi_b32 v92, v4, s26, v92
    v_bfi_b32 v93, v4, s27, v93
    v_fma_f32 v76, v120, v60, v62
    v_fma_f32 v77, v121, v60, v62
    v_fma_f32 v78, v122, v60, v62
    v_fma_f32 v79, v123, v60, v62
    v_cvt_pkrtz_f16_f32 v94, v76, v77
    v_add_u32 v94, s30, v94
    v_cvt_pkrtz_f16_f32 v95, v78, v79
    v_add_u32 v95, s30, v95
    v_bfi_b32 v94, v4, s28, v94
    v_bfi_b32 v95, v4, s29, v95
    global_store_dwordx4 v238, v[92:95], s[42:43] sc1
    v_fma_f32 v80, v124, v60, v62
    v_fma_f32 v81, v125, v60, v62
    v_fma_f32 v82, v126, v60, v62
    v_fma_f32 v83, v127, v60, v62
    v_cvt_pkrtz_f16_f32 v96, v80, v81
    v_add_u32 v96, s30, v96
    v_cvt_pkrtz_f16_f32 v97, v82, v83
    v_add_u32 v97, s30, v97
    v_bfi_b32 v96, v4, s26, v96
    v_bfi_b32 v97, v4, s27, v97
    v_fma_f32 v84, v128, v60, v62
    v_fma_f32 v85, v129, v60, v62
    v_fma_f32 v86, v130, v60, v62
    v_fma_f32 v87, v131, v60, v62
    v_cvt_pkrtz_f16_f32 v98, v84, v85
    v_add_u32 v98, s30, v98
    v_cvt_pkrtz_f16_f32 v99, v86, v87
    v_add_u32 v99, s30, v99
    v_bfi_b32 v98, v4, s28, v98
    v_bfi_b32 v99, v4, s29, v99
    global_store_dwordx4 v238, v[96:99], s[42:43] offset:1024 sc1
    v_fma_f32 v88, v132, v60, v62
    v_fma_f32 v89, v133, v60, v62
    v_fma_f32 v90, v134, v60, v62
    v_fma_f32 v91, v135, v60, v62
    v_cvt_pkrtz_f16_f32 v100, v88, v89
    v_add_u32 v100, s30, v100
    v_cvt_pkrtz_f16_f32 v101, v90, v91
    v_add_u32 v101, s30, v101
    v_bfi_b32 v100, v4, s26, v100
    v_bfi_b32 v101, v4, s27, v101
    global_store_dwordx2 v239, v[100:101], s[42:43] offset:2048 sc1
    v_add_f32 v52, 1.0, v60
    v_fma_f32 v53, v56, v52, v62
    v_mul_f32 v54, v52, v52
    v_mul_f32 v54, v54, v57
    v_cvt_pk_bf16_f32 v61, v54, v54
    v_and_b32 v61, 0xffff0000, v61
    v_cvt_pk_bf16_f32 v55, v53, v53
    v_and_b32 v55, 0xffff0000, v55
    v_add_f32 v61, 0x3727c5ac, v61
    v_cvt_pk_bf16_f32 v61, v61, v61
    v_and_b32 v61, 0xffff0000, v61
    v_sqrt_f32 v61, v61
    s_nop 0
    v_cvt_pk_bf16_f32 v63, v61, v61
    v_and_b32 v63, 0xffff0000, v63
    v_rcp_f32 v64, v63
    s_nop 0
    v_and_b32 v64, 0xffffff00, v64
    v_mul_f32_e64 v66, -v55, v64
    v_add_f32 v116, v116, v72
    v_add_f32 v117, v117, v73
    v_add_f32 v118, v118, v74
    v_add_f32 v119, v119, v75
    v_add_f32 v120, v120, v76
    v_add_f32 v121, v121, v77
    v_add_f32 v122, v122, v78
    v_add_f32 v123, v123, v79
    v_add_f32 v124, v124, v80
    v_add_f32 v125, v125, v81
    v_add_f32 v126, v126, v82
    v_add_f32 v127, v127, v83
    v_add_f32 v128, v128, v84
    v_add_f32 v129, v129, v85
    v_add_f32 v130, v130, v86
    v_add_f32 v131, v131, v87
    v_add_f32 v132, v132, v88
    v_add_f32 v133, v133, v89
    v_add_f32 v134, v134, v90
    v_add_f32 v135, v135, v91
    v_fma_f32 v72, v116, v64, v66
    v_fma_f32 v73, v117, v64, v66
    v_fma_f32 v74, v118, v64, v66
    v_fma_f32 v75, v119, v64, v66
    v_fma_f32 v76, v120, v64, v66
    v_fma_f32 v77, v121, v64, v66
    v_fma_f32 v78, v122, v64, v66
    v_fma_f32 v79, v123, v64, v66
    v_fma_f32 v80, v124, v64, v66
    v_fma_f32 v81, v125, v64, v66
    v_fma_f32 v82, v126, v64, v66
    v_fma_f32 v83, v127, v64, v66
    v_fma_f32 v84, v128, v64, v66
    v_fma_f32 v85, v129, v64, v66
    v_fma_f32 v86, v130, v64, v66
    v_fma_f32 v87, v131, v64, v66
    v_fma_f32 v88, v132, v64, v66
    v_fma_f32 v89, v133, v64, v66
    v_fma_f32 v90, v134, v64, v66
    v_fma_f32 v91, v135, v64, v66
    v_cvt_pk_f16_f32 v104, v72, v80
    v_cvt_pk_f16_f32 v105, v88, v77
    v_cvt_pk_f16_f32 v106, v85, v74
    v_cvt_pk_f16_f32 v107, v82, v90
    v_cvt_pk_f16_f32 v112, v79, v87
    v_mov_b32 v113, 0
    v_cvt_pk_f16_f32 v108, v76, v84
    v_cvt_pk_f16_f32 v109, v73, v81
    v_cvt_pk_f16_f32 v110, v89, v78
    v_cvt_pk_f16_f32 v111, v86, v75
    v_cvt_pk_f16_f32 v114, v83, v91
    v_mov_b32 v115, 0
    v_mfma_f32_16x16x32_f16 v[64:67], v[156:159], v[104:107], 0
    v_mfma_f32_16x16x32_f16 v[68:71], v[160:163], v[104:107], 0
    v_mfma_f32_16x16x32_f16 v[72:75], v[164:167], v[104:107], 0
    v_mfma_f32_16x16x32_f16 v[76:79], v[156:159], v[108:111], 0
    v_mfma_f32_16x16x32_f16 v[80:83], v[160:163], v[108:111], 0
    v_mfma_f32_16x16x32_f16 v[84:87], v[164:167], v[108:111], 0
    v_mfma_f32_16x16x16_f16 v[64:67], v[168:169], v[112:113], v[64:67]
    v_mfma_f32_16x16x16_f16 v[68:71], v[170:171], v[112:113], v[68:71]
    v_mfma_f32_16x16x16_f16 v[72:75], v[172:173], v[112:113], v[72:75]
    v_mfma_f32_16x16x16_f16 v[76:79], v[168:169], v[114:115], v[76:79]
    v_mfma_f32_16x16x16_f16 v[80:83], v[170:171], v[114:115], v[80:83]
    v_mfma_f32_16x16x16_f16 v[84:87], v[172:173], v[114:115], v[84:87]
    s_nop 2
    v_cvt_pk_f16_f32 v88, v64, v65
    s_nop 1
    v_cvt_pk_f16_f32 v89, v76, v77
    ds_write_b64 v235, v[88:89] offset:16640
    v_cvt_pk_f16_f32 v90, v66, v67
    v_cvt_pk_f16_f32 v91, v78, v79
    ds_write_b64 v235, v[90:91] offset:17936
    v_cvt_pk_f16_f32 v92, v68, v69
    v_cvt_pk_f16_f32 v93, v80, v81
    ds_write_b64 v235, v[92:93] offset:27008
    v_cvt_pk_f16_f32 v94, v70, v71
    v_cvt_pk_f16_f32 v95, v82, v83
    ds_write_b64 v235, v[94:95] offset:28304
    v_cvt_pk_f16_f32 v96, v72, v73
    v_cvt_pk_f16_f32 v97, v84, v85
    ds_write_b64 v235, v[96:97] offset:37376
    v_cvt_pk_f16_f32 v98, v74, v75
    v_cvt_pk_f16_f32 v99, v86, v87
    ds_write_b64 v235, v[98:99] offset:38672
    s_waitcnt lgkmcnt(0)
    s_barrier
    s_call_b64 s[36:37], L_rowtail
    s_cmp_lg_u32 s22, 4
    s_cbranch_scc1 L_sp_14
    v_mul_u32_u24 v114, 58, v1
    v_add3_u32 v114, v114, s23, 9
    v_and_b32 v114, 127, v114
    v_lshlrev_b32 v114, 10, v114
    v_lshl_add_u32 v114, v1, 7, v114
    v_add_u32 v114, 0x60200, v114
    s_lshl_b32 s64, s23, 9
    s_add_u32 s64, s64, 0x1180
    v_writelane_b32 v114, s64, 2
    v_mov_b32 v115, s24
    s_mov_b64 exec, 7
    global_store_dword v114, v115, s[20:21] sc1
    s_mov_b64 exec, -1
L_sp_14:
    v_and_b32 v112, 7, v3
    v_mov_b32 v111, s51
    v_lshl_add_u32 v112, v112, 2, s51
    s_add_u32 s40, s20, 0xa00000
    s_addc_u32 s41, s21, 0
    s_mov_b32 s73, 1
    s_mov_b32 s66, s51
    s_lshl_b32 s51, s23, 10
    s_add_u32 s51, s51, 0x60200
    s_cmp_lg_u32 s22, 0
    s_cbranch_scc1 L_wm_15
    v_lshrrev_b32 v52, 5, v1
    v_mul_u32_u24 v52, 128, v52
    v_add_u32 v52, s51, v52
    s_mov_b32 s70, 20000
    s_nop 0
L_wt_16:
    global_load_dword v53, v52, s[20:21] offset:0 sc1
    s_waitcnt vmcnt(0)
    v_and_b32 v53, 0xffff, v53
    v_cmp_ne_u32 vcc, s24, v53
    s_cbranch_vccz L_wm_15
    s_sleep 1
    s_sub_u32 s70, s70, 1
    s_cmp_lg_u32 s70, 0
    s_cbranch_scc1 L_wt_16
L_wm_15:
    s_barrier
    s_mov_b32 s51, s66
    s_call_b64 s[36:37], L_cola
    global_load_dwordx4 v[100:103], v111, s[20:21] sc1
    global_load_dwordx4 v[104:107], v111, s[20:21] offset:16 sc1
    global_load_dword v113, v112, s[20:21] sc1
    s_call_b64 s[36:37], L_colb
    s_waitcnt vmcnt(2)
    s_cmp_lg_u32 s72, 0
    s_cbranch_scc1 L_go_17
    s_waitcnt vmcnt(1)
L_go_17:
    s_mov_b32 s70, 20000
    s_branch L_rt_18_c
L_rt_18:
    global_load_dwordx4 v[100:103], v111, s[20:21] sc1
    global_load_dwordx4 v[104:107], v111, s[20:21] offset:16 sc1
    global_load_dword v113, v112, s[20:21] sc1
    s_waitcnt vmcnt(0)
L_rt_18_c:
    v_xor_b32 v53, s24, v100
    v_bitop3_b32 v53, v53, s24, v101 bitop3:0xf6
    v_bitop3_b32 v53, v53, s24, v102 bitop3:0xf6
    v_bitop3_b32 v53, v53, s24, v103 bitop3:0xf6
    v_bitop3_b32 v53, v53, s24, v104 bitop3:0xf6
    v_bitop3_b32 v53, v53, s24, v105 bitop3:0xf6
    v_bitop3_b32 v53, v53, s24, v106 bitop3:0xf6
    v_bitop3_b32 v53, v53, s24, v107 bitop3:0xf6
    v_bitop3_b32 v53, v53, s24, v113 bitop3:0xf6
    v_and_b32 v53, 0xffff, v53
    v_cmp_ne_u32 vcc, 0, v53
    s_cbranch_vccz L_rd_19
    s_sleep 1
    s_sub_u32 s70, s70, 1
    s_cmp_lg_u32 s70, 0
    s_cbranch_scc1 L_rt_18
L_rd_19:
    v_bfe_u32 v56, v113, 16, 7
    v_bfe_u32 v57, v113, 23, 4
    v_mul_u32_u24 v110, 20480, v56
    s_mul_i32 s64, s22, 2560
    v_lshlrev_b32 v109, 5, v57
    v_lshl_add_u32 v109, v2, 3, v109
    v_lshlrev_b32 v108, 1, v109
    v_add3_u32 v108, v108, v110, s64
    v_add3_u32 v109, v109, v110, s64
    v_lshl_add_u32 v110, v56, 4, v57
    v_lshlrev_b32 v110, 4, v110
    global_load_dwordx4 v[224:227], v108, s[42:43] sc1
    global_load_dwordx4 v[228:231], v108, s[42:43] offset:1024 sc1
    global_load_dwordx2 v[232:233], v109, s[42:43] offset:2048 sc1
    global_load_dwordx2 v[96:97], v110, s[46:47] sc1
    v_bfe_u32 v100, v100, 16, 11
    v_bfe_u32 v101, v101, 16, 11
    v_bfe_u32 v102, v102, 16, 11
    v_bfe_u32 v103, v103, 16, 11
    v_bfe_u32 v104, v104, 16, 11
    v_bfe_u32 v105, v105, 16, 11
    v_bfe_u32 v106, v106, 16, 11
    v_bfe_u32 v107, v107, 16, 11
    v_and_b32 v72, 1, v2
    v_cmp_eq_u32 vcc, 1, v72
    v_lshrrev_b32 v73, 1, v2
    v_mul_u32_u24 v74, 1536, v73
    v_cndmask_b32 v64, v100, v104, vcc
    v_cndmask_b32 v65, v101, v105, vcc
    v_cndmask_b32 v66, v102, v106, vcc
    v_cndmask_b32 v67, v103, v107, vcc
    v_mad_u32_u24 v64, v64, v248, v74
    v_and_b32 v64, 0x7ff, v64
    v_cvt_f32_u32 v64, v64
    v_mul_f32 v64, 0x3a000000, v64
    v_cos_f32 v68, v64
    v_mad_u32_u24 v65, v65, v248, v74
    v_and_b32 v65, 0x7ff, v65
    v_cvt_f32_u32 v65, v65
    v_mul_f32 v65, 0x3a000000, v65
    v_cos_f32 v69, v65
    v_mad_u32_u24 v66, v66, v248, v74
    v_and_b32 v66, 0x7ff, v66
    v_cvt_f32_u32 v66, v66
    v_mul_f32 v66, 0x3a000000, v66
    v_cos_f32 v70, v66
    v_mad_u32_u24 v67, v67, v248, v74
    v_and_b32 v67, 0x7ff, v67
    v_cvt_f32_u32 v67, v67
    v_mul_f32 v67, 0x3a000000, v67
    v_cos_f32 v71, v67
    v_mul_u32_u24 v73, 0x8000, v73
    v_lshl_or_b32 v73, v73, 16, v73
    s_cmp_le_u32 s22, 4
    s_cselect_b32 s64, 0, -1
    v_and_b32 v74, s64, v73
    v_cvt_pk_f16_f32 v176, v68, v69
    v_xor_b32 v178, v73, v176
    v_xor_b32 v180, v74, v176
    v_cvt_pk_f16_f32 v177, v70, v71
    v_xor_b32 v179, v73, v177
    v_xor_b32 v181, v74, v177
    v_mov_b32 v32, 8
    v_cmp_eq_u32 vcc, v100, v248
    s_nop 1
    v_cndmask_b32_e64 v32, v32, 0, vcc
    v_cmp_eq_u32 vcc, v101, v248
    s_nop 1
    v_cndmask_b32_e64 v32, v32, 1, vcc
    v_cmp_eq_u32 vcc, v102, v248
    s_nop 1
    v_cndmask_b32_e64 v32, v32, 2, vcc
    v_cmp_eq_u32 vcc, v103, v248
    s_nop 1
    v_cndmask_b32_e64 v32, v32, 3, vcc
    v_cmp_eq_u32 vcc, v104, v248
    s_nop 1
    v_cndmask_b32_e64 v32, v32, 4, vcc
    v_cmp_eq_u32 vcc, v105, v248
    s_nop 1
    v_cndmask_b32_e64 v32, v32, 5, vcc
    v_cmp_eq_u32 vcc, v106, v248
    s_nop 1
    v_cndmask_b32_e64 v32, v32, 6, vcc
    v_cmp_eq_u32 vcc, v107, v248
    s_nop 1
    v_cndmask_b32_e64 v32, v32, 7, vcc
    v_cmp_gt_u32 s[76:77], 8, v32
    v_and_b32 v32, 7, v32
    v_lshl_add_u32 v32, v2, 4, v32
    v_lshlrev_b32 v32, 2, v32
    v_add_u32 v33, 32, v32
    s_lshr_b32 s64, s22, 1
    s_lshl_b32 s64, s64, 7
    s_and_b32 s65, s22, 1
    s_lshl_b32 s65, s65, 3
    s_add_u32 s64, s64, s65
    s_add_u32 s64, s64, 0x50800
    v_mul_u32_u24 v34, 5120, v2
    v_and_b32 v53, 7, v3
    v_lshrrev_b32 v54, 3, v3
    v_lshl_add_u32 v34, v53, 4, v34
    v_lshl_add_u32 v34, v54, 2, v34
    v_add_u32 v34, s64, v34
    v_mul_u32_u24 v54, 636, v54
    v_sub_u32 v35, v235, v54
    s_mul_i32 s64, s22, 1296
    s_sub_u32 s65, 31104, s64
    s_add_u32 s66, s64, 20736
    s_cmp_le_u32 s22, 4
    s_cselect_b32 s66, s66, s65
    s_sub_u32 s65, 10368, s64
    v_add_u32 v36, s64, v234
    v_add_u32 v37, s66, v234
    v_add_u32 v38, s65, v234
    s_waitcnt vmcnt(0)
    s_mov_b32 s70, 20000
    s_branch L_rt_20_c
L_rt_20:
    global_load_dwordx4 v[224:227], v108, s[42:43] sc1
    global_load_dwordx4 v[228:231], v108, s[42:43] offset:1024 sc1
    global_load_dwordx2 v[232:233], v109, s[42:43] offset:2048 sc1
    global_load_dwordx2 v[96:97], v110, s[46:47] sc1
    s_waitcnt vmcnt(0)
L_rt_20_c:
    v_xor_b32 v224, s26, v224
    v_xor_b32 v225, s27, v225
    v_xor_b32 v226, s28, v226
    v_xor_b32 v227, s29, v227
    v_xor_b32 v228, s26, v228
    v_xor_b32 v229, s27, v229
    v_xor_b32 v230, s28, v230
    v_xor_b32 v231, s29, v231
    v_xor_b32 v232, s26, v232
    v_xor_b32 v233, s27, v233
    v_or3_b32 v76, v224, v225, v226
    v_or3_b32 v76, v76, v227, v228
    v_or3_b32 v76, v76, v229, v230
    v_or3_b32 v76, v76, v231, v232
    v_or_b32 v76, v76, v233
    v_and_b32 v76, v4, v76
    v_cmp_ne_u32 vcc, 0, v76
    v_xor_b32 v78, s24, v96
    v_bitop3_b32 v78, v78, s24, v97 bitop3:0xf6
    v_and_b32 v78, 0xffff, v78
    v_or_b32 v76, v76, v78
    v_cmp_ne_u32 vcc, 0, v76
    s_cbranch_vccz L_rd_21
    s_sub_u32 s70, s70, 1
    s_cmp_lg_u32 s70, 0
    s_cbranch_scc1 L_rt_20
    s_nop 0
L_rd_21:
    v_and_b32 v96, 0xffff0000, v96
    v_and_b32 v97, 0xffff0000, v97
    v_add_f32 v97, 1.0, v97
    v_cmp_lt_u32 s[78:79], 7, v3
    v_fma_mix_f32 v76, v224, v97, v96 op_sel:[0,0,0] op_sel_hi:[1,0,0]
    v_fma_mix_f32 v77, v224, v97, v96 op_sel:[1,0,0] op_sel_hi:[1,0,0]
    v_fma_mix_f32 v78, v225, v97, v96 op_sel:[0,0,0] op_sel_hi:[1,0,0]
    v_fma_mix_f32 v79, v225, v97, v96 op_sel:[1,0,0] op_sel_hi:[1,0,0]
    v_fma_mix_f32 v80, v226, v97, v96 op_sel:[0,0,0] op_sel_hi:[1,0,0]
    v_fma_mix_f32 v81, v226, v97, v96 op_sel:[1,0,0] op_sel_hi:[1,0,0]
    v_fma_mix_f32 v82, v227, v97, v96 op_sel:[0,0,0] op_sel_hi:[1,0,0]
    v_fma_mix_f32 v83, v227, v97, v96 op_sel:[1,0,0] op_sel_hi:[1,0,0]
    v_fma_mix_f32 v84, v228, v97, v96 op_sel:[0,0,0] op_sel_hi:[1,0,0]
    v_fma_mix_f32 v85, v228, v97, v96 op_sel:[1,0,0] op_sel_hi:[1,0,0]
    v_fma_mix_f32 v86, v229, v97, v96 op_sel:[0,0,0] op_sel_hi:[1,0,0]
    v_fma_mix_f32 v87, v229, v97, v96 op_sel:[1,0,0] op_sel_hi:[1,0,0]
    v_fma_mix_f32 v88, v230, v97, v96 op_sel:[0,0,0] op_sel_hi:[1,0,0]
    v_fma_mix_f32 v89, v230, v97, v96 op_sel:[1,0,0] op_sel_hi:[1,0,0]
    v_fma_mix_f32 v90, v231, v97, v96 op_sel:[0,0,0] op_sel_hi:[1,0,0]
    v_fma_mix_f32 v91, v231, v97, v96 op_sel:[1,0,0] op_sel_hi:[1,0,0]
    v_fma_mix_f32 v92, v232, v97, v96 op_sel:[0,0,0] op_sel_hi:[1,0,0]
    v_fma_mix_f32 v93, v232, v97, v96 op_sel:[1,0,0] op_sel_hi:[1,0,0]
    v_fma_mix_f32 v94, v233, v97, v96 op_sel:[0,0,0] op_sel_hi:[1,0,0]
    v_fma_mix_f32 v95, v233, v97, v96 op_sel:[1,0,0] op_sel_hi:[1,0,0]
    s_add_u32 s92, s40, 0x2000
    s_addc_u32 s93, s41, 0
    s_add_u32 s94, s40, 0x4000
    s_addc_u32 s95, s41, 0
    v_mov_b32 v114, s51
    global_load_dwordx2 v[224:225], v237, s[40:41] sc1
    global_load_dwordx2 v[226:227], v237, s[92:93] offset:-4096 sc1
    global_load_dwordx2 v[228:229], v237, s[92:93] sc1
    global_load_dwordx2 v[230:231], v237, s[94:95] offset:-4096 sc1
    global_load_dwordx2 v[232:233], v237, s[94:95] sc1
    v_cndmask_b32 v22, v76, v80, s[78:79]
    v_cndmask_b32 v23, v84, v88, s[78:79]
    v_cndmask_b32 v24, v92, v77, s[78:79]
    v_cndmask_b32 v25, v81, v85, s[78:79]
    v_cndmask_b32 v26, v89, v93, s[78:79]
    v_cndmask_b32 v27, v78, v82, s[78:79]
    v_cndmask_b32 v28, v86, v90, s[78:79]
    v_cndmask_b32 v29, v94, v79, s[78:79]
    v_cndmask_b32 v30, v83, v87, s[78:79]
    v_cndmask_b32 v31, v91, v95, s[78:79]
    v_add_f32 v52, v22, v23
    v_mul_f32 v53, v22, v22
    v_fmac_f32 v53, v23, v23
    v_add_f32 v52, v52, v24
    v_fmac_f32 v53, v24, v24
    v_add_f32 v52, v52, v25
    v_fmac_f32 v53, v25, v25
    v_add_f32 v52, v52, v26
    v_fmac_f32 v53, v26, v26
    v_add_f32 v52, v52, v27
    v_fmac_f32 v53, v27, v27
    v_add_f32 v52, v52, v28
    v_fmac_f32 v53, v28, v28
    v_add_f32 v52, v52, v29
    v_fmac_f32 v53, v29, v29
    v_add_f32 v52, v52, v30
    v_fmac_f32 v53, v30, v30
    v_add_f32 v52, v52, v31
    v_fmac_f32 v53, v31, v31
    s_nop 1
    v_permlane32_swap_b32 v52, v53
    v_add_f32 v52, v52, v53
    v_mov_b32 v53, v52
    v_lshlrev_b32 v72, 2, v1
    s_nop 0
    v_permlane16_swap_b32 v52, v53
    v_add_f32 v52, v52, v53
    v_add_u32 v72, 92512, v72
    s_nop 0
    v_add_f32_dpp v52, v52, v52 row_ror:8 row_mask:0xf bank_mask:0xf
    ds_write_b32 v244, v52 offset:2048
    s_waitcnt lgkmcnt(0)
    s_barrier
    ds_read2st64_b32 v[64:65], v72 offset0:0 offset1:1
    ds_read2st64_b32 v[66:67], v72 offset0:2 offset1:3
    ds_read2st64_b32 v[68:69], v72 offset0:4 offset1:5
    ds_read2st64_b32 v[70:71], v72 offset0:6 offset1:7
    s_waitcnt lgkmcnt(2)
    v_add_f32 v64, v64, v65
    v_add_f32 v66, v66, v67
    s_waitcnt lgkmcnt(0)
    v_add_f32 v68, v68, v69
    v_add_f32 v70, v70, v71
    v_add_f32 v64, v64, v66
    v_add_f32 v68, v68, v70
    v_add_f32 v52, v64, v68
    v_add_f32 v53, v64, v68
    s_nop 1
    v_permlane32_swap_b32 v52, v53
    v_mul_f32 v56, 0x3acccccd, v52
    v_mul_f32 v57, 0x3acccccd, v53
    v_fma_f32 v57, -v56, v56, v57
    v_max_f32 v57, 0, v57
    v_cvt_pk_bf16_f32 v61, v57, v57
    v_and_b32 v61, 0xffff0000, v61
    v_cvt_pk_bf16_f32 v58, v56, v56
    v_and_b32 v58, 0xffff0000, v58
    v_add_f32 v61, 0x3727c5ac, v61
    v_cvt_pk_bf16_f32 v61, v61, v61
    v_and_b32 v61, 0xffff0000, v61
    v_sqrt_f32 v61, v61
    s_nop 0
    v_cvt_pk_bf16_f32 v59, v61, v61
    v_and_b32 v59, 0xffff0000, v59
    v_rcp_f32 v60, v59
    s_nop 0
    v_and_b32 v60, 0xffffff00, v60
    v_mul_f32_e64 v62, -v58, v60
    v_fma_f32 v12, v22, v60, v62
    v_fma_f32 v13, v23, v60, v62
    v_fma_f32 v14, v24, v60, v62
    v_fma_f32 v15, v25, v60, v62
    v_fma_f32 v16, v26, v60, v62
    v_fma_f32 v17, v27, v60, v62
    v_fma_f32 v18, v28, v60, v62
    v_fma_f32 v19, v29, v60, v62
    v_fma_f32 v20, v30, v60, v62
    v_fma_f32 v21, v31, v60, v62
    s_add_u32 s44, s20, 0x2a000
    s_addc_u32 s45, s21, 0
    s_add_u32 s46, s20, 0x38000
    s_addc_u32 s47, s21, 0
    s_add_u32 s42, s20, 0x1000000
    s_addc_u32 s43, s21, 0
    global_load_dword v115, v114, s[20:21] offset:256 sc1
    s_waitcnt vmcnt(1)
    s_mov_b32 s70, 20000
    s_branch L_rt_22_c
L_rt_22:
    global_load_dwordx2 v[224:225], v237, s[40:41] sc1
    global_load_dwordx2 v[226:227], v237, s[92:93] offset:-4096 sc1
    global_load_dwordx2 v[228:229], v237, s[92:93] sc1
    global_load_dwordx2 v[230:231], v237, s[94:95] offset:-4096 sc1
    global_load_dwordx2 v[232:233], v237, s[94:95] sc1
    s_waitcnt vmcnt(0)
L_rt_22_c:
    v_xor_b32 v224, v240, v224
    v_xor_b32 v225, v241, v225
    v_xor_b32 v226, v240, v226
    v_xor_b32 v227, v241, v227
    v_xor_b32 v228, v240, v228
    v_xor_b32 v229, v241, v229
    v_xor_b32 v230, v240, v230
    v_xor_b32 v231, v241, v231
    v_xor_b32 v232, v240, v232
    v_xor_b32 v233, v241, v233
    v_or3_b32 v60, v224, v225, v226
    v_or3_b32 v60, v60, v227, v228
    v_or3_b32 v60, v60, v229, v230
    v_or3_b32 v60, v60, v231, v232
    v_or_b32 v60, v60, v233
    v_and_b32 v60, v4, v60
    v_cmp_ne_u32 vcc, 0, v60
    s_cbranch_vccz L_rd_23
    s_sub_u32 s70, s70, 1
    s_cmp_lg_u32 s70, 0
    s_cbranch_scc1 L_rt_22
    s_nop 0
L_rd_23:
    v_fma_mix_f32 v116, v224, s82, v116 op_sel:[0,0,0] op_sel_hi:[1,0,0]
    v_fma_mix_f32 v117, v224, s82, v117 op_sel:[1,0,0] op_sel_hi:[1,0,0]
    v_fma_mix_f32 v118, v225, s82, v118 op_sel:[0,0,0] op_sel_hi:[1,0,0]
    v_fma_mix_f32 v119, v225, s82, v119 op_sel:[1,0,0] op_sel_hi:[1,0,0]
    v_fma_mix_f32 v120, v226, s82, v120 op_sel:[0,0,0] op_sel_hi:[1,0,0]
    v_fma_mix_f32 v121, v226, s82, v121 op_sel:[1,0,0] op_sel_hi:[1,0,0]
    v_fma_mix_f32 v122, v227, s82, v122 op_sel:[0,0,0] op_sel_hi:[1,0,0]
    v_fma_mix_f32 v123, v227, s82, v123 op_sel:[1,0,0] op_sel_hi:[1,0,0]
    v_fma_mix_f32 v124, v228, s82, v124 op_sel:[0,0,0] op_sel_hi:[1,0,0]
    v_fma_mix_f32 v125, v228, s82, v125 op_sel:[1,0,0] op_sel_hi:[1,0,0]
    v_fma_mix_f32 v126, v229, s82, v126 op_sel:[0,0,0] op_sel_hi:[1,0,0]
    v_fma_mix_f32 v127, v229, s82, v127 op_sel:[1,0,0] op_sel_hi:[1,0,0]
    v_fma_mix_f32 v128, v230, s82, v128 op_sel:[0,0,0] op_sel_hi:[1,0,0]
    v_fma_mix_f32 v129, v230, s82, v129 op_sel:[1,0,0] op_sel_hi:[1,0,0]
    v_fma_mix_f32 v130, v231, s82, v130 op_sel:[0,0,0] op_sel_hi:[1,0,0]
    v_fma_mix_f32 v131, v231, s82, v131 op_sel:[1,0,0] op_sel_hi:[1,0,0]
    v_fma_mix_f32 v132, v232, s82, v132 op_sel:[0,0,0] op_sel_hi:[1,0,0]
    v_fma_mix_f32 v133, v232, s82, v133 op_sel:[1,0,0] op_sel_hi:[1,0,0]
    v_fma_mix_f32 v134, v233, s82, v134 op_sel:[0,0,0] op_sel_hi:[1,0,0]
    v_fma_mix_f32 v135, v233, s82, v135 op_sel:[1,0,0] op_sel_hi:[1,0,0]
    s_waitcnt vmcnt(0)
    s_mov_b32 s70, 20000
    s_branch L_rt_24_c
L_rt_24:
    global_load_dword v115, v114, s[20:21] offset:256 sc1
    s_waitcnt vmcnt(0)
L_rt_24_c:
    v_xor_b32 v115, s24, v115
    v_and_b32 v115, 0xffff, v115
    v_cmp_ne_u32 vcc, 0, v115
    s_cbranch_vccz L_rd_25
    s_sleep 1
    s_sub_u32 s70, s70, 1
    s_cmp_lg_u32 s70, 0
    s_cbranch_scc1 L_rt_24
L_rd_25:
    global_load_dword v74, v34, s[20:21] offset:-2048 sc1
    global_load_dword v75, v34, s[20:21] offset:-1536 sc1
    global_load_dword v76, v34, s[20:21] offset:-1024 sc1
    global_load_dword v77, v34, s[20:21] offset:-512 sc1
    global_load_dword v78, v34, s[20:21] offset:0 sc1
    global_load_dword v79, v34, s[20:21] offset:512 sc1
    global_load_dword v80, v34, s[20:21] offset:1024 sc1
    global_load_dword v81, v34, s[20:21] offset:1536 sc1
    global_load_dword v82, v34, s[20:21] offset:2048 sc1
    global_load_dword v83, v34, s[20:21] offset:2560 sc1
    s_waitcnt vmcnt(0)
    s_mov_b32 s70, 20000
    s_branch L_rt_26_c
L_rt_26:
    global_load_dword v74, v34, s[20:21] offset:-2048 sc1
    global_load_dword v75, v34, s[20:21] offset:-1536 sc1
    global_load_dword v76, v34, s[20:21] offset:-1024 sc1
    global_load_dword v77, v34, s[20:21] offset:-512 sc1
    global_load_dword v78, v34, s[20:21] offset:0 sc1
    global_load_dword v79, v34, s[20:21] offset:512 sc1
    global_load_dword v80, v34, s[20:21] offset:1024 sc1
    global_load_dword v81, v34, s[20:21] offset:1536 sc1
    global_load_dword v82, v34, s[20:21] offset:2048 sc1
    global_load_dword v83, v34, s[20:21] offset:2560 sc1
    s_waitcnt vmcnt(0)
L_rt_26_c:
    v_xor_b32 v53, s24, v74
    v_bitop3_b32 v53, v53, s24, v75 bitop3:0xf6
    v_bitop3_b32 v53, v53, s24, v76 bitop3:0xf6
    v_bitop3_b32 v53, v53, s24, v77 bitop3:0xf6
    v_bitop3_b32 v53, v53, s24, v78 bitop3:0xf6
    v_bitop3_b32 v53, v53, s24, v79 bitop3:0xf6
    v_bitop3_b32 v53, v53, s24, v80 bitop3:0xf6
    v_bitop3_b32 v53, v53, s24, v81 bitop3:0xf6
    v_bitop3_b32 v53, v53, s24, v82 bitop3:0xf6
    v_bitop3_b32 v53, v53, s24, v83 bitop3:0xf6
    v_and_b32 v53, 0xffff, v53
    v_cmp_ne_u32 vcc, 0, v53
    s_cbranch_vccz L_rd_27
    s_sub_u32 s70, s70, 1
    s_cmp_lg_u32 s70, 0
    s_cbranch_scc1 L_rt_26
    s_nop 0
L_rd_27:
    v_and_b32 v74, 0xffff0000, v74
    v_and_b32 v75, 0xffff0000, v75
    v_and_b32 v76, 0xffff0000, v76
    v_and_b32 v77, 0xffff0000, v77
    v_and_b32 v78, 0xffff0000, v78
    v_and_b32 v79, 0xffff0000, v79
    v_and_b32 v80, 0xffff0000, v80
    v_and_b32 v81, 0xffff0000, v81
    v_and_b32 v82, 0xffff0000, v82
    v_and_b32 v83, 0xffff0000, v83
    s_cmp_eq_u64 s[76:77], 0
    s_cbranch_scc1 L_own_28
    ds_bpermute_b32 v96, v32, v74
    ds_bpermute_b32 v97, v33, v74
    ds_bpermute_b32 v98, v32, v75
    ds_bpermute_b32 v99, v33, v75
    ds_bpermute_b32 v100, v32, v76
    ds_bpermute_b32 v101, v33, v76
    ds_bpermute_b32 v102, v32, v77
    ds_bpermute_b32 v103, v33, v77
    ds_bpermute_b32 v104, v32, v78
    ds_bpermute_b32 v105, v33, v78
    ds_bpermute_b32 v106, v32, v79
    ds_bpermute_b32 v107, v33, v79
    s_waitcnt lgkmcnt(6)
    ds_bpermute_b32 v108, v32, v80
    ds_bpermute_b32 v109, v33, v80
    ds_bpermute_b32 v110, v32, v81
    ds_bpermute_b32 v111, v33, v81
    ds_bpermute_b32 v112, v32, v82
    ds_bpermute_b32 v113, v33, v82
    ds_bpermute_b32 v114, v32, v83
    ds_bpermute_b32 v115, v33, v83
    s_waitcnt lgkmcnt(0)
    s_mov_b64 exec, s[76:77]
    v_add_f32 v116, v116, v96
    v_add_f32 v120, v120, v97
    v_add_f32 v124, v124, v98
    v_add_f32 v128, v128, v99
    v_add_f32 v132, v132, v100
    v_add_f32 v117, v117, v101
    v_add_f32 v121, v121, v102
    v_add_f32 v125, v125, v103
    v_add_f32 v129, v129, v104
    v_add_f32 v133, v133, v105
    v_add_f32 v118, v118, v106
    v_add_f32 v122, v122, v107
    v_add_f32 v126, v126, v108
    v_add_f32 v130, v130, v109
    v_add_f32 v134, v134, v110
    v_add_f32 v119, v119, v111
    v_add_f32 v123, v123, v112
    v_add_f32 v127, v127, v113
    v_add_f32 v131, v131, v114
    v_add_f32 v135, v135, v115
    s_mov_b64 exec, -1
    s_nop 0
L_own_28:
    v_add_f32 v84, v74, v22
    v_add_f32 v85, v75, v23
    v_add_f32 v86, v76, v24
    v_add_f32 v87, v77, v25
    v_add_f32 v88, v78, v26
    v_add_f32 v89, v79, v27
    v_add_f32 v90, v80, v28
    v_add_f32 v91, v81, v29
    v_add_f32 v92, v82, v30
    v_add_f32 v93, v83, v31
    v_add_f32 v52, v84, v85
    v_mul_f32 v53, v84, v84
    v_fmac_f32 v53, v85, v85
    v_add_f32 v52, v52, v86
    v_fmac_f32 v53, v86, v86
    v_add_f32 v52, v52, v87
    v_fmac_f32 v53, v87, v87
    v_add_f32 v52, v52, v88
    v_fmac_f32 v53, v88, v88
    v_add_f32 v52, v52, v89
    v_fmac_f32 v53, v89, v89
    v_add_f32 v52, v52, v90
    v_fmac_f32 v53, v90, v90
    v_add_f32 v52, v52, v91
    v_fmac_f32 v53, v91, v91
    v_add_f32 v52, v52, v92
    v_fmac_f32 v53, v92, v92
    v_add_f32 v52, v52, v93
    v_fmac_f32 v53, v93, v93
    s_nop 1
    v_permlane32_swap_b32 v52, v53
    v_add_f32 v52, v52, v53
    v_mov_b32 v53, v52
    v_lshlrev_b32 v72, 2, v1
    s_nop 0
    v_permlane16_swap_b32 v52, v53
    v_add_f32 v52, v52, v53
    v_add_u32 v72, 94560, v72
    s_nop 0
    v_add_f32_dpp v52, v52, v52 row_ror:8 row_mask:0xf bank_mask:0xf
    ds_write_b32 v244, v52 offset:4096
    s_waitcnt lgkmcnt(0)
    s_barrier
    ds_read2st64_b32 v[64:65], v72 offset0:0 offset1:1
    ds_read2st64_b32 v[66:67], v72 offset0:2 offset1:3
    ds_read2st64_b32 v[68:69], v72 offset0:4 offset1:5
    ds_read2st64_b32 v[70:71], v72 offset0:6 offset1:7
    s_waitcnt lgkmcnt(2)
    v_add_f32 v64, v64, v65
    v_add_f32 v66, v66, v67
    s_waitcnt lgkmcnt(0)
    v_add_f32 v68, v68, v69
    v_add_f32 v70, v70, v71
    v_add_f32 v64, v64, v66
    v_add_f32 v68, v68, v70
    v_add_f32 v52, v64, v68
    v_add_f32 v53, v64, v68
    s_nop 1
    v_permlane32_swap_b32 v52, v53
    v_mul_f32 v56, 0x3acccccd, v52
    v_mul_f32 v57, 0x3acccccd, v53
    v_fma_f32 v57, -v56, v56, v57
    v_max_f32 v57, 0, v57
    v_cvt_pk_bf16_f32 v61, v57, v57
    v_and_b32 v61, 0xffff0000, v61
    v_cvt_pk_bf16_f32 v58, v56, v56
    v_and_b32 v58, 0xffff0000, v58
    v_add_f32 v61, 0x3727c5ac, v61
    v_cvt_pk_bf16_f32 v61, v61, v61
    v_and_b32 v61, 0xffff0000, v61
    v_sqrt_f32 v61, v61
    s_nop 0
    v_cvt_pk_bf16_f32 v59, v61, v61
    v_and_b32 v59, 0xffff0000, v59
    v_rcp_f32 v60, v59
    s_nop 0
    v_and_b32 v60, 0xffffff00, v60
    v_mul_f32_e64 v62, -v58, v60
    v_sub_f32 v74, v62, v12
    v_fmac_f32 v74, v84, v60
    v_sub_f32 v75, v62, v13
    v_fmac_f32 v75, v85, v60
    v_cvt_pk_f16_f32 v96, v74, v75
    v_sub_f32 v76, v62, v14
    v_fmac_f32 v76, v86, v60
    v_sub_f32 v77, v62, v15
    v_fmac_f32 v77, v87, v60
    v_cvt_pk_f16_f32 v97, v76, v77
    v_sub_f32 v78, v62, v16
    v_fmac_f32 v78, v88, v60
    v_sub_f32 v79, v62, v17
    v_fmac_f32 v79, v89, v60
    v_cvt_pk_f16_f32 v98, v78, v79
    v_sub_f32 v80, v62, v18
    v_fmac_f32 v80, v90, v60
    v_sub_f32 v81, v62, v19
    v_fmac_f32 v81, v91, v60
    v_cvt_pk_f16_f32 v99, v80, v81
    v_sub_f32 v82, v62, v20
    v_fmac_f32 v82, v92, v60
    v_sub_f32 v83, v62, v21
    v_fmac_f32 v83, v93, v60
    v_cvt_pk_f16_f32 v100, v82, v83
    v_mov_b32 v101, 0
    v_mfma_f32_16x16x32_f16 v[64:67], v[156:159], v[96:99], 0
    v_mfma_f32_16x16x32_f16 v[68:71], v[160:163], v[96:99], 0
    v_mfma_f32_16x16x32_f16 v[72:75], v[164:167], v[96:99], 0
    v_mfma_f32_16x16x16_f16 v[64:67], v[168:169], v[100:101], v[64:67]
    v_mfma_f32_16x16x16_f16 v[68:71], v[170:171], v[100:101], v[68:71]
    v_mfma_f32_16x16x16_f16 v[72:75], v[172:173], v[100:101], v[72:75]
    s_mov_b32 s64, 0xbc003c00
    s_nop 4
    v_cvt_pk_f16_f32 v76, v64, v65
    ds_write_b32 v35, v76 offset:16640
    v_pk_mul_f16 v77, v76, s64 op_sel:[1,0] op_sel_hi:[0,1]
    ds_write_b32 v35, v77 offset:17280
    v_cvt_pk_f16_f32 v78, v66, v67
    ds_write_b32 v35, v78 offset:17936
    v_pk_mul_f16 v79, v78, s64 op_sel:[1,0] op_sel_hi:[0,1]
    ds_write_b32 v35, v79 offset:18576
    v_cvt_pk_f16_f32 v80, v68, v69
    ds_write_b32 v35, v80 offset:27008
    v_pk_mul_f16 v81, v80, s64 op_sel:[1,0] op_sel_hi:[0,1]
    ds_write_b32 v35, v81 offset:27648
    v_cvt_pk_f16_f32 v82, v70, v71
    ds_write_b32 v35, v82 offset:28304
    v_pk_mul_f16 v83, v82, s64 op_sel:[1,0] op_sel_hi:[0,1]
    ds_write_b32 v35, v83 offset:28944
    v_cvt_pk_f16_f32 v84, v72, v73
    ds_write_b32 v35, v84 offset:37376
    v_pk_mul_f16 v85, v84, s64 op_sel:[1,0] op_sel_hi:[0,1]
    ds_write_b32 v35, v85 offset:38016
    v_cvt_pk_f16_f32 v86, v74, v75
    ds_write_b32 v35, v86 offset:38672
    v_pk_mul_f16 v87, v86, s64 op_sel:[1,0] op_sel_hi:[0,1]
    ds_write_b32 v35, v87 offset:39312
    s_waitcnt lgkmcnt(0)
    s_barrier
    ds_read_b128 v[56:59], v36 offset:16640
    ds_read_b128 v[60:63], v36 offset:27008
    ds_read_b128 v[64:67], v37 offset:16640
    ds_read_b128 v[68:71], v38 offset:27008
    ds_read_b128 v[72:75], v38 offset:16640
    s_waitcnt lgkmcnt(4)
    v_mfma_f32_16x16x32_f16 v[76:79], v[56:59], v[184:187], 0
    s_waitcnt lgkmcnt(3)
    v_mfma_f32_16x16x32_f16 v[80:83], v[60:63], v[192:195], 0
    s_waitcnt lgkmcnt(2)
    v_mfma_f32_16x16x32_f16 v[84:87], v[64:67], v[200:203], 0
    s_waitcnt lgkmcnt(1)
    v_mfma_f32_16x16x32_f16 v[88:91], v[68:71], v[208:211], 0
    s_waitcnt lgkmcnt(0)
    v_mfma_f32_16x16x32_f16 v[92:95], v[72:75], v[216:219], 0
    v_cvt_pk_f16_f32 v96, v76, v77
    v_cvt_pk_f16_f32 v97, v78, v79
    s_nop 1
    v_mfma_f32_16x16x16_f16 v[116:119], v[96:97], v[176:177], v[116:119]
    v_cvt_pk_f16_f32 v98, v80, v81
    v_cvt_pk_f16_f32 v99, v82, v83
    s_nop 1
    v_mfma_f32_16x16x16_f16 v[120:123], v[98:99], v[176:177], v[120:123]
    v_cvt_pk_f16_f32 v100, v84, v85
    v_cvt_pk_f16_f32 v101, v86, v87
    s_nop 1
    v_mfma_f32_16x16x16_f16 v[124:127], v[100:101], v[180:181], v[124:127]
    v_cvt_pk_f16_f32 v102, v88, v89
    v_cvt_pk_f16_f32 v103, v90, v91
    s_nop 1
    v_mfma_f32_16x16x16_f16 v[128:131], v[102:103], v[178:179], v[128:131]
    v_cvt_pk_f16_f32 v104, v92, v93
    v_cvt_pk_f16_f32 v105, v94, v95
    s_nop 1
    v_mfma_f32_16x16x16_f16 v[132:135], v[104:105], v[178:179], v[132:135]
    v_add_f32 v52, v116, v117
    v_mul_f32 v53, v116, v116
    v_mul_f32 v54, v116, v136
    v_fmac_f32 v53, v117, v117
    v_fmac_f32 v54, v117, v137
    v_add_f32 v52, v52, v118
    v_fmac_f32 v53, v118, v118
    v_fmac_f32 v54, v118, v138
    v_add_f32 v52, v52, v119
    v_fmac_f32 v53, v119, v119
    v_fmac_f32 v54, v119, v139
    v_add_f32 v52, v52, v120
    v_fmac_f32 v53, v120, v120
    v_fmac_f32 v54, v120, v140
    v_add_f32 v52, v52, v121
    v_fmac_f32 v53, v121, v121
    v_fmac_f32 v54, v121, v141
    v_add_f32 v52, v52, v122
    v_fmac_f32 v53, v122, v122
    v_fmac_f32 v54, v122, v142
    v_add_f32 v52, v52, v123
    v_fmac_f32 v53, v123, v123
    v_fmac_f32 v54, v123, v143
    v_add_f32 v52, v52, v124
    v_fmac_f32 v53, v124, v124
    v_fmac_f32 v54, v124, v144
    v_add_f32 v52, v52, v125
    v_fmac_f32 v53, v125, v125
    v_fmac_f32 v54, v125, v145
    v_add_f32 v52, v52, v126
    v_fmac_f32 v53, v126, v126
    v_fmac_f32 v54, v126, v146
    v_add_f32 v52, v52, v127
    v_fmac_f32 v53, v127, v127
    v_fmac_f32 v54, v127, v147
    v_add_f32 v52, v52, v128
    v_fmac_f32 v53, v128, v128
    v_fmac_f32 v54, v128, v148
    v_add_f32 v52, v52, v129
    v_fmac_f32 v53, v129, v129
    v_fmac_f32 v54, v129, v149
    v_add_f32 v52, v52, v130
    v_fmac_f32 v53, v130, v130
    v_fmac_f32 v54, v130, v150
    v_add_f32 v52, v52, v131
    v_fmac_f32 v53, v131, v131
    v_fmac_f32 v54, v131, v151
    v_add_f32 v52, v52, v132
    v_fmac_f32 v53, v132, v132
    v_fmac_f32 v54, v132, v152
    v_add_f32 v52, v52, v133
    v_fmac_f32 v53, v133, v133
    v_fmac_f32 v54, v133, v153
    v_add_f32 v52, v52, v134
    v_fmac_f32 v53, v134, v134
    v_fmac_f32 v54, v134, v154
    v_add_f32 v52, v52, v135
    v_fmac_f32 v53, v135, v135
    v_fmac_f32 v54, v135, v155
    v_mov_b32 v55, v242
    v_permlane32_swap_b32 v52, v53
    s_nop 0
    v_permlane32_swap_b32 v54, v55
    v_add_f32 v52, v52, v53
    v_add_f32 v54, v54, v55
    s_nop 1
    v_permlane16_swap_b32 v52, v54
    v_add_f32 v52, v52, v54
    ds_write_b32 v244, v52 offset:6144
    v_lshlrev_b32 v53, 2, v1
    v_add_u32 v53, 96608, v53
    s_waitcnt lgkmcnt(0)
    s_barrier
    ds_read2st64_b32 v[64:65], v53 offset0:0 offset1:1
    ds_read2st64_b32 v[66:67], v53 offset0:2 offset1:3
    ds_read2st64_b32 v[68:69], v53 offset0:4 offset1:5
    ds_read2st64_b32 v[70:71], v53 offset0:6 offset1:7
    s_waitcnt lgkmcnt(2)
    v_add_f32 v64, v64, v65
    v_add_f32 v66, v66, v67
    s_waitcnt lgkmcnt(0)
    v_add_f32 v68, v68, v69
    v_add_f32 v70, v70, v71
    v_add_f32 v64, v64, v66
    v_add_f32 v68, v68, v70
    v_add_f32 v52, v64, v68
    v_add_f32 v54, v64, v68
    s_nop 1
    v_permlane16_swap_b32 v52, v54
    v_mov_b32 v53, v52
    v_mov_b32 v55, v54
    s_nop 0
    v_permlane32_swap_b32 v52, v53
    v_permlane32_swap_b32 v54, v55
    v_mul_f32 v56, 0x3acccccd, v52
    v_mul_f32 v57, 0x3acccccd, v53
    v_fma_f32 v57, -v56, v56, v57
    v_max_f32 v57, 0, v57
    v_cvt_pk_bf16_f32 v61, v57, v57
    v_and_b32 v61, 0xffff0000, v61
    v_cvt_pk_bf16_f32 v58, v56, v56
    v_and_b32 v58, 0xffff0000, v58
    v_add_f32 v61, 0x3727c5ac, v61
    v_cvt_pk_bf16_f32 v61, v61, v61
    v_and_b32 v61, 0xffff0000, v61
    v_sqrt_f32 v61, v61
    s_nop 0
    v_cvt_pk_bf16_f32 v59, v61, v61
    v_and_b32 v59, 0xffff0000, v59
    v_rcp_f32 v60, v59
    s_nop 0
    v_and_b32 v60, 0xffffff00, v60
    s_cmp_lg_u32 s22, 0
    s_cbranch_scc1 L_key_29
    v_fma_f32 v64, -v58, v55, v54
    v_mul_f32 v64, v64, v60
    v_cvt_pk_bf16_f32 v70, v64, v64
    v_and_b32 v70, 0xffff0000, v70
    v_ashrrev_i32 v65, 31, v70
    v_or_b32 v65, 0x80000000, v65
    v_xor_b32 v65, v65, v70
    v_and_b32 v65, 0xffff0000, v65
    v_or_b32 v65, s24, v65
    s_lshl_b32 s64, s23, 6
    v_lshl_add_u32 v66, v3, 2, s64
    s_mov_b64 exec, 0xffff
    global_store_dword v66, v65, s[44:45] sc1
    v_or_b32 v68, s24, v58
    v_or_b32 v69, s24, v59
    v_or_b32 v70, s24, v70
    v_mov_b32 v71, s24
    v_lshlrev_b32 v66, 2, v66
    global_store_dwordx4 v66, v[68:71], s[46:47] sc1
    s_lshl_b32 s64, s23, 9
    s_add_u32 s64, s64, 0x1000 + 256
    v_mov_b32 v67, s64
    s_mov_b64 exec, 1
    global_store_dword v67, v71, s[20:21] sc1
    s_mov_b64 exec, -1
L_key_29:
    v_mul_f32_e64 v62, -v58, v60
    v_fma_f32 v72, v116, v60, v62
    v_fma_f32 v73, v117, v60, v62
    v_fma_f32 v74, v118, v60, v62
    v_fma_f32 v75, v119, v60, v62
    v_cvt_pkrtz_f16_f32 v92, v72, v73
    v_add_u32 v92, s30, v92
    v_cvt_pkrtz_f16_f32 v93, v74, v75
    v_add_u32 v93, s30, v93
    v_bfi_b32 v92, v4, s26, v92
    v_bfi_b32 v93, v4, s27, v93
    v_fma_f32 v76, v120, v60, v62
    v_fma_f32 v77, v121, v60, v62
    v_fma_f32 v78, v122, v60, v62
    v_fma_f32 v79, v123, v60, v62
    v_cvt_pkrtz_f16_f32 v94, v76, v77
    v_add_u32 v94, s30, v94
    v_cvt_pkrtz_f16_f32 v95, v78, v79
    v_add_u32 v95, s30, v95
    v_bfi_b32 v94, v4, s28, v94
    v_bfi_b32 v95, v4, s29, v95
    global_store_dwordx4 v238, v[92:95], s[42:43] sc1
    v_fma_f32 v80, v124, v60, v62
    v_fma_f32 v81, v125, v60, v62
    v_fma_f32 v82, v126, v60, v62
    v_fma_f32 v83, v127, v60, v62
    v_cvt_pkrtz_f16_f32 v96, v80, v81
    v_add_u32 v96, s30, v96
    v_cvt_pkrtz_f16_f32 v97, v82, v83
    v_add_u32 v97, s30, v97
    v_bfi_b32 v96, v4, s26, v96
    v_bfi_b32 v97, v4, s27, v97
    v_fma_f32 v84, v128, v60, v62
    v_fma_f32 v85, v129, v60, v62
    v_fma_f32 v86, v130, v60, v62
    v_fma_f32 v87, v131, v60, v62
    v_cvt_pkrtz_f16_f32 v98, v84, v85
    v_add_u32 v98, s30, v98
    v_cvt_pkrtz_f16_f32 v99, v86, v87
    v_add_u32 v99, s30, v99
    v_bfi_b32 v98, v4, s28, v98
    v_bfi_b32 v99, v4, s29, v99
    global_store_dwordx4 v238, v[96:99], s[42:43] offset:1024 sc1
    v_fma_f32 v88, v132, v60, v62
    v_fma_f32 v89, v133, v60, v62
    v_fma_f32 v90, v134, v60, v62
    v_fma_f32 v91, v135, v60, v62
    v_cvt_pkrtz_f16_f32 v100, v88, v89
    v_add_u32 v100, s30, v100
    v_cvt_pkrtz_f16_f32 v101, v90, v91
    v_add_u32 v101, s30, v101
    v_bfi_b32 v100, v4, s26, v100
    v_bfi_b32 v101, v4, s27, v101
    global_store_dwordx2 v239, v[100:101], s[42:43] offset:2048 sc1
    v_add_f32 v72, v72, v116
    v_add_f32 v73, v73, v117
    v_add_f32 v74, v74, v118
    v_add_f32 v75, v75, v119
    v_add_f32 v76, v76, v120
    v_add_f32 v77, v77, v121
    v_add_f32 v78, v78, v122
    v_add_f32 v79, v79, v123
    v_add_f32 v80, v80, v124
    v_add_f32 v81, v81, v125
    v_add_f32 v82, v82, v126
    v_add_f32 v83, v83, v127
    v_add_f32 v84, v84, v128
    v_add_f32 v85, v85, v129
    v_add_f32 v86, v86, v130
    v_add_f32 v87, v87, v131
    v_add_f32 v88, v88, v132
    v_add_f32 v89, v89, v133
    v_add_f32 v90, v90, v134
    v_add_f32 v91, v91, v135
    v_cvt_pk_bf16_f32 v104, v72, v76
    ds_write_b16 v243, v104 offset:0
    ds_write_b16_d16_hi v243, v104 offset:16
    v_cvt_pk_bf16_f32 v105, v80, v84
    ds_write_b16 v243, v105 offset:32
    ds_write_b16_d16_hi v243, v105 offset:48
    v_cvt_pk_bf16_f32 v106, v88, v73
    ds_write_b16 v243, v106 offset:64
    ds_write_b16_d16_hi v243, v106 offset:80
    v_cvt_pk_bf16_f32 v107, v77, v81
    ds_write_b16 v243, v107 offset:96
    ds_write_b16_d16_hi v243, v107 offset:112
    v_cvt_pk_bf16_f32 v108, v85, v89
    ds_write_b16 v243, v108 offset:128
    ds_write_b16_d16_hi v243, v108 offset:144
    s_waitcnt lgkmcnt(4)
    v_cvt_pk_bf16_f32 v109, v74, v78
    ds_write_b16 v243, v109 offset:160
    ds_write_b16_d16_hi v243, v109 offset:176
    v_cvt_pk_bf16_f32 v110, v82, v86
    ds_write_b16 v243, v110 offset:192
    ds_write_b16_d16_hi v243, v110 offset:208
    v_cvt_pk_bf16_f32 v111, v90, v75
    ds_write_b16 v243, v111 offset:224
    ds_write_b16_d16_hi v243, v111 offset:240
    v_cvt_pk_bf16_f32 v104, v79, v83
    ds_write_b16 v243, v104 offset:256
    ds_write_b16_d16_hi v243, v104 offset:272
    v_cvt_pk_bf16_f32 v105, v87, v91
    ds_write_b16 v243, v105 offset:288
    ds_write_b16_d16_hi v243, v105 offset:304
    s_waitcnt lgkmcnt(0)
    s_cmp_lg_u32 s22, 0
    s_cbranch_scc1 L_wm_30
    v_mov_b32 v52, s51
    s_mov_b32 s70, 20000
    s_nop 0
L_wt_31:
    global_load_dword v53, v52, s[20:21] offset:128 sc1
    s_waitcnt vmcnt(0)
    v_and_b32 v53, 0xffff, v53
    v_cmp_ne_u32 vcc, s24, v53
    s_cbranch_vccz L_wm_30
    s_sleep 1
    s_sub_u32 s70, s70, 1
    s_cmp_lg_u32 s70, 0
    s_cbranch_scc1 L_wt_31
L_wm_30:
    s_barrier
    ds_read2_b32 v[72:73], v249 offset0:0 offset1:1
    ds_read2_b32 v[74:75], v249 offset0:2 offset1:3
    ds_read2_b32 v[76:77], v250 offset0:0 offset1:1
    ds_read2_b32 v[78:79], v250 offset0:2 offset1:3
    ds_read2_b32 v[80:81], v251 offset0:0 offset1:1
    v_mov_b32 v111, s51
    v_add_u32 v111, 128, v111
    s_mov_b32 s70, 20000
    s_nop 0
L_rt_32:
    global_load_dwordx4 v[100:103], v111, s[20:21] sc1
    global_load_dwordx4 v[104:107], v111, s[20:21] offset:16 sc1
    s_waitcnt vmcnt(0)
    v_xor_b32 v53, s24, v100
    v_bitop3_b32 v53, v53, s24, v101 bitop3:0xf6
    v_bitop3_b32 v53, v53, s24, v102 bitop3:0xf6
    v_bitop3_b32 v53, v53, s24, v103 bitop3:0xf6
    v_bitop3_b32 v53, v53, s24, v104 bitop3:0xf6
    v_bitop3_b32 v53, v53, s24, v105 bitop3:0xf6
    v_bitop3_b32 v53, v53, s24, v106 bitop3:0xf6
    v_bitop3_b32 v53, v53, s24, v107 bitop3:0xf6
    v_and_b32 v53, 0xffff, v53
    v_cmp_ne_u32 vcc, 0, v53
    s_cbranch_vccz L_rd_33
    s_sub_u32 s70, s70, 1
    s_cmp_lg_u32 s70, 0
    s_cbranch_scc1 L_rt_32
    s_nop 0
L_rd_33:
    v_lshrrev_b32 v54, 5, v1
    s_lshl_b32 s64, s22, 1
    v_add_u32 v54, s64, v54
    v_lshl_add_u32 v54, v54, 7, s23
    s_mov_b64 s[76:77], -1
    v_lshrrev_b32 v100, 16, v100
    v_cmp_ne_u32 vcc, v100, v54
    s_nop 0
    s_and_b64 s[76:77], s[76:77], vcc
    v_lshrrev_b32 v101, 16, v101
    v_cmp_ne_u32 vcc, v101, v54
    s_nop 0
    s_and_b64 s[76:77], s[76:77], vcc
    v_lshrrev_b32 v102, 16, v102
    v_cmp_ne_u32 vcc, v102, v54
    s_nop 0
    s_and_b64 s[76:77], s[76:77], vcc
    v_lshrrev_b32 v103, 16, v103
    v_cmp_ne_u32 vcc, v103, v54
    s_nop 0
    s_and_b64 s[76:77], s[76:77], vcc
    v_lshrrev_b32 v104, 16, v104
    v_cmp_ne_u32 vcc, v104, v54
    s_nop 0
    s_and_b64 s[76:77], s[76:77], vcc
    v_lshrrev_b32 v105, 16, v105
    v_cmp_ne_u32 vcc, v105, v54
    s_nop 0
    s_and_b64 s[76:77], s[76:77], vcc
    v_lshrrev_b32 v106, 16, v106
    v_cmp_ne_u32 vcc, v106, v54
    s_nop 0
    s_and_b64 s[76:77], s[76:77], vcc
    v_lshrrev_b32 v107, 16, v107
    v_cmp_ne_u32 vcc, v107, v54
    s_nop 0
    s_and_b64 s[76:77], s[76:77], vcc
    s_waitcnt lgkmcnt(0)
    s_mov_b64 exec, s[76:77]
    s_cbranch_execz L_nost_34
    global_store_dwordx4 v252, v[72:75], s[16:17] offset:0 sc1
    global_store_dwordx4 v252, v[76:79], s[16:17] offset:512 sc1
    global_store_dwordx2 v253, v[80:81], s[16:17] offset:1024 sc1
    s_nop 0
L_nost_34:
    s_mov_b64 exec, -1
    s_branch L_end
L_F:
    s_cmp_ge_u32 s2, 256
    s_cbranch_scc1 L_end2
    s_and_b32 s23, s2, 127
    s_and_b32 s64, s23, 7
    s_lshr_b32 s65, s23, 3
    s_cmp_ge_u32 s65, 13
    s_cbranch_scc1 L_D
    s_cmp_ge_u32 s65, 8
    s_cbranch_scc1 L_C
    s_lshr_b32 s66, s65, 1
    s_lshl_b32 s66, s66, 3
    s_add_u32 s50, s64, s66
    s_lshl_b32 s50, s50, 1
    s_and_b32 s66, s65, 1
    s_add_u32 s50, s50, s66
    s_sub_u32 s67, s50, 54
    s_cmp_ge_u32 s50, 54
    s_cbranch_scc1 L_idle
    v_lshrrev_b32 v52, 2, v0
    v_mul_u32_u24 v52, 3456, v52
    v_and_b32 v53, 3, v0
    v_lshl_add_u32 v52, v53, 4, v52
    s_lshl_b32 s64, s50, 6
    v_add_u32 v52, s64, v52
    s_waitcnt lgkmcnt(0)
    s_load_dword s25, s[20:21], 0
    s_mov_b32 s52, s10
    s_and_b32 s53, s11, 0xffff
    s_mov_b32 s54, 2211840
    s_mov_b32 s55, 0x00020000
    s_mov_b32 s56, s12
    s_and_b32 s57, s13, 0xffff
    s_mov_b32 s58, 2211840
    s_mov_b32 s59, 0x00020000
    s_mov_b32 s64, 0
    buffer_load_dwordx4 v[192:195], v52, s[52:55], s64 offen
    buffer_load_dwordx4 v[212:215], v52, s[56:59], s64 offen
    s_mov_b32 s64, 442368
    buffer_load_dwordx4 v[196:199], v52, s[52:55], s64 offen
    buffer_load_dwordx4 v[216:219], v52, s[56:59], s64 offen
    s_mov_b32 s64, 884736
    buffer_load_dwordx4 v[200:203], v52, s[52:55], s64 offen
    buffer_load_dwordx4 v[220:223], v52, s[56:59], s64 offen
    s_mov_b32 s64, 1327104
    buffer_load_dwordx4 v[204:207], v52, s[52:55], s64 offen
    buffer_load_dwordx4 v[224:227], v52, s[56:59], s64 offen
    s_mov_b32 s64, 1769472
    buffer_load_dwordx4 v[208:211], v52, s[52:55], s64 offen
    buffer_load_dwordx4 v[228:231], v52, s[56:59], s64 offen
    v_and_b32 v1, 63, v0
    v_lshrrev_b32 v8, 6, v0
    v_lshrrev_b32 v2, 4, v1
    v_readfirstlane_b32 s22, v8
    v_and_b32 v3, 15, v0
    v_mov_b32 v4, 0x00030003
    s_mov_b32 s30, 0x00020002
    s_mov_b32 s82, 0x42000000
    s_and_b32 s23, s2, 127
    s_getpc_b64 s[34:35]
    s_add_u32 s34, s34, dft_tbl@rel32@lo+4
    s_addc_u32 s35, s35, dft_tbl@rel32@hi+12
    s_cmp_lg_u32 s22, 7
    s_cbranch_scc1 L_pf_35
    s_getpc_b64 s[84:85]
    s_add_u32 s84, s84, interleave_layers__spectral_fnet__moe_arch_mod__prompt_kernel@rel32@lo+4
    s_addc_u32 s85, s85, interleave_layers__spectral_fnet__moe_arch_mod__prompt_kernel@rel32@hi+12
    s_lshr_b32 s64, s2, 3
    s_mul_i32 s64, s64, 6
    v_min_u32 v8, 5, v1
    v_add_u32 v8, s64, v8
    v_min_u32 v8, 179, v8
    v_lshlrev_b32 v8, 7, v8
    global_load_dword v8, v8, s[84:85]
    s_nop 0
L_pf_35:
    v_lshlrev_b32 v168, 4, v0
    v_mul_u32_u24 v52, 160, v2
    v_lshrrev_b32 v53, 2, v3
    v_mul_u32_u24 v54, 40, v53
    v_add3_u32 v52, v52, v54, s22
    v_and_b32 v54, 3, v3
    v_lshlrev_b32 v55, 3, v54
    v_lshl_add_u32 v52, v52, 6, v55
    v_lshrrev_b32 v56, 2, v0
    v_and_b32 v57, 3, v0
    v_lshl_add_u32 v56, v57, 9, v56
    v_sub_u32 v164, 2047, v56
    v_sub_u32 v165, 1919, v56
    v_sub_u32 v166, 1791, v56
    v_sub_u32 v167, 1663, v56
    v_lshrrev_b32 v56, 3, v3
    v_and_b32 v57, 7, v3
    v_lshrrev_b32 v58, 1, v2
    v_lshlrev_b32 v171, 7, v58
    v_lshl_add_u32 v171, v57, 4, v171
    s_lshl_b32 s64, s50, 9
    s_lshl_b32 s65, s22, 8
    s_add_u32 s64, s64, s65
    v_add_u32 v171, s64, v171
    v_lshrrev_b32 v188, 2, v171
    v_add_u32 v188, 0x7000, v188
    s_lshl_b32 s64, s22, 12
    s_add_u32 s64, s64, 0
    v_lshl_add_u32 v169, v1, 4, s64
    v_lshl_add_u32 v58, v2, 4, v57
    v_lshlrev_b32 v170, 4, v58
    v_lshl_add_u32 v170, v56, 14, v170
    s_lshl_b32 s64, s22, 11
    s_add_u32 s64, s64, 0
    v_add_u32 v170, s64, v170
    s_lshl_b32 s64, s22, 5
    s_add_u32 s64, s64, 41344
    v_mov_b32 v172, s64
    v_and_b32 v175, 31, v1
    v_lshlrev_b32 v175, 2, v175
    v_add_u32 v175, 32768, v175
    v_lshrrev_b32 v174, 5, v1
    v_lshlrev_b32 v174, 6, v174
    v_add_u32 v174, 32768, v174
    v_and_b32 v177, 7, v3
    v_lshl_add_u32 v177, v177, 2, v172
    v_bfe_u32 v178, v1, 2, 3
    v_lshl_add_u32 v178, v178, 2, v172
    v_lshrrev_b32 v179, 3, v1
    v_lshl_add_u32 v179, v179, 2, v172
    s_mul_i32 s64, s22, 2560
    v_lshrrev_b32 v58, 5, v1
    v_lshl_add_u32 v185, v58, 10, s64
    v_and_b32 v58, 3, v1
    v_lshl_add_u32 v185, v58, 4, v185
    s_add_u32 s64, s64, 2048
    v_and_b32 v58, 7, v1
    v_lshl_add_u32 v186, v58, 2, s64
    s_mul_i32 s64, s22, 1280
    s_add_u32 s64, s64, 41856
    v_lshl_add_u32 v180, v1, 4, s64
    v_lshl_add_u32 v181, v1, 2, s64
    v_lshl_add_u32 v58, v57, 2, v2
    v_lshl_add_u32 v182, v58, 4, s64
    v_lshl_add_u32 v183, v58, 3, s64
    v_lshl_add_u32 v187, v2, 5, s50
    v_and_b32 v187, 127, v187
    v_lshlrev_b32 v187, 9, v187
    v_add_u32 v187, 0x1080, v187
    s_mul_i32 s64, s50, 205
    s_lshr_b32 s64, s64, 12
    s_mul_i32 s65, s64, 20
    s_sub_u32 s65, s50, s65
    s_lshl_b32 s65, s65, 3
    s_add_u32 s64, s64, s65
    s_lshl_b32 s64, s64, 7
    s_add_u32 s71, s64, 0x80000
    v_mul_u32_u24 v176, 54, v2
    v_min_u32 v176, 128, v176
    v_add_u32 v176, s50, v176
    v_lshlrev_b32 v176, 9, v176
    v_lshl_add_u32 v176, v3, 2, v176
    v_add_u32 v176, 0x11000, v176
    s_mov_b32 s78, 0x00ff00ff
    s_cmp_lt_u32 s50, 20
    s_cselect_b32 s79, s78, 0
    s_lshl_b32 s51, s50, 9
    s_add_u32 s51, s51, 0x1080
    s_waitcnt lgkmcnt(0)
    s_and_b32 s64, s25, 0xffff
    s_lshr_b32 s65, s25, 16
    s_add_u32 s24, s64, 1
    s_and_b32 s24, s24, 0xbfff
    s_add_u32 s66, s64, 2
    s_and_b32 s66, s66, 0xbfff
    s_cmp_eq_u32 s24, s65
    s_cselect_b32 s24, s66, s24
    s_lshl_b32 s83, s24, 16
    s_bfe_u32 s64, s24, 0x20000
    s_bfe_u32 s65, s24, 0x20002
    s_lshl_b32 s65, s65, 16
    s_or_b32 s26, s64, s65
    s_bfe_u32 s64, s24, 0x20004
    s_bfe_u32 s65, s24, 0x20006
    s_lshl_b32 s65, s65, 16
    s_or_b32 s27, s64, s65
    s_bfe_u32 s64, s24, 0x20008
    s_bfe_u32 s65, s24, 0x2000a
    s_lshl_b32 s65, s65, 16
    s_or_b32 s28, s64, s65
    s_xor_b32 s29, s26, 0x00030003
    v_and_b32 v58, 1, v1
    v_cmp_eq_u32 vcc, 1, v58
    v_mov_b32 v184, s26
    v_mov_b32 v58, s27
    v_cndmask_b32 v184, v184, v58, vcc
    s_waitcnt vmcnt(9)
    ds_write_b128 v168, v[192:195] offset:0
    s_waitcnt vmcnt(8)
    ds_write_b128 v168, v[212:215] offset:40960
    s_waitcnt vmcnt(7)
    ds_write_b128 v168, v[196:199] offset:8192
    s_waitcnt vmcnt(6)
    ds_write_b128 v168, v[216:219] offset:49152
    s_waitcnt vmcnt(5)
    ds_write_b128 v168, v[200:203] offset:16384
    s_waitcnt vmcnt(4)
    ds_write_b128 v168, v[220:223] offset:57344
    s_waitcnt vmcnt(3)
    ds_write_b128 v168, v[204:207] offset:24576
    s_waitcnt vmcnt(2)
    v_add_u32 v59, 65536, v168
    ds_write_b128 v59, v[224:227] offset:0
    s_waitcnt vmcnt(1)
    ds_write_b128 v168, v[208:211] offset:32768
    s_waitcnt vmcnt(0)
    v_add_u32 v59, 65536, v168
    ds_write_b128 v59, v[228:231] offset:8192
    s_waitcnt lgkmcnt(0)
    s_barrier
    ds_read_b64_tr_b16 v[116:117], v52 offset:0
    ds_read_b64_tr_b16 v[118:119], v52 offset:512
    ds_read_b64_tr_b16 v[120:121], v52 offset:1024
    ds_read_b64_tr_b16 v[122:123], v52 offset:1536
    ds_read_b64_tr_b16 v[124:125], v52 offset:2048
    ds_read_b64_tr_b16 v[128:129], v52 offset:32
    ds_read_b64_tr_b16 v[130:131], v52 offset:544
    ds_read_b64_tr_b16 v[132:133], v52 offset:1056
    ds_read_b64_tr_b16 v[134:135], v52 offset:1568
    ds_read_b64_tr_b16 v[136:137], v52 offset:2080
    s_waitcnt lgkmcnt(0)
    ds_read_b64_tr_b16 v[140:141], v52 offset:40960
    ds_read_b64_tr_b16 v[142:143], v52 offset:41472
    ds_read_b64_tr_b16 v[144:145], v52 offset:41984
    ds_read_b64_tr_b16 v[146:147], v52 offset:42496
    ds_read_b64_tr_b16 v[148:149], v52 offset:43008
    ds_read_b64_tr_b16 v[152:153], v52 offset:40992
    ds_read_b64_tr_b16 v[154:155], v52 offset:41504
    ds_read_b64_tr_b16 v[156:157], v52 offset:42016
    ds_read_b64_tr_b16 v[158:159], v52 offset:42528
    ds_read_b64_tr_b16 v[160:161], v52 offset:43040
    s_waitcnt lgkmcnt(0)
    s_barrier
    s_mov_b32 s73, 0
    s_mov_b32 s100, 20480
L_Gloop:
    s_mul_i32 s65, s73, 0x2000
    s_add_u32 s65, s65, 0x28000
    s_add_u32 s44, s20, s65
    s_addc_u32 s45, s21, 0
    s_mul_i32 s65, s73, 0x10000
    s_add_u32 s65, s65, 0x90000
    s_add_u32 s48, s20, s65
    s_addc_u32 s49, s21, 0
    s_mul_i32 s65, s73, 0x300000
    s_add_u32 s65, s65, 0xd00000
    s_add_u32 s42, s20, s65
    s_addc_u32 s43, s21, 0
    v_mov_b32 v52, 41280
    v_mov_b32 v53, 0
    ds_write_b32 v52, v53
    ds_write_b32 v175, v53
    s_waitcnt lgkmcnt(0)
    s_cmp_lg_u32 s22, 0
    s_cbranch_scc1 L_wm_36
    v_lshrrev_b32 v52, 5, v1
    v_mul_u32_u24 v52, 32768, v52
    v_add_u32 v52, s51, v52
    s_mov_b32 s70, 20000
    s_nop 0
L_wt_37:
    global_load_dword v53, v52, s[20:21] offset:0 sc1
    s_waitcnt vmcnt(0)
    v_and_b32 v53, 0xffff, v53
    v_cmp_ne_u32 vcc, s24, v53
    s_cbranch_vccz L_wm_36
    s_sleep 1
    s_sub_u32 s70, s70, 1
    s_cmp_lg_u32 s70, 0
    s_cbranch_scc1 L_wt_37
L_wm_36:
    s_barrier
    s_mov_b32 s70, 20000
L_rt_38:
    global_load_dwordx4 v[56:59], v168, s[44:45] sc1
    s_waitcnt vmcnt(0)
    v_xor_b32 v53, s24, v56
    v_bitop3_b32 v53, v53, s24, v57 bitop3:0xf6
    v_bitop3_b32 v53, v53, s24, v58 bitop3:0xf6
    v_bitop3_b32 v53, v53, s24, v59 bitop3:0xf6
    v_and_b32 v53, 0xffff, v53
    v_cmp_ne_u32 vcc, 0, v53
    s_cbranch_vccz L_rd_39
    s_sub_u32 s70, s70, 1
    s_cmp_lg_u32 s70, 0
    s_cbranch_scc1 L_rt_38
    s_nop 0
L_rd_39:
    s_mov_b32 s68, 0xffff0000
    v_and_or_b32 v56, v56, s68, v164
    v_and_or_b32 v57, v57, s68, v165
    v_and_or_b32 v58, v58, s68, v166
    v_and_or_b32 v59, v59, s68, v167
    v_max3_u32 v60, v56, v57, v58
    v_max_u32 v60, v60, v59
    s_lshl_b32 s64, s22, 2
    s_add_u32 s64, s64, 41216
    v_max_u32_dpp v60, v60, v60 row_ror:8 row_mask:0xf bank_mask:0xf
    s_nop 1
    v_max_u32_dpp v60, v60, v60 row_ror:4 row_mask:0xf bank_mask:0xf
    s_nop 1
    v_max_u32_dpp v60, v60, v60 row_ror:2 row_mask:0xf bank_mask:0xf
    s_nop 1
    v_max_u32_dpp v60, v60, v60 row_ror:1 row_mask:0xf bank_mask:0xf
    v_mov_b32 v61, v60
    v_mov_b32 v64, s64
    s_nop 0
    v_permlane16_swap_b32 v60, v61
    v_max_u32 v60, v60, v61
    v_mov_b32 v61, v60
    v_mov_b32 v65, 41216
    s_nop 0
    v_permlane32_swap_b32 v60, v61
    v_max_u32 v60, v60, v61
    ds_write_b32 v64, v60
    s_waitcnt lgkmcnt(0)
    s_barrier
    ds_read_b128 v[68:71], v65
    ds_read_b128 v[72:75], v65 offset:16
    v_mov_b32 v64, 41280
    s_waitcnt lgkmcnt(0)
    v_min3_u32 v62, v68, v69, v70
    v_min3_u32 v63, v71, v72, v73
    v_min3_u32 v62, v62, v74, v75
    v_min_u32 v62, v62, v63
    s_nop 1
L_topk_again:
    v_cmp_ge_u32 s[84:85], v56, v62
    v_cmp_ge_u32 s[86:87], v57, v62
    v_cmp_ge_u32 s[88:89], v58, v62
    v_cmp_ge_u32 s[90:91], v59, v62
    s_bcnt1_i32_b64 s64, s[84:85]
    s_bcnt1_i32_b64 s65, s[86:87]
    s_bcnt1_i32_b64 s66, s[88:89]
    s_bcnt1_i32_b64 s67, s[90:91]
    s_add_u32 s65, s65, s64
    s_add_u32 s66, s66, s65
    s_add_u32 s67, s67, s66
    v_mov_b32 v65, s67
    s_mov_b64 exec, 1
    ds_add_rtn_u32 v66, v64, v65
    s_mov_b64 exec, -1
    v_mbcnt_lo_u32_b32 v68, s84, 0
    v_mbcnt_hi_u32_b32 v68, s85, v68
    v_mbcnt_lo_u32_b32 v69, s86, 0
    v_mbcnt_hi_u32_b32 v69, s87, v69
    v_mbcnt_lo_u32_b32 v70, s88, 0
    v_mbcnt_hi_u32_b32 v70, s89, v70
    v_mbcnt_lo_u32_b32 v71, s90, 0
    v_mbcnt_hi_u32_b32 v71, s91, v71
    v_add_u32 v69, s64, v69
    v_add_u32 v70, s65, v70
    v_add_u32 v71, s66, v71
    s_waitcnt lgkmcnt(0)
    v_readfirstlane_b32 s68, v66
    s_nop 0
    s_lshl_b32 s68, s68, 2
    s_add_u32 s68, s68, 32768
    v_lshl_add_u32 v68, v68, 2, s68
    v_lshl_add_u32 v69, v69, 2, s68
    v_lshl_add_u32 v70, v70, 2, s68
    v_lshl_add_u32 v71, v71, 2, s68
    s_mov_b64 exec, s[84:85]
    ds_write_b32 v68, v56
    s_mov_b64 exec, s[86:87]
    ds_write_b32 v69, v57
    s_mov_b64 exec, s[88:89]
    ds_write_b32 v70, v58
    s_mov_b64 exec, s[90:91]
    ds_write_b32 v71, v59
    s_mov_b64 exec, -1
    s_waitcnt lgkmcnt(0)
    s_barrier
    ds_read_b32 v66, v175
    ds_read_b128 v[72:75], v174 offset:0
    ds_read_b128 v[76:79], v174 offset:16
    ds_read_b128 v[80:83], v174 offset:32
    ds_read_b128 v[84:87], v174 offset:48
    ds_read_b32 v68, v64
    v_mov_b32 v67, 0
    v_mov_b32 v69, 0
    s_waitcnt lgkmcnt(4)
    v_cmp_gt_u32 s[84:85], v72, v66
    v_cmp_gt_u32 s[86:87], v73, v66
    v_cmp_gt_u32 s[88:89], v74, v66
    v_cmp_gt_u32 s[90:91], v75, v66
    v_addc_co_u32 v67, s[96:97], 0, v67, s[84:85]
    v_addc_co_u32 v69, s[96:97], 0, v69, s[86:87]
    v_addc_co_u32 v67, s[96:97], 0, v67, s[88:89]
    v_addc_co_u32 v69, s[96:97], 0, v69, s[90:91]
    s_waitcnt lgkmcnt(3)
    v_cmp_gt_u32 s[84:85], v76, v66
    v_cmp_gt_u32 s[86:87], v77, v66
    v_cmp_gt_u32 s[88:89], v78, v66
    v_cmp_gt_u32 s[90:91], v79, v66
    v_addc_co_u32 v67, s[96:97], 0, v67, s[84:85]
    v_addc_co_u32 v69, s[96:97], 0, v69, s[86:87]
    v_addc_co_u32 v67, s[96:97], 0, v67, s[88:89]
    v_addc_co_u32 v69, s[96:97], 0, v69, s[90:91]
    s_waitcnt lgkmcnt(2)
    v_cmp_gt_u32 s[84:85], v80, v66
    v_cmp_gt_u32 s[86:87], v81, v66
    v_cmp_gt_u32 s[88:89], v82, v66
    v_cmp_gt_u32 s[90:91], v83, v66
    v_addc_co_u32 v67, s[96:97], 0, v67, s[84:85]
    v_addc_co_u32 v69, s[96:97], 0, v69, s[86:87]
    v_addc_co_u32 v67, s[96:97], 0, v67, s[88:89]
    v_addc_co_u32 v69, s[96:97], 0, v69, s[90:91]
    s_waitcnt lgkmcnt(1)
    v_cmp_gt_u32 s[84:85], v84, v66
    v_cmp_gt_u32 s[86:87], v85, v66
    v_cmp_gt_u32 s[88:89], v86, v66
    v_cmp_gt_u32 s[90:91], v87, v66
    v_addc_co_u32 v67, s[96:97], 0, v67, s[84:85]
    v_addc_co_u32 v69, s[96:97], 0, v69, s[86:87]
    v_addc_co_u32 v67, s[96:97], 0, v67, s[88:89]
    v_addc_co_u32 v69, s[96:97], 0, v69, s[90:91]
    s_waitcnt lgkmcnt(0)
    v_readfirstlane_b32 s64, v68
    v_add_u32 v67, v67, v69
    v_mov_b32 v69, v67
    s_nop 1
    v_permlane32_swap_b32 v67, v69
    v_add_u32 v67, v67, v69
    s_cmp_le_u32 s64, 32
    s_cbranch_scc1 L_topk_done
    v_cmp_eq_u32 vcc, 7, v67
    s_nop 0
    s_ff1_i32_b64 s66, vcc
    v_readlane_b32 s66, v66, s66
    s_nop 1
    v_mov_b32 v62, s66
    s_barrier
    v_mov_b32 v65, 0
    ds_write_b32 v64, v65
    ds_write_b32 v175, v65
    s_waitcnt lgkmcnt(0)
    s_barrier
    s_branch L_topk_again
L_topk_done:
    v_cmp_gt_u32 vcc, 8, v67
    v_lshl_add_u32 v67, v67, 2, v172
    s_mov_b64 exec, vcc
    ds_write_b32 v67, v66
    s_mov_b64 exec, -1
    s_waitcnt lgkmcnt(0)
    ds_read_b32 v52, v178
    ds_read_b32 v53, v179
    ds_read_b32 v173, v177
    s_waitcnt lgkmcnt(2)
    v_not_b32 v52, v52
    v_and_b32 v56, 127, v52
    v_bfe_u32 v57, v52, 7, 4
    v_mad_u32_u24 v54, v56, s100, v185
    v_lshl_add_u32 v54, v57, 6, v54
    s_waitcnt lgkmcnt(1)
    v_not_b32 v53, v53
    v_and_b32 v56, 127, v53
    v_bfe_u32 v57, v53, 7, 4
    v_mad_u32_u24 v55, v56, s100, v186
    v_lshl_add_u32 v55, v57, 5, v55
    global_load_dwordx4 v[60:63], v54, s[42:43] sc1
    global_load_dword v64, v55, s[42:43] sc1
    s_cmp_lg_u32 s22, 7
    s_cbranch_scc1 L_mail_40
    s_lshl_b32 s65, s73, 7
    v_add_u32 v58, s65, v176
    s_waitcnt lgkmcnt(0)
    v_not_b32 v173, v173
    v_and_b32 v59, 0x7ff, v173
    v_lshl_or_b32 v59, v59, 16, s24
    s_mov_b64 exec, s[78:79]
    global_store_dword v58, v59, s[20:21] sc1
    s_mov_b64 exec, -1
L_mail_40:
    s_cmp_eq_u32 s22, 7
    s_waitcnt vmcnt(1)
    s_cbranch_scc1 L_w7_41
    s_waitcnt vmcnt(0)
L_w7_41:
    s_mov_b32 s70, 20000
    s_branch L_rt_42_c
L_rt_42:
    global_load_dwordx4 v[60:63], v54, s[42:43] sc1
    global_load_dword v64, v55, s[42:43] sc1
    s_waitcnt vmcnt(0)
L_rt_42_c:
    v_xor_b32 v60, s26, v60
    v_xor_b32 v61, s27, v61
    v_xor_b32 v62, s28, v62
    v_xor_b32 v63, s29, v63
    v_xor_b32 v64, v184, v64
    v_or3_b32 v72, v60, v61, v62
    v_or3_b32 v72, v72, v63, v64
    v_and_b32 v72, v4, v72
    v_cmp_ne_u32 vcc, 0, v72
    s_cbranch_vccz L_rd_43
    s_sub_u32 s70, s70, 1
    s_cmp_lg_u32 s70, 0
    s_cbranch_scc1 L_rt_42
    s_nop 0
L_rd_43:
    v_cvt_f32_f16 v88, v60
    v_cvt_f32_f16_sdwa v89, v60 dst_sel:DWORD dst_unused:UNUSED_PAD src0_sel:WORD_1
    v_cvt_pk_bf16_f32 v68, v88, v89
    v_cvt_f32_f16 v90, v61
    v_cvt_f32_f16_sdwa v91, v61 dst_sel:DWORD dst_unused:UNUSED_PAD src0_sel:WORD_1
    v_cvt_pk_bf16_f32 v69, v90, v91
    v_cvt_f32_f16 v92, v62
    v_cvt_f32_f16_sdwa v93, v62 dst_sel:DWORD dst_unused:UNUSED_PAD src0_sel:WORD_1
    v_cvt_pk_bf16_f32 v70, v92, v93
    v_cvt_f32_f16 v94, v63
    v_cvt_f32_f16_sdwa v95, v63 dst_sel:DWORD dst_unused:UNUSED_PAD src0_sel:WORD_1
    v_cvt_pk_bf16_f32 v71, v94, v95
    ds_write_b128 v180, v[68:71]
    v_cvt_f32_f16 v88, v64
    v_cvt_f32_f16_sdwa v89, v64 dst_sel:DWORD dst_unused:UNUSED_PAD src0_sel:WORD_1
    v_cvt_pk_bf16_f32 v72, v88, v89
    ds_write_b32 v181, v72 offset:1024
    ds_read_b128 v[76:79], v182
    ds_read_b128 v[80:83], v182 offset:512
    ds_read_b64 v[84:85], v183 offset:1024
    s_waitcnt lgkmcnt(2)
    v_mfma_f32_16x16x32_bf16 v[96:99], v[116:119], v[76:79], 0
    v_mfma_f32_16x16x32_bf16 v[100:103], v[140:143], v[76:79], 0
    v_mfma_f32_16x16x32_bf16 v[104:107], v[128:131], v[76:79], 0
    v_mfma_f32_16x16x32_bf16 v[108:111], v[152:155], v[76:79], 0
    s_waitcnt lgkmcnt(1)
    v_mfma_f32_16x16x32_bf16 v[96:99], v[120:123], v[80:83], v[96:99]
    v_mfma_f32_16x16x32_bf16 v[100:103], v[144:147], v[80:83], v[100:103]
    v_mfma_f32_16x16x32_bf16 v[104:107], v[132:135], v[80:83], v[104:107]
    v_mfma_f32_16x16x32_bf16 v[108:111], v[156:159], v[80:83], v[108:111]
    s_waitcnt lgkmcnt(0)
    v_mfma_f32_16x16x16_bf16 v[96:99], v[124:125], v[84:85], v[96:99]
    v_mfma_f32_16x16x16_bf16 v[100:103], v[148:149], v[84:85], v[100:103]
    v_mfma_f32_16x16x16_bf16 v[104:107], v[136:137], v[84:85], v[104:107]
    v_mfma_f32_16x16x16_bf16 v[108:111], v[160:161], v[84:85], v[108:111]
    s_nop 4
    ds_write_b128 v169, v[96:99] offset:0
    ds_write_b128 v169, v[100:103] offset:1024
    ds_write_b128 v169, v[104:107] offset:2048
    ds_write_b128 v169, v[108:111] offset:3072
    s_waitcnt lgkmcnt(0)
    s_barrier
    s_cmp_gt_u32 s22, 1
    s_cbranch_scc1 L_gfin_44
    ds_read_b128 v[60:63], v170 offset:0
    ds_read_b128 v[64:67], v170 offset:1024
    ds_read_b128 v[68:71], v170 offset:4096
    ds_read_b128 v[72:75], v170 offset:5120
    ds_read_b128 v[76:79], v170 offset:8192
    ds_read_b128 v[80:83], v170 offset:9216
    ds_read_b128 v[84:87], v170 offset:12288
    ds_read_b128 v[88:91], v170 offset:13312
    s_waitcnt lgkmcnt(4)
    v_add_f32 v60, v60, v68
    v_add_f32 v61, v61, v69
    v_add_f32 v62, v62, v70
    v_add_f32 v63, v63, v71
    v_add_f32 v64, v64, v72
    v_add_f32 v65, v65, v73
    v_add_f32 v66, v66, v74
    v_add_f32 v67, v67, v75
    s_waitcnt lgkmcnt(0)
    v_add_f32 v76, v76, v84
    v_add_f32 v77, v77, v85
    v_add_f32 v78, v78, v86
    v_add_f32 v79, v79, v87
    v_add_f32 v80, v80, v88
    v_add_f32 v81, v81, v89
    v_add_f32 v82, v82, v90
    v_add_f32 v83, v83, v91
    v_add_f32 v60, v60, v76
    v_add_f32 v61, v61, v77
    v_add_f32 v62, v62, v78
    v_add_f32 v63, v63, v79
    v_add_f32 v64, v64, v80
    v_add_f32 v65, v65, v81
    v_add_f32 v66, v66, v82
    v_add_f32 v67, v67, v83
    v_add_f32_dpp v60, v60, v60 row_ror:8 row_mask:0xf bank_mask:0xf
    v_add_f32_dpp v61, v61, v61 row_ror:8 row_mask:0xf bank_mask:0xf
    v_add_f32_dpp v62, v62, v62 row_ror:8 row_mask:0xf bank_mask:0xf
    v_add_f32_dpp v63, v63, v63 row_ror:8 row_mask:0xf bank_mask:0xf
    v_add_f32_dpp v64, v64, v64 row_ror:8 row_mask:0xf bank_mask:0xf
    v_add_f32_dpp v65, v65, v65 row_ror:8 row_mask:0xf bank_mask:0xf
    v_add_f32_dpp v66, v66, v66 row_ror:8 row_mask:0xf bank_mask:0xf
    v_add_f32_dpp v67, v67, v67 row_ror:8 row_mask:0xf bank_mask:0xf
    v_cvt_pk_bf16_f32 v68, v60, v61
    v_cvt_pk_bf16_f32 v70, v62, v63
    v_lshlrev_b32 v60, 16, v68
    v_and_b32 v61, 0xffff0000, v68
    v_lshlrev_b32 v62, 16, v70
    v_and_b32 v63, 0xffff0000, v70
    v_mul_f32 v68, 0xbfb8aa3b, v60
    v_mul_f32 v69, 0xbfb8aa3b, v61
    v_mul_f32 v70, 0xbfb8aa3b, v62
    v_mul_f32 v71, 0xbfb8aa3b, v63
    v_exp_f32 v68, v68
    v_exp_f32 v69, v69
    v_exp_f32 v70, v70
    v_exp_f32 v71, v71
    v_cvt_pk_bf16_f32 v72, v64, v65
    v_cvt_pk_bf16_f32 v74, v66, v67
    v_lshlrev_b32 v64, 16, v72
    v_and_b32 v65, 0xffff0000, v72
    v_lshlrev_b32 v66, 16, v74
    v_and_b32 v67, 0xffff0000, v74
    v_add_f32 v68, 1.0, v68
    v_add_f32 v69, 1.0, v69
    v_add_f32 v70, 1.0, v70
    v_add_f32 v71, 1.0, v71
    v_rcp_f32 v68, v68
    v_rcp_f32 v69, v69
    v_rcp_f32 v70, v70
    v_rcp_f32 v71, v71
    v_mul_f32 v60, v60, v68
    v_mul_f32 v61, v61, v69
    v_mul_f32 v62, v62, v70
    v_mul_f32 v63, v63, v71
    v_cvt_pk_bf16_f32 v68, v60, v61
    v_cvt_pk_bf16_f32 v70, v62, v63
    v_lshlrev_b32 v60, 16, v68
    v_and_b32 v61, 0xffff0000, v68
    v_lshlrev_b32 v62, 16, v70
    v_and_b32 v63, 0xffff0000, v70
    v_mul_f32 v60, v60, v64
    v_mul_f32 v61, v61, v65
    v_mul_f32 v62, v62, v66
    v_mul_f32 v63, v63, v67
    v_cvt_pk_bf16_f32 v72, v60, v61
    v_cvt_pk_bf16_f32 v73, v62, v63
    v_mov_b32 v74, v72
    v_mov_b32 v75, v73
    s_or_b32 s64, s24, s83
    v_permlane16_swap_b32 v72, v74
    v_permlane16_swap_b32 v73, v75
    s_mov_b32 exec_lo, 0xff
    s_mov_b32 exec_hi, 0xff
    global_store_dwordx4 v171, v[72:75], s[48:49] sc1
    v_bitop3_b32 v68, v72, v73, v74 bitop3:0x96
    v_bitop3_b32 v68, v68, v75, s64 bitop3:0x96
    global_store_dword v188, v68, s[48:49] sc1
    s_mov_b64 exec, -1
    s_cmp_lg_u32 s22, 0
    s_cbranch_scc1 L_hn_45
    s_lshl_b32 s64, s73, 9
    s_add_u32 s64, s64, s71
    v_mov_b32 v58, s64
    v_mov_b32 v59, s24
    s_mov_b64 exec, 1
    global_store_dword v58, v59, s[20:21] sc1
    s_mov_b64 exec, -1
L_hn_45:
L_gfin_44:
    s_add_u32 s73, s73, 1
    s_add_u32 s51, s51, 128
    s_cmp_lt_u32 s73, 2
    s_cbranch_scc1 L_Gloop
    s_branch L_end
L_C:
    v_and_b32 v1, 63, v0
    v_lshrrev_b32 v8, 6, v0
    v_lshrrev_b32 v2, 4, v1
    v_readfirstlane_b32 s22, v8
    v_and_b32 v3, 15, v0
    v_mov_b32 v4, 0x00030003
    s_mov_b32 s30, 0x00020002
    s_mov_b32 s82, 0x42000000
    s_and_b32 s23, s2, 127
    s_getpc_b64 s[34:35]
    s_add_u32 s34, s34, dft_tbl@rel32@lo+4
    s_addc_u32 s35, s35, dft_tbl@rel32@hi+12
    s_cmp_lg_u32 s22, 7
    s_cbranch_scc1 L_pf_46
    s_getpc_b64 s[84:85]
    s_add_u32 s84, s84, interleave_layers__spectral_fnet__moe_arch_mod__prompt_kernel@rel32@lo+4
    s_addc_u32 s85, s85, interleave_layers__spectral_fnet__moe_arch_mod__prompt_kernel@rel32@hi+12
    s_lshr_b32 s64, s2, 3
    s_mul_i32 s64, s64, 6
    v_min_u32 v8, 5, v1
    v_add_u32 v8, s64, v8
    v_min_u32 v8, 179, v8
    v_lshlrev_b32 v8, 7, v8
    global_load_dword v8, v8, s[84:85]
    s_nop 0
L_pf_46:
    s_and_b32 s64, s23, 7
    s_lshr_b32 s65, s23, 3
    s_sub_u32 s50, s23, 64
    s_mov_b32 s71, s64
    s_add_u32 s72, s65, 8
    s_add_u32 s51, s50, 84
    s_lshl_b32 s51, s51, 9
    s_add_u32 s51, s51, 0x1000
    s_waitcnt lgkmcnt(0)
    s_load_dword s25, s[20:21], 0
    s_sub_u32 s65, s65, 8
    s_lshl_b32 s65, s65, 3
    s_add_u32 s65, s65, s22
    s_mul_i32 s64, s65, 1152
    v_min_u32 v53, 8, v1
    v_lshl_add_u32 v53, v53, 7, s64
    global_load_dword v116, v53, s[34:35]
    s_waitcnt lgkmcnt(0)
    s_and_b32 s64, s25, 0xffff
    s_lshr_b32 s65, s25, 16
    s_add_u32 s24, s64, 1
    s_and_b32 s24, s24, 0xbfff
    s_add_u32 s66, s64, 2
    s_and_b32 s66, s66, 0xbfff
    s_cmp_eq_u32 s24, s65
    s_cselect_b32 s24, s66, s24
    s_lshl_b32 s83, s24, 16
    s_bfe_u32 s64, s24, 0x20000
    s_bfe_u32 s65, s24, 0x20002
    s_lshl_b32 s65, s65, 16
    s_or_b32 s26, s64, s65
    s_bfe_u32 s64, s24, 0x20004
    s_bfe_u32 s65, s24, 0x20006
    s_lshl_b32 s65, s65, 16
    s_or_b32 s27, s64, s65
    s_bfe_u32 s64, s24, 0x20008
    s_bfe_u32 s65, s24, 0x2000a
    s_lshl_b32 s65, s65, 16
    s_or_b32 s28, s64, s65
    s_xor_b32 s29, s26, 0x00030003
    s_mul_i32 s64, s71, 21
    s_add_u32 s64, s64, s72
    s_lshl_b32 s64, s64, 14
    v_lshl_add_u32 v44, v0, 4, s64
    v_bfe_u32 v52, v0, 2, 1
    v_mul_u32_u24 v45, 8256, v52
    v_bfe_u32 v52, v0, 3, 1
    v_lshl_add_u32 v45, v52, 12, v45
    v_lshrrev_b32 v52, 4, v0
    v_lshl_add_u32 v45, v52, 6, v45
    v_and_b32 v52, 3, v0
    v_lshl_add_u32 v45, v52, 4, v45
    s_lshr_b32 s65, s22, 2
    s_and_b32 s66, s22, 3
    s_mul_i32 s64, s65, 8256
    v_lshrrev_b32 v52, 1, v2
    v_lshlrev_b32 v53, 9, v52
    v_lshrrev_b32 v54, 2, v3
    v_lshl_add_u32 v53, v54, 6, v53
    v_and_b32 v54, 3, v3
    v_lshl_add_u32 v53, v54, 4, v53
    v_and_b32 v55, 1, v2
    v_lshl_add_u32 v53, v55, 3, v53
    v_add_u32 v46, s64, v53
    s_lshl_b32 s65, s65, 3
    s_add_u32 s65, s65, s71
    s_lshl_b32 s66, s66, 1
    v_lshrrev_b32 v53, 3, v3
    v_add_u32 v53, s66, v53
    v_and_b32 v54, 7, v3
    v_lshl_add_u32 v56, v53, 4, s65
    v_mul_u32_u24 v47, 20480, v56
    s_lshl_b32 s64, s72, 9
    v_lshl_add_u32 v57, v2, 7, s64
    v_lshl_add_u32 v57, v54, 4, v57
    v_add_u32 v47, v47, v57
    v_lshl_add_u32 v56, v54, 7, v56
    v_sub_u32 v57, 0, v56
    v_and_b32 v57, 0x3ff, v57
    v_and_b32 v53, 127, v57
    v_mul_u32_u24 v48, 20480, v53
    v_lshrrev_b32 v57, 7, v57
    v_lshl_add_u32 v48, v57, 4, v48
    s_sub_u32 s64, 40, s72
    s_lshl_b32 s64, s64, 9
    s_add_u32 s64, s64, 384
    v_lshlrev_b32 v57, 7, v2
    v_sub_u32 v57, s64, v57
    v_add_u32 v48, v48, v57
    v_cmp_eq_u32 s[74:75], 0, v56
    v_cvt_f32_u32 v57, v56
    v_mul_f32 v57, 0x3a000000, v57
    v_cvt_f32_u32 v52, v52
    v_cvt_f32_u32 v55, v55
    v_mul_f32 v52, 0x41800000, v52
    v_mul_f32 v55, 0xbe800000, v55
    v_fma_f32 v56, v52, v57, v55
    v_cos_f32 v54, v57
    v_mul_f32 v53, 0x42000000, v57
    v_add_f32 v54, v54, v54
    v_add_f32 v55, v56, v57
    v_cos_f32 v60, v56
    v_cos_f32 v61, v55
    v_add_f32 v56, v56, v53
    v_add_f32 v55, v56, v57
    v_cos_f32 v76, v56
    v_cos_f32 v77, v55
    v_add_f32 v56, v56, v53
    v_fma_f32 v62, v54, v61, -v60
    v_fma_f32 v78, v54, v77, -v76
    v_fma_f32 v63, v54, v62, -v61
    v_fma_f32 v79, v54, v78, -v77
    v_cvt_pk_f16_f32 v12, v60, v62
    v_cvt_pk_f16_f32 v28, v61, v63
    v_cvt_pk_f16_f32 v16, v76, v78
    v_cvt_pk_f16_f32 v32, v77, v79
    v_fma_f32 v64, v54, v63, -v62
    v_fma_f32 v80, v54, v79, -v78
    v_fma_f32 v65, v54, v64, -v63
    v_fma_f32 v81, v54, v80, -v79
    v_fma_f32 v66, v54, v65, -v64
    v_fma_f32 v82, v54, v81, -v80
    v_fma_f32 v67, v54, v66, -v65
    v_fma_f32 v83, v54, v82, -v81
    v_cvt_pk_f16_f32 v13, v64, v66
    v_cvt_pk_f16_f32 v29, v65, v67
    v_cvt_pk_f16_f32 v17, v80, v82
    v_cvt_pk_f16_f32 v33, v81, v83
    v_fma_f32 v68, v54, v67, -v66
    v_fma_f32 v84, v54, v83, -v82
    v_fma_f32 v69, v54, v68, -v67
    v_fma_f32 v85, v54, v84, -v83
    v_fma_f32 v70, v54, v69, -v68
    v_fma_f32 v86, v54, v85, -v84
    v_fma_f32 v71, v54, v70, -v69
    v_fma_f32 v87, v54, v86, -v85
    v_cvt_pk_f16_f32 v14, v68, v70
    v_cvt_pk_f16_f32 v30, v69, v71
    v_cvt_pk_f16_f32 v18, v84, v86
    v_cvt_pk_f16_f32 v34, v85, v87
    v_fma_f32 v72, v54, v71, -v70
    v_fma_f32 v88, v54, v87, -v86
    v_fma_f32 v73, v54, v72, -v71
    v_fma_f32 v89, v54, v88, -v87
    v_fma_f32 v74, v54, v73, -v72
    v_fma_f32 v90, v54, v89, -v88
    v_fma_f32 v75, v54, v74, -v73
    v_fma_f32 v91, v54, v90, -v89
    v_cvt_pk_f16_f32 v15, v72, v74
    v_cvt_pk_f16_f32 v31, v73, v75
    v_cvt_pk_f16_f32 v19, v88, v90
    v_cvt_pk_f16_f32 v35, v89, v91
    v_add_f32 v55, v56, v57
    v_cos_f32 v60, v56
    v_cos_f32 v61, v55
    v_add_f32 v56, v56, v53
    v_add_f32 v55, v56, v57
    v_cos_f32 v76, v56
    v_cos_f32 v77, v55
    v_add_f32 v56, v56, v53
    v_fma_f32 v62, v54, v61, -v60
    v_fma_f32 v78, v54, v77, -v76
    v_fma_f32 v63, v54, v62, -v61
    v_fma_f32 v79, v54, v78, -v77
    v_cvt_pk_f16_f32 v20, v60, v62
    v_cvt_pk_f16_f32 v36, v61, v63
    v_cvt_pk_f16_f32 v24, v76, v78
    v_cvt_pk_f16_f32 v40, v77, v79
    v_fma_f32 v64, v54, v63, -v62
    v_fma_f32 v80, v54, v79, -v78
    v_fma_f32 v65, v54, v64, -v63
    v_fma_f32 v81, v54, v80, -v79
    v_fma_f32 v66, v54, v65, -v64
    v_fma_f32 v82, v54, v81, -v80
    v_fma_f32 v67, v54, v66, -v65
    v_fma_f32 v83, v54, v82, -v81
    v_cvt_pk_f16_f32 v21, v64, v66
    v_cvt_pk_f16_f32 v37, v65, v67
    v_cvt_pk_f16_f32 v25, v80, v82
    v_cvt_pk_f16_f32 v41, v81, v83
    v_fma_f32 v68, v54, v67, -v66
    v_fma_f32 v84, v54, v83, -v82
    v_fma_f32 v69, v54, v68, -v67
    v_fma_f32 v85, v54, v84, -v83
    v_fma_f32 v70, v54, v69, -v68
    v_fma_f32 v86, v54, v85, -v84
    v_fma_f32 v71, v54, v70, -v69
    v_fma_f32 v87, v54, v86, -v85
    v_cvt_pk_f16_f32 v22, v68, v70
    v_cvt_pk_f16_f32 v38, v69, v71
    v_cvt_pk_f16_f32 v26, v84, v86
    v_cvt_pk_f16_f32 v42, v85, v87
    v_fma_f32 v72, v54, v71, -v70
    v_fma_f32 v88, v54, v87, -v86
    v_fma_f32 v73, v54, v72, -v71
    v_fma_f32 v89, v54, v88, -v87
    v_fma_f32 v74, v54, v73, -v72
    v_fma_f32 v90, v54, v89, -v88
    v_fma_f32 v75, v54, v74, -v73
    v_fma_f32 v91, v54, v90, -v89
    v_cvt_pk_f16_f32 v23, v72, v74
    v_cvt_pk_f16_f32 v39, v73, v75
    v_cvt_pk_f16_f32 v27, v88, v90
    v_cvt_pk_f16_f32 v43, v89, v91
    s_add_u32 s38, s20, 0x100000
    s_addc_u32 s39, s21, 0
    s_add_u32 s40, s20, 0x700000
    s_addc_u32 s41, s21, 0
    s_mov_b32 s73, 0
    s_cmp_lg_u32 s22, 0
    s_cbranch_scc1 L_wm_47
    v_mov_b32 v52, s51
    s_mov_b32 s70, 20000
    s_nop 0
L_wt_48:
    global_load_dword v53, v52, s[20:21] offset:0 sc1
    s_waitcnt vmcnt(0)
    v_and_b32 v53, 0xffff, v53
    v_cmp_ne_u32 vcc, s24, v53
    s_cbranch_vccz L_wm_47
    s_sleep 1
    s_sub_u32 s70, s70, 1
    s_cmp_lg_u32 s70, 0
    s_cbranch_scc1 L_wt_48
L_wm_47:
    s_barrier
    s_call_b64 s[36:37], L_cola
    s_call_b64 s[36:37], L_colb
    s_add_u32 s38, s20, 0x400000
    s_addc_u32 s39, s21, 0
    s_add_u32 s40, s20, 0xa00000
    s_addc_u32 s41, s21, 0
    s_add_u32 s51, s51, 384
    s_mov_b32 s73, 1
    s_cmp_lg_u32 s22, 0
    s_cbranch_scc1 L_wm_49
    v_mov_b32 v52, s51
    s_mov_b32 s70, 20000
    s_nop 0
L_wt_50:
    global_load_dword v53, v52, s[20:21] offset:0 sc1
    s_waitcnt vmcnt(0)
    v_and_b32 v53, 0xffff, v53
    v_cmp_ne_u32 vcc, s24, v53
    s_cbranch_vccz L_wm_49
    s_sleep 1
    s_sub_u32 s70, s70, 1
    s_cmp_lg_u32 s70, 0
    s_cbranch_scc1 L_wt_50
L_wm_49:
    s_barrier
    s_call_b64 s[36:37], L_cola
    s_call_b64 s[36:37], L_colb
    s_branch L_end
L_D:
    s_lshl_b32 s50, s64, 1
    s_add_u32 s50, s50, s65
    s_sub_u32 s50, s50, 13
    s_add_u32 s66, s64, 16
    s_cmp_eq_u32 s65, 15
    s_cselect_b32 s50, s66, s50
    s_sub_u32 s67, s50, 10
    s_cmp_ge_u32 s50, 20
    s_cbranch_scc1 L_idle
    v_mov_b32 v192, 0
    v_lshrrev_b32 v52, 2, v0
    v_mul_u32_u24 v52, 1280, v52
    v_and_b32 v53, 3, v0
    v_lshl_add_u32 v52, v53, 4, v52
    s_lshl_b32 s67, s50, 6
    v_add_u32 v52, s67, v52
    s_waitcnt lgkmcnt(0)
    s_load_dword s25, s[20:21], 0
    s_mov_b32 s60, s14
    s_and_b32 s61, s15, 0xffff
    s_mov_b32 s62, 2211840
    s_mov_b32 s63, 0x00020000
    s_mov_b32 s64, 0
    buffer_load_dwordx4 v[116:119], v52, s[60:63], s64 offen
    s_mov_b32 s64, 163840
    buffer_load_dwordx4 v[120:123], v52, s[60:63], s64 offen
    s_mov_b32 s64, 327680
    buffer_load_dwordx4 v[124:127], v52, s[60:63], s64 offen
    s_mov_b32 s64, 491520
    buffer_load_dwordx4 v[128:131], v52, s[60:63], s64 offen
    s_mov_b32 s64, 655360
    buffer_load_dwordx4 v[132:135], v52, s[60:63], s64 offen
    s_mov_b32 s64, 819200
    buffer_load_dwordx4 v[136:139], v52, s[60:63], s64 offen
    s_mov_b32 s64, 983040
    buffer_load_dwordx4 v[140:143], v52, s[60:63], s64 offen
    s_mov_b32 s64, 1146880
    buffer_load_dwordx4 v[144:147], v52, s[60:63], s64 offen
    s_mov_b32 s64, 1310720
    buffer_load_dwordx4 v[148:151], v52, s[60:63], s64 offen
    s_mov_b32 s64, 1474560
    buffer_load_dwordx4 v[152:155], v52, s[60:63], s64 offen
    s_mov_b32 s64, 1638400
    buffer_load_dwordx4 v[156:159], v52, s[60:63], s64 offen
    s_mov_b32 s64, 1802240
    buffer_load_dwordx4 v[160:163], v52, s[60:63], s64 offen
    s_mov_b32 s64, 1966080
    buffer_load_dwordx4 v[164:167], v52, s[60:63], s64 offen
    s_mov_b32 s64, 2129920
    buffer_load_dwordx4 v[168:171], v52, s[60:63], s64 offen
    v_and_b32 v1, 63, v0
    v_lshrrev_b32 v8, 6, v0
    v_lshrrev_b32 v2, 4, v1
    v_readfirstlane_b32 s22, v8
    v_and_b32 v3, 15, v0
    v_mov_b32 v4, 0x00030003
    s_mov_b32 s30, 0x00020002
    s_mov_b32 s82, 0x42000000
    s_and_b32 s23, s2, 127
    s_getpc_b64 s[34:35]
    s_add_u32 s34, s34, dft_tbl@rel32@lo+4
    s_addc_u32 s35, s35, dft_tbl@rel32@hi+12
    s_cmp_lg_u32 s22, 7
    s_cbranch_scc1 L_pf_51
    s_getpc_b64 s[84:85]
    s_add_u32 s84, s84, interleave_layers__spectral_fnet__moe_arch_mod__prompt_kernel@rel32@lo+4
    s_addc_u32 s85, s85, interleave_layers__spectral_fnet__moe_arch_mod__prompt_kernel@rel32@hi+12
    s_lshr_b32 s64, s2, 3
    s_mul_i32 s64, s64, 6
    v_min_u32 v8, 5, v1
    v_add_u32 v8, s64, v8
    v_min_u32 v8, 179, v8
    v_lshlrev_b32 v8, 7, v8
    global_load_dword v8, v8, s[84:85]
    s_nop 0
L_pf_51:
    v_lshlrev_b32 v54, 4, v0
    v_add_u32 v55, 65536, v54
    s_min_u32 s65, s22, 3
    s_mul_i32 s64, s22, 3
    s_add_u32 s65, s65, s64
    v_lshrrev_b32 v53, 2, v3
    v_lshl_add_u32 v53, v2, 3, v53
    v_and_b32 v60, 3, v3
    v_lshlrev_b32 v60, 3, v60
    v_lshl_add_u32 v58, v53, 6, v60
    s_lshl_b32 s64, s65, 12
    v_add_u32 v58, s64, v58
    v_lshrrev_b32 v56, 3, v3
    v_lshlrev_b32 v180, 9, v56
    v_lshl_add_u32 v180, v2, 7, v180
    v_and_b32 v57, 7, v3
    v_lshl_add_u32 v180, v57, 4, v180
    s_lshl_b32 s64, s65, 10
    v_add_u32 v180, s64, v180
    v_lshrrev_b32 v199, 2, v180
    v_add_u32 v199, 0x7000, v199
    s_lshl_b32 s64, s22, 11
    v_lshl_add_u32 v181, v1, 4, s64
    s_lshl_b32 s64, s22, 10
    v_lshl_add_u32 v197, v1, 4, s64
    s_lshl_b32 s51, s50, 9
    s_add_u32 s51, s51, 0x21000
    v_min_u32 v198, 0, v2
    s_lshl_b32 s64, s50, 10
    s_add_u32 s64, s64, 0x80000
    v_lshl_add_u32 v198, v198, 7, s64
    s_and_b32 s71, s22, 1
    s_lshl_b32 s64, s50, 1
    s_add_u32 s71, s71, s64
    s_waitcnt lgkmcnt(0)
    s_and_b32 s64, s25, 0xffff
    s_lshr_b32 s65, s25, 16
    s_add_u32 s24, s64, 1
    s_and_b32 s24, s24, 0xbfff
    s_add_u32 s66, s64, 2
    s_and_b32 s66, s66, 0xbfff
    s_cmp_eq_u32 s24, s65
    s_cselect_b32 s24, s66, s24
    s_lshl_b32 s83, s24, 16
    s_bfe_u32 s64, s24, 0x20000
    s_bfe_u32 s65, s24, 0x20002
    s_lshl_b32 s65, s65, 16
    s_or_b32 s26, s64, s65
    s_bfe_u32 s64, s24, 0x20004
    s_bfe_u32 s65, s24, 0x20006
    s_lshl_b32 s65, s65, 16
    s_or_b32 s27, s64, s65
    s_bfe_u32 s64, s24, 0x20008
    s_bfe_u32 s65, s24, 0x2000a
    s_lshl_b32 s65, s65, 16
    s_or_b32 s28, s64, s65
    s_xor_b32 s29, s26, 0x00030003
    s_mul_i32 s65, s71, 205
    s_lshr_b32 s65, s65, 11
    s_mul_i32 s64, s65, 10
    s_sub_u32 s64, s71, s64
    s_lshl_b32 s66, s64, 1
    s_add_u32 s66, s66, 0
    s_mul_i32 s67, s66, 13
    s_lshr_b32 s67, s67, 6
    s_mul_i32 s68, s67, 5
    s_sub_u32 s66, s66, s68
    s_and_b32 s68, s66, 1
    s_lshl_b32 s68, s68, 2
    s_add_u32 s67, s67, s68
    s_bitcmp1_b32 s67, 1
    s_cselect_b32 s86, s27, s26
    s_cselect_b32 s87, s29, s28
    s_bitcmp1_b32 s67, 2
    s_cselect_b32 s86, s87, s86
    s_lshr_b32 s87, s86, 16
    s_bitcmp1_b32 s67, 0
    s_cselect_b32 s86, s87, s86
    s_and_b32 s86, s86, 3
    s_lshl_b32 s67, s67, 1
    s_lshr_b32 s68, s66, 1
    s_lshl_b32 s68, s68, 10
    s_add_u32 s67, s67, s68
    s_cmp_eq_u32 s66, 4
    s_cselect_b32 s85, 5, 6
    s_cselect_b32 s68, 3, 4
    s_lshl_b32 s68, s65, s68
    s_add_u32 s84, s67, s68
    s_lshl_b32 s66, s64, 1
    s_add_u32 s66, s66, 1
    s_mul_i32 s67, s66, 13
    s_lshr_b32 s67, s67, 6
    s_mul_i32 s68, s67, 5
    s_sub_u32 s66, s66, s68
    s_and_b32 s68, s66, 1
    s_lshl_b32 s68, s68, 2
    s_add_u32 s67, s67, s68
    s_bitcmp1_b32 s67, 1
    s_cselect_b32 s90, s27, s26
    s_cselect_b32 s91, s29, s28
    s_bitcmp1_b32 s67, 2
    s_cselect_b32 s90, s91, s90
    s_lshr_b32 s91, s90, 16
    s_bitcmp1_b32 s67, 0
    s_cselect_b32 s90, s91, s90
    s_and_b32 s90, s90, 3
    s_lshl_b32 s67, s67, 1
    s_lshr_b32 s68, s66, 1
    s_lshl_b32 s68, s68, 10
    s_add_u32 s67, s67, s68
    s_cmp_eq_u32 s66, 4
    s_cselect_b32 s89, 5, 6
    s_cselect_b32 s68, 3, 4
    s_lshl_b32 s68, s65, s68
    s_add_u32 s88, s67, s68
    v_cmp_lt_u32 vcc, 1, v2
    v_mov_b32 v193, s84
    v_mov_b32 v60, s88
    v_cndmask_b32 v193, v193, v60, vcc
    v_mov_b32 v194, s85
    v_mov_b32 v60, s89
    v_cndmask_b32 v194, v194, v60, vcc
    v_mov_b32 v195, s86
    v_mov_b32 v60, s90
    v_cndmask_b32 v195, v195, v60, vcc
    v_and_b32 v60, 1, v2
    v_mul_u32_u24 v60, 10240, v60
    v_add_u32 v60, 3840, v60
    v_add_u32 v193, v193, v60
    s_waitcnt vmcnt(13)
    ds_write_b128 v54, v[116:119] offset:0
    s_waitcnt vmcnt(12)
    ds_write_b128 v54, v[120:123] offset:8192
    s_waitcnt vmcnt(11)
    ds_write_b128 v54, v[124:127] offset:16384
    s_waitcnt vmcnt(10)
    ds_write_b128 v54, v[128:131] offset:24576
    s_waitcnt vmcnt(9)
    ds_write_b128 v54, v[132:135] offset:32768
    s_waitcnt vmcnt(8)
    ds_write_b128 v54, v[136:139] offset:40960
    s_waitcnt vmcnt(7)
    ds_write_b128 v54, v[140:143] offset:49152
    s_waitcnt vmcnt(6)
    ds_write_b128 v54, v[144:147] offset:57344
    s_waitcnt vmcnt(5)
    ds_write_b128 v55, v[148:151] offset:0
    s_waitcnt vmcnt(4)
    ds_write_b128 v55, v[152:155] offset:8192
    s_waitcnt vmcnt(3)
    ds_write_b128 v55, v[156:159] offset:16384
    s_waitcnt vmcnt(2)
    ds_write_b128 v55, v[160:163] offset:24576
    s_waitcnt vmcnt(1)
    ds_write_b128 v55, v[164:167] offset:32768
    s_waitcnt vmcnt(0)
    ds_write_b128 v55, v[168:171] offset:40960
    s_waitcnt lgkmcnt(0)
    s_barrier
    ds_read_b64_tr_b16 v[116:117], v58 offset:0
    ds_read_b64_tr_b16 v[118:119], v58 offset:256
    ds_read_b64_tr_b16 v[120:121], v58 offset:2048
    ds_read_b64_tr_b16 v[122:123], v58 offset:2304
    ds_read_b64_tr_b16 v[124:125], v58 offset:4096
    ds_read_b64_tr_b16 v[126:127], v58 offset:4352
    ds_read_b64_tr_b16 v[128:129], v58 offset:6144
    ds_read_b64_tr_b16 v[130:131], v58 offset:6400
    s_waitcnt lgkmcnt(0)
    ds_read_b64_tr_b16 v[132:133], v58 offset:8192
    ds_read_b64_tr_b16 v[134:135], v58 offset:8448
    ds_read_b64_tr_b16 v[136:137], v58 offset:10240
    ds_read_b64_tr_b16 v[138:139], v58 offset:10496
    ds_read_b64_tr_b16 v[140:141], v58 offset:12288
    ds_read_b64_tr_b16 v[142:143], v58 offset:12544
    ds_read_b64_tr_b16 v[144:145], v58 offset:14336
    ds_read_b64_tr_b16 v[146:147], v58 offset:14592
    s_waitcnt lgkmcnt(0)
    ds_read_b64_tr_b16 v[148:149], v58 offset:32
    ds_read_b64_tr_b16 v[150:151], v58 offset:288
    ds_read_b64_tr_b16 v[152:153], v58 offset:2080
    ds_read_b64_tr_b16 v[154:155], v58 offset:2336
    ds_read_b64_tr_b16 v[156:157], v58 offset:4128
    ds_read_b64_tr_b16 v[158:159], v58 offset:4384
    ds_read_b64_tr_b16 v[160:161], v58 offset:6176
    ds_read_b64_tr_b16 v[162:163], v58 offset:6432
    s_waitcnt lgkmcnt(0)
    ds_read_b64_tr_b16 v[164:165], v58 offset:8224
    ds_read_b64_tr_b16 v[166:167], v58 offset:8480
    ds_read_b64_tr_b16 v[168:169], v58 offset:10272
    ds_read_b64_tr_b16 v[170:171], v58 offset:10528
    ds_read_b64_tr_b16 v[172:173], v58 offset:12320
    ds_read_b64_tr_b16 v[174:175], v58 offset:12576
    ds_read_b64_tr_b16 v[176:177], v58 offset:14368
    ds_read_b64_tr_b16 v[178:179], v58 offset:14624
    s_waitcnt lgkmcnt(0)
    s_barrier
    s_mov_b32 s73, 0
L_Dloop:
    s_mul_i32 s65, s73, 0x8000
    s_add_u32 s65, s65, 0x30000
    s_add_u32 s46, s20, s65
    s_addc_u32 s47, s21, 0
    s_mul_i32 s65, s73, 0x10000
    s_add_u32 s65, s65, 0x90000
    s_add_u32 s48, s20, s65
    s_addc_u32 s49, s21, 0
    s_mul_i32 s65, s73, 0x300000
    s_add_u32 s65, s65, 0xd00000
    s_add_u32 s42, s20, s65
    s_addc_u32 s43, s21, 0
    s_cmp_gt_u32 s22, 1
    s_cbranch_scc1 L_dw_52
    v_and_b32 v53, 7, v3
    v_lshl_add_u32 v52, v53, 2, s51
    s_mov_b32 s70, 20000
    s_nop 0
L_rt_53:
    global_load_dword v182, v52, s[20:21] sc1
    s_waitcnt vmcnt(0)
    v_xor_b32 v53, s24, v182
    v_and_b32 v53, 0xffff, v53
    v_cmp_ne_u32 vcc, 0, v53
    s_cbranch_vccz L_rd_54
    s_sleep 1
    s_sub_u32 s70, s70, 1
    s_cmp_lg_u32 s70, 0
    s_cbranch_scc1 L_rt_53
L_rd_54:
    v_bfe_u32 v182, v182, 16, 11
    v_and_b32 v56, 127, v182
    v_lshrrev_b32 v57, 7, v182
    v_lshl_add_u32 v54, v56, 4, v57
    v_lshlrev_b32 v54, 4, v54
    v_mul_u32_u24 v58, 20480, v56
    v_lshlrev_b32 v57, v194, v57
    v_add3_u32 v58, v58, v57, v193
    s_mov_b32 s70, 20000
    s_nop 0
L_rt_55:
    global_load_dwordx4 v[184:187], v54, s[46:47] sc1
    global_load_ushort v60, v58, s[42:43] offset:-3840 sc1
    global_load_ushort v61, v58, s[42:43] offset:-1280 sc1
    global_load_ushort v62, v58, s[42:43] offset:1280 sc1
    global_load_ushort v63, v58, s[42:43] offset:3840 sc1
    s_waitcnt vmcnt(0)
    v_xor_b32 v60, v195, v60
    v_xor_b32 v61, v195, v61
    v_xor_b32 v62, v195, v62
    v_xor_b32 v63, v195, v63
    v_or3_b32 v64, v60, v61, v62
    v_or_b32 v64, v64, v63
    v_and_b32 v64, 3, v64
    v_xor_b32 v65, s24, v184
    v_bitop3_b32 v65, v65, s24, v185 bitop3:0xf6
    v_bitop3_b32 v65, v65, s24, v186 bitop3:0xf6
    v_and_b32 v65, 0xffff, v65
    v_or_b32 v64, v64, v65
    v_cmp_ne_u32 vcc, 0, v64
    s_cbranch_vccz L_rd_56
    s_sub_u32 s70, s70, 1
    s_cmp_lg_u32 s70, 0
    s_cbranch_scc1 L_rt_55
    s_nop 0
L_rd_56:
    v_and_b32 v196, 0xffff0000, v186
    v_mul_f32 v196, 0xbfb8aa3b, v196
    v_exp_f32 v196, v196
    v_and_b32 v56, 0xffff0000, v184
    v_add_f32 v196, 1.0, v196
    v_rcp_f32 v196, v196
    v_and_b32 v57, 0xffff0000, v185
    v_cvt_pk_bf16_f32 v196, v196, v196
    v_and_b32 v196, 0xffff0000, v196
    v_add_f32 v57, 1.0, v57
    v_fma_mix_f32 v188, v60, v57, v56 op_sel:[0,0,0] op_sel_hi:[1,0,0]
    v_fma_mix_f32 v189, v61, v57, v56 op_sel:[0,0,0] op_sel_hi:[1,0,0]
    v_fma_mix_f32 v190, v62, v57, v56 op_sel:[0,0,0] op_sel_hi:[1,0,0]
    v_fma_mix_f32 v191, v63, v57, v56 op_sel:[0,0,0] op_sel_hi:[1,0,0]
    s_lshl_b32 s64, s71, 5
    v_mul_u32_u24 v192, 1280, v182
    v_lshl_add_u32 v192, v2, 3, v192
    v_add_u32 v192, s64, v192
    s_cmp_lg_u32 s73, 0
    s_cbranch_scc1 L_dw_52
    s_lshl_b32 s64, s71, 9
    s_add_u32 s64, s64, 0x50000
    v_and_b32 v56, 1, v2
    v_lshl_add_u32 v192, v56, 8, s64
    v_lshrrev_b32 v56, 1, v2
    v_lshl_add_u32 v192, v56, 7, v192
    v_lshl_add_u32 v192, v3, 4, v192
    s_nop 1
L_dw_52:
    s_cmp_lg_u32 s22, 2
    s_cbranch_scc1 L_wm_57
    s_lshl_b32 s64, s73, 9
    v_add_u32 v52, s64, v198
    s_mov_b32 s70, 20000
    s_nop 0
L_wt_58:
    global_load_dword v53, v52, s[20:21] offset:0 sc1
    s_waitcnt vmcnt(0)
    v_and_b32 v53, 0xffff, v53
    v_cmp_ne_u32 vcc, s24, v53
    s_cbranch_vccz L_wm_57
    s_sleep 1
    s_sub_u32 s70, s70, 1
    s_cmp_lg_u32 s70, 0
    s_cbranch_scc1 L_wt_58
L_wm_57:
    s_barrier
    s_or_b32 s65, s24, s83
    s_mov_b32 s70, 20000
L_rt_59:
    global_load_dwordx4 v[60:63], v180, s[48:49] offset:0 sc1
    global_load_dword v92, v199, s[48:49] offset:0 sc1
    global_load_dwordx4 v[64:67], v180, s[48:49] offset:1024 sc1
    global_load_dword v93, v199, s[48:49] offset:256 sc1
    global_load_dwordx4 v[68:71], v180, s[48:49] offset:2048 sc1
    global_load_dword v94, v199, s[48:49] offset:512 sc1
    s_cmp_gt_u32 s22, 2
    s_cbranch_scc1 L_p4_61
    global_load_dwordx4 v[72:75], v180, s[48:49] offset:3072 sc1
    global_load_dword v95, v199, s[48:49] offset:768 sc1
L_p4_61:
    s_waitcnt vmcnt(0)
    v_mov_b32 v56, 0
    v_bitop3_b32 v92, v92, v60, v61 bitop3:0x96
    v_bitop3_b32 v92, v92, v62, v63 bitop3:0x96
    v_bitop3_b32 v56, v56, s65, v92 bitop3:0xf6
    v_bitop3_b32 v93, v93, v64, v65 bitop3:0x96
    v_bitop3_b32 v93, v93, v66, v67 bitop3:0x96
    v_bitop3_b32 v56, v56, s65, v93 bitop3:0xf6
    v_bitop3_b32 v94, v94, v68, v69 bitop3:0x96
    v_bitop3_b32 v94, v94, v70, v71 bitop3:0x96
    v_bitop3_b32 v56, v56, s65, v94 bitop3:0xf6
    s_cmp_gt_u32 s22, 2
    s_cbranch_scc1 L_p4_62
    v_bitop3_b32 v95, v95, v72, v73 bitop3:0x96
    v_bitop3_b32 v95, v95, v74, v75 bitop3:0x96
    v_bitop3_b32 v56, v56, s65, v95 bitop3:0xf6
    s_nop 1
L_p4_62:
    v_cmp_ne_u32 vcc, 0, v56
    s_cbranch_vccz L_rd_60
    s_sub_u32 s70, s70, 1
    s_cmp_lg_u32 s70, 0
    s_cbranch_scc1 L_rt_59
    s_nop 0
L_rd_60:
L_Dbody:
    v_mfma_f32_16x16x32_bf16 v[76:79], v[116:119], v[60:63], 0
    v_mfma_f32_16x16x32_bf16 v[80:83], v[120:123], v[60:63], 0
    v_mfma_f32_16x16x32_bf16 v[84:87], v[148:151], v[60:63], 0
    v_mfma_f32_16x16x32_bf16 v[88:91], v[152:155], v[60:63], 0
    v_mfma_f32_16x16x32_bf16 v[76:79], v[124:127], v[64:67], v[76:79]
    v_mfma_f32_16x16x32_bf16 v[80:83], v[128:131], v[64:67], v[80:83]
    v_mfma_f32_16x16x32_bf16 v[84:87], v[156:159], v[64:67], v[84:87]
    v_mfma_f32_16x16x32_bf16 v[88:91], v[160:163], v[64:67], v[88:91]
    v_mfma_f32_16x16x32_bf16 v[76:79], v[132:135], v[68:71], v[76:79]
    v_mfma_f32_16x16x32_bf16 v[80:83], v[136:139], v[68:71], v[80:83]
    v_mfma_f32_16x16x32_bf16 v[84:87], v[164:167], v[68:71], v[84:87]
    v_mfma_f32_16x16x32_bf16 v[88:91], v[168:171], v[68:71], v[88:91]
    s_cmp_gt_u32 s22, 2
    s_cbranch_scc1 L_p4_63
    v_mfma_f32_16x16x32_bf16 v[76:79], v[140:143], v[72:75], v[76:79]
    v_mfma_f32_16x16x32_bf16 v[80:83], v[144:147], v[72:75], v[80:83]
    v_mfma_f32_16x16x32_bf16 v[84:87], v[172:175], v[72:75], v[84:87]
    v_mfma_f32_16x16x32_bf16 v[88:91], v[176:179], v[72:75], v[88:91]
    s_nop 7
L_p4_63:
    v_cmp_lt_u32 vcc, 7, v3
    s_nop 1
    v_cndmask_b32 v76, v76, v80, vcc
    v_cndmask_b32 v77, v77, v81, vcc
    v_cndmask_b32 v78, v78, v82, vcc
    v_cndmask_b32 v79, v79, v83, vcc
    ds_write_b128 v181, v[76:79] offset:0
    v_cndmask_b32 v84, v84, v88, vcc
    v_cndmask_b32 v85, v85, v89, vcc
    v_cndmask_b32 v86, v86, v90, vcc
    v_cndmask_b32 v87, v87, v91, vcc
    ds_write_b128 v181, v[84:87] offset:1024
    s_waitcnt lgkmcnt(0)
    s_barrier
    s_cmp_gt_u32 s22, 1
    s_cbranch_scc1 L_dfin_64
    ds_read_b128 v[60:63], v197 offset:0
    ds_read_b128 v[64:67], v197 offset:2048
    ds_read_b128 v[68:71], v197 offset:4096
    ds_read_b128 v[72:75], v197 offset:6144
    ds_read_b128 v[76:79], v197 offset:8192
    ds_read_b128 v[80:83], v197 offset:10240
    ds_read_b128 v[84:87], v197 offset:12288
    ds_read_b128 v[88:91], v197 offset:14336
    s_mov_b32 s76, 0x00ff00ff
    s_mov_b32 s77, 0x00ff00ff
    s_waitcnt lgkmcnt(6)
    v_add_f32 v60, v60, v64
    v_add_f32 v61, v61, v65
    v_add_f32 v62, v62, v66
    v_add_f32 v63, v63, v67
    s_waitcnt lgkmcnt(4)
    v_add_f32 v68, v68, v72
    v_add_f32 v69, v69, v73
    v_add_f32 v70, v70, v74
    v_add_f32 v71, v71, v75
    s_waitcnt lgkmcnt(2)
    v_add_f32 v76, v76, v80
    v_add_f32 v77, v77, v81
    v_add_f32 v78, v78, v82
    v_add_f32 v79, v79, v83
    s_waitcnt lgkmcnt(0)
    v_add_f32 v84, v84, v88
    v_add_f32 v85, v85, v89
    v_add_f32 v86, v86, v90
    v_add_f32 v87, v87, v91
    v_add_f32 v60, v60, v68
    v_add_f32 v76, v76, v84
    v_add_f32 v61, v61, v69
    v_add_f32 v77, v77, v85
    v_add_f32 v62, v62, v70
    v_add_f32 v78, v78, v86
    v_add_f32 v63, v63, v71
    v_add_f32 v79, v79, v87
    v_add_f32 v60, v60, v76
    v_add_f32 v61, v61, v77
    v_add_f32 v62, v62, v78
    v_add_f32 v63, v63, v79
    v_add_f32_dpp v60, v60, v60 row_ror:8 row_mask:0xf bank_mask:0xf
    v_add_f32_dpp v61, v61, v61 row_ror:8 row_mask:0xf bank_mask:0xf
    v_add_f32_dpp v62, v62, v62 row_ror:8 row_mask:0xf bank_mask:0xf
    v_add_f32_dpp v63, v63, v63 row_ror:8 row_mask:0xf bank_mask:0xf
    v_cvt_pk_bf16_f32 v64, v60, v61
    v_cvt_pk_bf16_f32 v66, v62, v63
    v_lshlrev_b32 v60, 16, v64
    v_and_b32 v61, 0xffff0000, v64
    v_lshlrev_b32 v62, 16, v66
    v_and_b32 v63, 0xffff0000, v66
    v_mul_f32 v60, v60, v196
    v_mul_f32 v61, v61, v196
    v_mul_f32 v62, v62, v196
    v_mul_f32 v63, v63, v196
    v_cvt_pk_bf16_f32 v64, v60, v61
    v_cvt_pk_bf16_f32 v66, v62, v63
    v_lshlrev_b32 v60, 16, v64
    v_and_b32 v61, 0xffff0000, v64
    v_lshlrev_b32 v62, 16, v66
    v_and_b32 v63, 0xffff0000, v66
    s_cmp_lt_i32 s73, 0
    s_cbranch_scc1 L_dfin_64
    s_cmp_lg_u32 s73, 0
    s_cbranch_scc1 L_l2_65
    v_permlane32_swap_b32 v60, v62
    v_permlane32_swap_b32 v61, v63
    v_or_b32 v68, s24, v60
    v_or_b32 v69, s24, v62
    v_or_b32 v70, s24, v61
    v_or_b32 v71, s24, v63
    s_mov_b64 exec, s[76:77]
    global_store_dwordx4 v192, v[68:71], s[20:21] sc1
    s_mov_b64 exec, -1
    s_cmp_lg_u32 s22, 0
    s_cbranch_scc1 L_un_66
    s_cmp_lg_u32 s73, 0
    s_cbranch_scc1 L_un_66
    s_add_u32 s64, s50, 10
    s_sub_u32 s65, s50, 10
    s_cmp_lt_u32 s50, 10
    s_cselect_b32 s64, s64, s65
    v_and_b32 v92, 7, v1
    v_mul_u32_u24 v92, 20, v92
    v_mov_b32 v93, s50
    v_mov_b32 v94, s64
    v_cmp_lt_u32 vcc, 7, v1
    s_nop 1
    v_cndmask_b32 v93, v93, v94, vcc
    v_add_u32 v92, v93, v92
    v_lshrrev_b32 v93, 3, v1
    v_cmp_gt_u32 vcc, 128, v92
    v_lshlrev_b32 v92, 9, v92
    v_lshl_add_u32 v92, v93, 7, v92
    v_add_u32 v92, 0x11100, v92
    s_and_b32 vcc_lo, vcc_lo, 255
    s_mov_b32 vcc_hi, 0
    v_mov_b32 v93, s24
    s_mov_b64 exec, vcc
    global_store_dword v92, v93, s[20:21] sc1
    s_mov_b64 exec, -1
L_un_66:
    s_branch L_dfin_64
L_l2_65:
    v_add_f32 v60, v60, v188
    v_add_f32 v61, v61, v189
    v_add_f32 v62, v62, v190
    v_add_f32 v63, v63, v191
    v_cvt_pk_bf16_f32 v64, v60, v61
    v_cvt_pk_bf16_f32 v65, v62, v63
    s_mov_b64 exec, s[76:77]
    global_store_dwordx2 v192, v[64:65], s[16:17]
    s_mov_b64 exec, -1
    s_cmp_lg_u32 s71, 0
    s_cbranch_scc1 L_dfin_64
    s_or_b32 s64, s24, s83
    v_mov_b32 v56, 0
    v_mov_b32 v57, s64
    s_mov_b64 exec, 1
    global_store_dword v56, v57, s[20:21]
    s_mov_b64 exec, -1
L_dfin_64:
    s_add_u32 s73, s73, 1
    s_add_u32 s51, s51, 128
    s_cmp_lt_u32 s73, 2
    s_cbranch_scc1 L_Dloop
    s_branch L_end
L_idle:
    s_mul_i32 s66, s67, 63232
    s_add_u32 s66, s66, 1327104
    s_waitcnt lgkmcnt(0)
    s_mov_b32 s52, s10
    s_and_b32 s53, s11, 0xffff
    s_mov_b32 s54, 2211840
    s_mov_b32 s55, 0x00020000
    s_mov_b32 s56, s12
    s_and_b32 s57, s13, 0xffff
    s_mov_b32 s58, 2211840
    s_mov_b32 s59, 0x00020000
    v_add_u32 v62, 0, v0
    v_min_u32 v62, 493, v62
    v_lshl_add_u32 v62, v62, 7, s66
    buffer_load_dword v64, v62, s[52:55], 0 offen
    buffer_load_dword v65, v62, s[56:59], 0 offen
    s_waitcnt vmcnt(0)
    s_branch L_end2
L_end:
L_end2:
    s_endpgm
L_code_end:
.if (L_code_end-interleave_layers__spectral_fnet__moe_arch_mod__prompt_kernel) < 22916
.error "code prefetch runs past the code"
.endif
.section .rodata,"a"
.p2align 6
.amdhsa_kernel interleave_layers__spectral_fnet__moe_arch_mod__prompt_kernel
  .amdhsa_next_free_vgpr 254
  .amdhsa_next_free_sgpr 102
  .amdhsa_accum_offset 256
  .amdhsa_group_segment_fixed_size 0
  .amdhsa_kernarg_size 104
  .amdhsa_user_sgpr_count 2
  .amdhsa_user_sgpr_kernarg_segment_ptr 1
  .amdhsa_system_sgpr_workgroup_id_x 1
.end_amdhsa_kernel
.section .rodata,"a"
.p2align 10
.type dft_tbl,@object
dft_tbl:
.quad 0x3c003c003c003c00,0x3c003c003c003c00,0x8000800080008000,0x8000800080008000,0x3b213b9c3be73c00,0x374438b439a83a79,0xb744b4f2b1028000,0xbb21ba79b9a8b8b4
.quad 0x38b43a793b9c3c00,0xb8b4b4f2000034f2,0xba79b8b4b4f28000,0xba79bb9cbc00bb9c,0x310238b43b213c00,0xbbe7bb9cb9a8b4f2,0xbbe7ba79b7448000,0x3102b4f2b9a8bb9c
.quad 0xb4f234f23a793c00,0xb4f2ba79bc00ba79,0xbb9cbb9cb8b48000,0x3b9c38b48000b8b4,0xb9a8000039a83c00,0x39a88000b9a8bc00,0xb9a8bc00b9a88000,0x39a83c0039a88000
.quad 0xbb9cb4f238b43c00,0x3b9c3a798000ba79,0xb4f2bb9cba798000,0xb4f238b43c0038b4,0xbbe7b8b437443c00,0x31023b9c39a8b4f2,0x3102ba79bb218000,0xbbe7b4f239a83b9c
.quad 0x3c003c003c003c00,0x3c003c003c003c00,0x8000800080008000,0x8000800080008000,0xb744b4f2b1020000,0xbb21ba79b9a8b8b4,0xbb21bb9cbbe7bc00,0xb744b8b4b9a8ba79
.quad 0xb8b4ba79bb9cbc00,0x38b434f28000b4f2,0x3a7938b434f28000,0x3a793b9c3c003b9c,0x3be73a7937448000,0xb10234f239a83b9c,0x310238b43b213c00,0xbbe7bb9cb9a8b4f2
.quad 0xb4f234f23a793c00,0xb4f2ba79bc00ba79,0xbb9cbb9cb8b48000,0x3b9c38b48000b8b4,0xb9a8bc00b9a80000,0x39a83c0039a88000,0x39a88000b9a8bc00,0xb9a8800039a83c00
.quad 0x3b9c34f2b8b4bc00,0xbb9cba7900003a79,0x34f23b9c3a798000,0x34f2b8b4bc00b8b4,0xb1023a793b218000,0x3be734f2b9a8bb9c,0xbbe7b8b437443c00,0x31023b9c39a8b4f2
.quad 0x3c003c003c003c00,0x3c003c003c003c00,0x8000800080008000,0x8000800080008000,0xbb21bb9cbbe7bc00,0xb744b8b4b9a8ba79,0x374434f231028000,0x3b213a7939a838b4
.quad 0x38b43a793b9c3c00,0xb8b4b4f2000034f2,0xba79b8b4b4f28000,0xba79bb9cbc00bb9c,0xb102b8b4bb21bc00,0x3be73b9c39a834f2,0x3be73a7937448000,0xb10234f239a83b9c
.quad 0xb4f234f23a793c00,0xb4f2ba79bc00ba79,0xbb9cbb9cb8b48000,0x3b9c38b48000b8b4,0x39a88000b9a8bc00,0xb9a8000039a83c00,0x39a83c0039a88000,0xb9a8bc00b9a88000
.quad 0xbb9cb4f238b43c00,0x3b9c3a798000ba79,0xb4f2bb9cba798000,0xb4f238b43c0038b4,0x3be738b4b744bc00,0xb102bb9cb9a834f2,0xb1023a793b218000,0x3be734f2b9a8bb9c
.quad 0x3c003c003c003c00,0x3c003c003c003c00,0x8000800080008000,0x8000800080008000,0x374434f231028000,0x3b213a7939a838b4,0x3b213b9c3be73c00,0x374438b439a83a79
.quad 0xb8b4ba79bb9cbc00,0x38b434f28000b4f2,0x3a7938b434f28000,0x3a793b9c3c003b9c,0xbbe7ba79b7440000,0x3102b4f2b9a8bb9c,0xb102b8b4bb21bc00,0x3be73b9c39a834f2
.quad 0xb4f234f23a793c00,0xb4f2ba79bc00ba79,0xbb9cbb9cb8b48000,0x3b9c38b48000b8b4,0x39a83c0039a88000,0xb9a8bc00b9a80000,0xb9a8800039a83c00,0x39a88000b9a8bc00
.quad 0x3b9c34f2b8b4bc00,0xbb9cba7900003a79,0x34f23b9c3a798000,0x34f2b8b4bc00b8b4,0x3102ba79bb210000,0xbbe7b4f239a83b9c,0x3be738b4b744bc00,0xb102bb9cb9a834f2
.quad 0xba79ba7934f23c00,0xba7934f23c0034f2,0x38b4b8b4bb9c8000,0xb8b4bb9c80003b9c,0xb744bb9c31023c00,0xbb21b8b439a83a79,0x3b21b4f2bbe78000,0x3744ba79b9a838b4
.quad 0x8000bc0000003c00,0x8000bc0000003c00,0x3c008000bc008000,0x3c008000bc008000,0x3744bb9cb1023c00,0x3b21b8b4b9a83a79,0x3b2134f2bbe78000,0x37443a79b9a8b8b4
.quad 0x3a79ba79b4f23c00,0x3a7934f2bc0034f2,0x38b438b4bb9c8000,0xb8b43b9c8000bb9c,0x3be7b8b4b7443c00,0xb1023b9cb9a8b4f2,0x31023a79bb218000,0xbbe734f239a8bb9c
.quad 0x3b9cb4f2b8b43c00,0xbb9c3a798000ba79,0xb4f23b9cba798000,0xb4f2b8b43c00b8b4,0x39a88000b9a83c00,0xb9a8000039a8bc00,0xb9a83c00b9a88000,0x39a8bc0039a88000
.quad 0xba79ba7934f23c00,0xba7934f23c0034f2,0x38b4b8b4bb9c8000,0xb8b4bb9c80003b9c,0x3b21b4f2bbe70000,0x3744ba79b9a838b4,0x37443b9cb102bc00,0x3b2138b4b9a8ba79
.quad 0x3c008000bc00,0x3c008000bc00,0xbc0080003c008000,0xbc0080003c008000,0xbb21b4f23be78000,0xb744ba7939a838b4,0x3744bb9cb1023c00,0x3b21b8b4b9a83a79
.quad 0x3a79ba79b4f23c00,0x3a7934f2bc0034f2,0x38b438b4bb9c8000,0xb8b43b9c8000bb9c,0x31023a79bb210000,0xbbe734f239a8bb9c,0xbbe738b43744bc00,0x3102bb9c39a834f2
.quad 0xbb9c34f238b4bc00,0x3b9cba7900003a79,0x34f2bb9c3a798000,0x34f238b4bc0038b4,0x39a8bc0039a88000,0xb9a83c00b9a80000,0x39a88000b9a83c00,0xb9a8800039a8bc00
.quad 0xba79ba7934f23c00,0xba7934f23c0034f2,0x38b4b8b4bb9c8000,0xb8b4bb9c80003b9c,0x37443b9cb102bc00,0x3b2138b4b9a8ba79,0xbb2134f23be78000,0xb7443a7939a8b8b4
.quad 0x8000bc0000003c00,0x8000bc0000003c00,0x3c008000bc008000,0x3c008000bc008000,0xb7443b9c3102bc00,0xbb2138b439a8ba79,0xbb21b4f23be78000,0xb744ba7939a838b4
.quad 0x3a79ba79b4f23c00,0x3a7934f2bc0034f2,0x38b438b4bb9c8000,0xb8b43b9c8000bb9c,0xbbe738b43744bc00,0x3102bb9c39a834f2,0xb102ba793b218000,0x3be7b4f2b9a83b9c
.quad 0x3b9cb4f2b8b43c00,0xbb9c3a798000ba79,0xb4f23b9cba798000,0xb4f2b8b43c00b8b4,0xb9a8000039a8bc00,0x39a88000b9a83c00,0x39a8bc0039a88000,0xb9a83c00b9a88000
.quad 0xba79ba7934f23c00,0xba7934f23c0034f2,0x38b4b8b4bb9c8000,0xb8b4bb9c80003b9c,0xbb2134f23be78000,0xb7443a7939a8b8b4,0xb744bb9c31023c00,0xbb21b8b439a83a79
.quad 0x3c008000bc00,0x3c008000bc00,0xbc0080003c008000,0xbc0080003c008000,0x3b2134f2bbe70000,0x37443a79b9a8b8b4,0xb7443b9c3102bc00,0xbb2138b439a8ba79
.quad 0x3a79ba79b4f23c00,0x3a7934f2bc0034f2,0x38b438b4bb9c8000,0xb8b43b9c8000bb9c,0xb102ba793b218000,0x3be7b4f2b9a83b9c,0x3be7b8b4b7443c00,0xb1023b9cb9a8b4f2
.quad 0xbb9c34f238b4bc00,0x3b9cba7900003a79,0x34f2bb9c3a798000,0x34f238b4bc0038b4,0xb9a83c00b9a80000,0x39a8bc0039a88000,0xb9a8800039a8bc00,0x39a88000b9a83c00
.quad 0x34f234f2ba793c00,0x34f2ba793c00ba79,0xbb9c3b9cb8b48000,0x3b9cb8b4800038b4,0xb10238b4bb213c00,0x3be7bb9c39a8b4f2,0xbbe73a79b7448000,0x310234f2b9a83b9c
.quad 0xb8b43a79bb9c3c00,0x38b4b4f2000034f2,0xba7938b4b4f28000,0xba793b9cbc003b9c,0xbb213b9cbbe73c00,0xb74438b4b9a83a79,0xb74434f2b1028000,0xbb213a79b9a838b4
.quad 0xbc003c00bc003c00,0xbc003c00bc003c00,0x8000800080008000,0x8000800080008000,0xbb213b9cbbe73c00,0xb74438b4b9a83a79,0x3744b4f231028000,0x3b21ba7939a8b8b4
.quad 0xb8b43a79bb9c3c00,0x38b4b4f2800034f2,0x3a79b8b434f28000,0x3a79bb9c3c00bb9c,0xb10238b4bb213c00,0x3be7bb9c39a8b4f2,0x3be7ba7937448000,0xb102b4f239a8bb9c
.quad 0x34f234f2ba793c00,0x34f2ba793c00ba79,0xbb9c3b9cb8b48000,0x3b9cb8b4800038b4,0xbbe73a79b7440000,0x310234f2b9a83b9c,0x3102b8b43b21bc00,0xbbe73b9cb9a834f2
.quad 0x38b4ba793b9cbc00,0xb8b434f28000b4f2,0x3a79b8b434f28000,0x3a79bb9c3c00bb9c,0x3744b4f231028000,0x3b21ba7939a8b8b4,0xbb213b9cbbe73c00,0xb74438b4b9a83a79
.quad 0xbc003c00bc003c00,0xbc003c00bc003c00,0x8000800080008000,0x8000800080008000,0x3744b4f231020000,0x3b21ba7939a8b8b4,0x3b21bb9c3be7bc00,0x3744b8b439a8ba79
.quad 0x38b4ba793b9cbc00,0xb8b434f20000b4f2,0xba7938b4b4f28000,0xba793b9cbc003b9c,0xbbe73a79b7448000,0x310234f2b9a83b9c,0xb10238b4bb213c00,0x3be7bb9c39a8b4f2
.quad 0x34f234f2ba793c00,0x34f2ba793c00ba79,0xbb9c3b9cb8b48000,0x3b9cb8b4800038b4,0x3102b8b43b21bc00,0xbbe73b9cb9a834f2,0x3be7ba7937448000,0xb102b4f239a8bb9c
.quad 0xb8b43a79bb9c3c00,0x38b4b4f2000034f2,0xba7938b4b4f28000,0xba793b9cbc003b9c,0x3b21bb9c3be7bc00,0x3744b8b439a8ba79,0x3744b4f231028000,0x3b21ba7939a8b8b4
.quad 0xbc003c00bc003c00,0xbc003c00bc003c00,0x8000800080008000,0x8000800080008000,0x3b21bb9c3be7bc00,0x3744b8b439a8ba79,0xb74434f2b1028000,0xbb213a79b9a838b4
.quad 0xb8b43a79bb9c3c00,0x38b4b4f2800034f2,0x3a79b8b434f28000,0x3a79bb9c3c00bb9c,0x3102b8b43b21bc00,0xbbe73b9cb9a834f2,0xbbe73a79b7448000,0x310234f2b9a83b9c
.quad 0x34f234f2ba793c00,0x34f2ba793c00ba79,0xbb9c3b9cb8b48000,0x3b9cb8b4800038b4,0x3be7ba7937448000,0xb102b4f239a8bb9c,0xb10238b4bb213c00,0x3be7bb9c39a8b4f2
.quad 0x38b4ba793b9cbc00,0xb8b434f28000b4f2,0x3a79b8b434f28000,0x3a79bb9c3c00bb9c,0xb74434f2b1020000,0xbb213a79b9a838b4,0x3b21bb9c3be7bc00,0x3744b8b439a8ba79
.quad 0xbc003c00bc003c00,0xbc003c00bc003c00,0x8000800080008000,0x8000800080008000,0xb74434f2b1028000,0xbb213a79b9a838b4,0xbb213b9cbbe73c00,0xb74438b4b9a83a79
.quad 0x38b4ba793b9cbc00,0xb8b434f20000b4f2,0xba7938b4b4f28000,0xba793b9cbc003b9c,0x3be7ba7937440000,0xb102b4f239a8bb9c,0x3102b8b43b21bc00,0xbbe73b9cb9a834f2
.quad 0x3c003c00,0x34f2ba79,0x80008000,0x3b9c38b4,0x310234f2,0x3be734f2,0xbbe7bb9c,0xb1023b9c
.quad 0xbb9cba79,0x3c00,0xb4f2b8b4,0xbc008000,0xb744ba79,0xbbe734f2,0x3b2138b4,0xb102bb9c
.quad 0x3a7934f2,0xb4f2ba79,0x38b43b9c,0x3b9cb8b4,0x39a83c00,0x3b21ba79,0xb9a88000,0x374438b4
.quad 0xb8b434f2,0x38b434f2,0xba79bb9c,0xba793b9c,0xbb21ba79,0xb9a83c00,0x3744b8b4,0xb9a88000
.quad 0x3c003c00,0x34f2ba79,0x80008000,0x3b9c38b4,0xbbe7bb9c,0xb1023b9c,0xb102b4f2,0xbbe7b4f2
.quad 0x3b9c3a79,0x8000bc00,0x34f238b4,0x3c008000,0xbb21b8b4,0x31023b9c,0xb744ba79,0xbbe734f2
.quad 0x3a7934f2,0xb4f2ba79,0x38b43b9c,0x3b9cb8b4,0xb9a80000,0x374438b4,0xb9a8bc00,0xbb213a79
.quad 0x38b4b4f2,0xb8b4b4f2,0x3a793b9c,0x3a79bb9c,0xb74438b4,0x39a88000,0xbb21ba79,0xb9a83c00
.quad 0x3c003c00,0x34f2ba79,0x80008000,0x3b9c38b4,0xb102b4f2,0xbbe7b4f2,0x3be73b9c,0x3102bb9c
.quad 0xbb9cba79,0x3c00,0xb4f2b8b4,0xbc008000,0x37443a79,0x3be7b4f2,0xbb21b8b4,0x31023b9c
.quad 0x3a7934f2,0xb4f2ba79,0x38b43b9c,0x3b9cb8b4,0xb9a8bc00,0xbb213a79,0x39a88000,0xb744b8b4
.quad 0xb8b434f2,0x38b434f2,0xba79bb9c,0xba793b9c,0x3b213a79,0x39a8bc00,0xb74438b4,0x39a88000
.quad 0x3c003c00,0x34f2ba79,0x80008000,0x3b9c38b4,0x3be73b9c,0x3102bb9c,0x310234f2,0x3be734f2
.quad 0x3b9c3a79,0x8000bc00,0x34f238b4,0x3c008000,0x3b2138b4,0xb102bb9c,0x37443a79,0x3be7b4f2
.quad 0x3a7934f2,0xb4f2ba79,0x38b43b9c,0x3b9cb8b4,0x39a88000,0xb744b8b4,0x39a83c00,0x3b21ba79
.quad 0x38b4b4f2,0xb8b4b4f2,0x3a793b9c,0x3a79bb9c,0x3744b8b4,0xb9a80000,0x3b213a79,0x39a8bc00
.quad 0xba7934f2,0x0,0x38b4bb9c,0x0,0x3744ba79,0x0,0x3b21b8b4,0x0
.quad 0x3b9cba79,0x0,0xb4f238b4,0x0,0xb10234f2,0x0,0xbbe73b9c,0x0
.quad 0xbc003c00,0x0,0x80008000,0x0,0xb10234f2,0x0,0x3be7bb9c,0x0
.quad 0x3b9cba79,0x0,0x34f2b8b4,0x0,0x3744ba79,0x0,0xbb2138b4,0x0
.quad 0xba7934f2,0x0,0x38b4bb9c,0x0,0x3b21b8b4,0x0,0xb7443a79,0x0
.quad 0xbb9c3a79,0x0,0x34f2b8b4,0x0,0x3be7bb9c,0x0,0xb10234f2,0x0
.quad 0xbc003c00,0x0,0x80008000,0x0,0x3be7bb9c,0x0,0x3102b4f2,0x0
.quad 0xbb9c3a79,0x0,0xb4f238b4,0x0,0x3b21b8b4,0x0,0x3744ba79,0x0
.quad 0xba7934f2,0x0,0x38b4bb9c,0x0,0xb7443a79,0x0,0xbb2138b4,0x0
.quad 0x3b9cba79,0x0,0xb4f238b4,0x0,0x3102b4f2,0x0,0x3be7bb9c,0x0
.quad 0xbc003c00,0x0,0x80008000,0x0,0x3102b4f2,0x0,0xbbe73b9c,0x0
.quad 0x3b9cba79,0x0,0x34f2b8b4,0x0,0xb7443a79,0x0,0x3b21b8b4,0x0
.quad 0xba7934f2,0x0,0x38b4bb9c,0x0,0xbb2138b4,0x0,0x3744ba79,0x0
.quad 0xbb9c3a79,0x0,0x34f2b8b4,0x0,0xbbe73b9c,0x0,0x3102b4f2,0x0
.quad 0xbc003c00,0x0,0x80008000,0x0,0xbbe73b9c,0x0,0xb10234f2,0x0
.quad 0xbb9c3a79,0x0,0xb4f238b4,0x0,0xbb2138b4,0x0,0xb7443a79,0x0
.quad 0x2800280028002800,0x0,0x221f25a827642800,0x276425a8221f0000,0xa5a8000025a82800,0x25a8280025a80000,0xa764a5a8221f2800,0xa21f25a827640000
.quad 0x8000a80000002800,0xa800000028000000,0x2764a5a8a21f2800,0xa21fa5a827640000,0x25a88000a5a82800,0x25a8a80025a80000,0xa21f25a8a7642800,0x2764a5a8221f0000
.quad 0xa8002800a8002800,0x0,0xa21f25a8a7642800,0xa76425a8a21f0000,0x25a80000a5a82800,0xa5a82800a5a80000,0x2764a5a8a21f2800,0x221f25a8a7640000
.quad 0xa80080002800,0x28000000a8000000,0xa764a5a8221f2800,0x221fa5a8a7640000,0xa5a8800025a82800,0xa5a8a800a5a80000,0x221f25a827642800,0xa764a5a8a21f0000
.quad 0x2800280028002800,0x0,0xa764a5a8a21f0000,0x221f25a827642800,0x25a88000a5a8a800,0xa5a8a800a5a80000,0xa21f25a827648000,0x276425a8a21fa800
.quad 0x8000a80000002800,0xa800000028000000,0x221f25a8a7640000,0x2764a5a8a21f2800,0xa5a8000025a8a800,0xa5a82800a5a80000,0x2764a5a8221f8000,0x221fa5a82764a800
.quad 0xa8002800a8002800,0x0,0x2764a5a8221f0000,0xa21f25a8a7642800,0xa5a8800025a8a800,0x25a8a80025a80000,0x221f25a8a7648000,0xa76425a8221fa800
.quad 0xa80080002800,0x28000000a8000000,0xa21f25a827640000,0xa764a5a8221f2800,0x25a80000a5a8a800,0x25a8280025a80000,0xa764a5a8a21f8000,0xa21fa5a8a764a800
.quad 0x2800280028002800,0x0,0xa21fa5a8a764a800,0xa764a5a8a21f0000,0xa5a8000025a82800,0x25a8280025a80000,0x276425a8a21fa800,0x221fa5a8a7640000
.quad 0x8000a80000002800,0xa800000028000000,0xa76425a8221fa800,0x221f25a8a7640000,0x25a88000a5a82800,0x25a8a80025a80000,0x221fa5a82764a800,0xa76425a8a21f0000
.quad 0xa8002800a8002800,0x0,0x221fa5a82764a800,0x2764a5a8221f0000,0x25a80000a5a82800,0xa5a82800a5a80000,0xa76425a8221fa800,0xa21fa5a827640000
.quad 0xa80080002800,0x28000000a8000000,0x276425a8a21fa800,0xa21f25a827640000,0xa5a8800025a82800,0xa5a8a800a5a80000,0xa21fa5a8a764a800,0x276425a8221f0000
.quad 0x2800280028002800,0x0,0x276425a8221f8000,0xa21fa5a8a764a800,0x25a88000a5a8a800,0xa5a8a800a5a80000,0x221fa5a8a7640000,0xa764a5a8221f2800
.quad 0x8000a80000002800,0xa800000028000000,0xa21fa5a827648000,0xa76425a8221fa800,0xa5a8000025a8a800,0xa5a82800a5a80000,0xa76425a8a21f0000,0xa21f25a8a7642800
.quad 0xa8002800a8002800,0x0,0xa76425a8a21f8000,0x221fa5a82764a800,0xa5a8800025a8a800,0x25a8a80025a80000,0xa21fa5a827640000,0x2764a5a8a21f2800
.quad 0xa80080002800,0x28000000a8000000,0x221fa5a8a7648000,0x276425a8a21fa800,0x25a80000a5a8a800,0x25a8280025a80000,0x276425a8221f0000,0x221f25a827642800
.quad 0x3c0000003c00,0x3c0000003c00,0xbc0000003c00,0xb61fbb64361f3b64,0x3c0000003c00,0x39a839a839a839a8,0xbc0000003c00,0xbb64b61f3b64361f
.quad 0x3c0000003c00,0x3c0000003c000000,0xbc0000003c00,0xbb64361f3b64b61f,0x3c0000003c00,0x39a8b9a839a8b9a8,0xbc0000003c00,0xb61f3b64361fbb64
.quad 0x3c0000003c00,0xbc000000bc00,0xbc0000003c00,0x361f3b64b61fbb64,0x3c0000003c00,0xb9a8b9a8b9a8b9a8,0xbc0000003c00,0x3b64361fbb64b61f
.quad 0x3c0000003c00,0xbc008000bc008000,0xbc0000003c00,0x3b64b61fbb64361f,0x3c0000003c00,0xb9a839a8b9a839a8,0xbc0000003c00,0x361fbb64b61f3b64
.quad 0x3c0000003c00,0x3c0000003c00,0xb9a8b9a839a839a8,0xbb64b61f3b64361f,0x3c0000003c000000,0x39a8b9a839a8b9a8,0xb9a839a839a8b9a8,0x361f3b64b61fbb64
.quad 0xbc000000bc00,0xbc008000bc008000,0x39a839a8b9a8b9a8,0x361fbb64b61f3b64,0xbc008000bc008000,0x39a839a839a839a8,0x39a8b9a8b9a839a8,0xbb64361f3b64b61f
.quad 0x3c0000003c00,0xbc000000bc00,0xb9a8b9a839a839a8,0x3b64361fbb64b61f,0x3c0000003c000000,0xb9a839a8b9a839a8,0xb9a839a839a8b9a8,0xb61fbb64361f3b64
.quad 0xbc000000bc00,0x3c0000003c000000,0x39a839a8b9a8b9a8,0xb61f3b64361fbb64,0xbc008000bc008000,0xb9a8b9a8b9a8b9a8,0x39a8b9a8b9a839a8,0x3b64b61fbb64361f
.quad 0x3c0000003c00,0x3c0000003c00,0xbc0080003c000000,0xbb64361f3b64b61f,0xbc000000bc00,0xb9a8b9a8b9a8b9a8,0x3c000000bc008000,0x361fbb64b61f3b64
.quad 0x3c0000003c00,0x3c0000003c000000,0xbc0080003c000000,0x361f3b64b61fbb64,0xbc000000bc00,0xb9a839a8b9a839a8,0x3c000000bc008000,0xbb64b61f3b64361f
.quad 0x3c0000003c00,0xbc000000bc00,0xbc0080003c000000,0x3b64b61fbb64361f,0xbc000000bc00,0x39a839a839a839a8,0x3c000000bc008000,0xb61f3b64361fbb64
.quad 0x3c0000003c00,0xbc008000bc008000,0xbc0080003c000000,0xb61fbb64361f3b64,0xbc000000bc00,0x39a8b9a839a8b9a8,0x3c000000bc008000,0x3b64361fbb64b61f
.quad 0x3c0000003c00,0x3c0000003c00,0xb9a839a839a8b9a8,0xb61f3b64361fbb64,0xbc008000bc008000,0xb9a839a8b9a839a8,0xb9a8b9a839a839a8,0xbb64361f3b64b61f
.quad 0xbc000000bc00,0xbc008000bc008000,0x39a8b9a8b9a839a8,0xbb64b61f3b64361f,0x3c0000003c000000,0xb9a8b9a8b9a8b9a8,0x39a839a8b9a8b9a8,0xb61fbb64361f3b64
.quad 0x3c0000003c00,0xbc000000bc00,0xb9a839a839a8b9a8,0x361fbb64b61f3b64,0xbc008000bc008000,0x39a8b9a839a8b9a8,0xb9a8b9a839a839a8,0x3b64b61fbb64361f
.quad 0xbc000000bc00,0x3c0000003c000000,0x39a8b9a8b9a839a8,0x3b64361fbb64b61f,0x3c0000003c000000,0x39a839a839a839a8,0x39a839a8b9a8b9a8,0x361f3b64b61fbb64
.quad 0x2d053bfa00003c00,0x2da63bf821073c00,0xad05bbfa00003c00,0xb767bb1836453b5c,0x2d053bfa00003c00,0x3a22392339b6399a,0xad05bbfa00003c00,0xbba2b4cb3b6c35fa
.quad 0x2d053bfa00003c00,0x3bf8ada63c00a107,0xad05bbfa00003c00,0xbb1837673b5cb645,0x2d053bfa00003c00,0x3923ba22399ab9b6,0xad05bbfa00003c00,0xb4cb3ba235fabb6c
.quad 0x2d053bfa00003c00,0xada6bbf8a107bc00,0xad05bbfa00003c00,0x37673b18b645bb5c,0x2d053bfa00003c00,0xba22b923b9b6b99a,0xad05bbfa00003c00,0x3ba234cbbb6cb5fa
.quad 0x2d053bfa00003c00,0xbbf82da6bc002107,0xad05bbfa00003c00,0x3b18b767bb5c3645,0x2d053bfa00003c00,0xb9233a22b99a39b6,0xad05bbfa00003c00,0x34cbbba2b5fa3b6c
.quad 0x2e463bf625073c00,0x2ee63bf4278a3bff,0xba2fb91339c4398b,0xbbaeb47e3b7a35af,0x3bf6ae463c00a507,0x3904ba3c397db9d2,0xb9133a2f398bb9c4,0x37ae3b05b68ebb4c
.quad 0xae46bbf6a507bc00,0xbbf42ee6bbff278a,0x3a2f3913b9c4b98b,0x347ebbaeb5af3b7a,0xbbf62e46bc002507,0x3a3c390439d2397d,0x3913ba2fb98b39c4,0xbb0537ae3b4cb68e
.quad 0x2e463bf625073c00,0xaee6bbf4a78abbff,0xba2fb91339c4398b,0x3bae347ebb7ab5af,0x3bf6ae463c00a507,0xb9043a3cb97d39d2,0xb9133a2f398bb9c4,0xb7aebb05368e3b4c
.quad 0xae46bbf6a507bc00,0x3bf4aee63bffa78a,0x3a2f3913b9c4b98b,0xb47e3bae35afbb7a,0xbbf62e46bc002507,0xba3cb904b9d2b97d,0x3913ba2fb98b39c4,0x3b05b7aebb4c368e
.quad 0x2f863bf229063bfe,0x30133bef2a483bfe,0xbbf22f863bfea906,0xbaf137f43b3bb6d7,0xaf86bbf2a906bbfe,0xba55b8e4b9edb95f,0x3bf2af86bbfe2906,0x3431bbb8b5643b88
.quad 0x2f863bf229063bfe,0x3befb0133bfeaa48,0xbbf22f863bfea906,0x37f43af1b6d7bb3b,0xaf86bbf2a906bbfe,0xb8e43a55b95f39ed,0x3bf2af86bbfe2906,0xbbb8b4313b883564
.quad 0x2f863bf229063bfe,0xb013bbefaa48bbfe,0xbbf22f863bfea906,0x3af1b7f4bb3b36d7,0xaf86bbf2a906bbfe,0x3a5538e439ed395f,0x3bf2af86bbfe2906,0xb4313bb83564bb88
.quad 0x2f863bf229063bfe,0xbbef3013bbfe2a48,0xbbf22f863bfea906,0xb7f4baf136d73b3b,0xaf86bbf2a906bbfe,0x38e4ba55395fb9ed,0x3bf2af86bbfe2906,0x3bb83431bb88b564
.quad 0x30623bed2b893bfc,0x30b23bea2c653bfb,0xb8d43a613950b9fb,0xb3c63bc33518bb95,0xbbed3062bbfc2b89,0xb8c43a6db9413a08,0xba61b8d439fb3950,0xbadd381d3b2ab720
.quad 0xb062bbedab89bbfc,0xbbea30b2bbfb2c65,0x38d4ba61b95039fb,0xbbc3b3c63b953518,0x3bedb0623bfcab89,0xba6db8c4ba08b941,0x3a6138d4b9fbb950,0xb81dbadd37203b2a
.quad 0x30623bed2b893bfc,0xb0b2bbeaac65bbfb,0xb8d43a613950b9fb,0x33c6bbc3b5183b95,0xbbed3062bbfc2b89,0x38c4ba6d3941ba08,0xba61b8d439fb3950,0x3addb81dbb2a3720
.quad 0xb062bbedab89bbfc,0x3beab0b23bfbac65,0x38d4ba61b95039fb,0x3bc333c6bb95b518,0x3bedb0623bfcab89,0x3a6d38c43a083941,0x3a6138d4b9fbb950,0x381d3addb720bb2a
.quad 0x31023be700003c00,0x31a03be025073c00,0xb102bbe700003c00,0xb850babd36693b54,0x31023be700003c00,0x3a90389339c4398b,0xb102bbe700003c00,0xbbd0b2dc3b7335d5
.quad 0x31023be700003c00,0x3be0b1a03c00a507,0xb102bbe700003c00,0xbabd38503b54b669,0x31023be700003c00,0x3893ba90398bb9c4,0xb102bbe700003c00,0xb2dc3bd035d5bb73
.quad 0x31023be700003c00,0xb1a0bbe0a507bc00,0xb102bbe700003c00,0x38503abdb669bb54,0x31023be700003c00,0xba90b893b9c4b98b,0xb102bbe700003c00,0x3bd032dcbb73b5d5
.quad 0x31023be700003c00,0xbbe031a0bc002507,0xb102bbe700003c00,0x3abdb850bb543669,0x31023be700003c00,0xb8933a90b98b39c4,0xb102bbe700003c00,0x32dcbbd0b5d53b73
.quad 0x323e3bd929063bfe,0x32dc3bd02b893bfc,0xbaa7b87239e0396e,0xbbe0b1a03b8f353e,0x3bd9b23e3bfea906,0x3850babd3950b9fb,0xb8723aa7396eb9e0,0x38933a90b6fcbb33
.quad 0xb23ebbd9a906bbfe,0xbbd032dcbbfc2b89,0x3aa73872b9e0b96e,0x31a0bbe0b53e3b8f,0xbbd9323ebbfe2906,0x3abd385039fb3950,0x3872baa7b96e39e0,0xba9038933b33b6fc
.quad 0x323e3bd929063bfe,0xb2dcbbd0ab89bbfc,0xbaa7b87239e0396e,0x3be031a0bb8fb53e,0x3bd9b23e3bfea906,0xb8503abdb95039fb,0xb8723aa7396eb9e0,0xb893ba9036fc3b33
.quad 0xb23ebbd9a906bbfe,0x3bd0b2dc3bfcab89,0x3aa73872b9e0b96e,0xb1a03be0353ebb8f,0xbbd9323ebbfe2906,0xbabdb850b9fbb950,0x3872baa7b96e39e0,0x3a90b893bb3336fc
.quad 0x33783bc72d053bfa,0x340a3bbe2e463bf6,0xbbc733783bfaad05,0xba6138d43b0eb78b,0xb378bbc7ad05bbfa,0xbae7b80cba2fb913,0x3bc7b378bbfa2d05,0x3062bbedb4a53ba8
.quad 0x33783bc72d053bfa,0x3bbeb40a3bf6ae46,0xbbc733783bfaad05,0x38d43a61b78bbb0e,0xb378bbc7ad05bbfa,0xb80c3ae7b9133a2f,0x3bc7b378bbfa2d05,0xbbedb0623ba834a5
.quad 0x33783bc72d053bfa,0xb40abbbeae46bbf6,0xbbc733783bfaad05,0x3a61b8d4bb0e378b,0xb378bbc7ad05bbfa,0x3ae7380c3a2f3913,0x3bc7b378bbfa2d05,0xb0623bed34a5bba8
.quad 0x33783bc72d053bfa,0xbbbe340abbf62e46,0xbbc733783bfaad05,0xb8d4ba61378b3b0e,0xb378bbc7ad05bbfa,0x380cbae73913ba2f,0x3bc7b378bbfa2d05,0x3bed3062bba8b4a5
.quad 0x34583bb32f863bf2,0x34a53ba830623bed,0xb7d13afb38f4ba48,0xae463bf6340abbbe,0xbbb33458bbf22f86,0xb78b3b0eb8d43a61,0xbafbb7d13a4838f4,0xba2f39133ae7b80c
.quad 0xb458bbb3af86bbf2,0xbba834a5bbed3062,0x37d1bafbb8f43a48,0xbbf6ae463bbe340a,0x3bb3b4583bf2af86,0xbb0eb78bba61b8d4,0x3afb37d1ba48b8f4,0xb913ba2f380c3ae7
.quad 0x34583bb32f863bf2,0xb4a5bba8b062bbed,0xb7d13afb38f4ba48,0x2e46bbf6b40a3bbe,0xbbb33458bbf22f86,0x378bbb0e38d4ba61,0xbafbb7d13a4838f4,0x3a2fb913bae7380c
.quad 0xb458bbb3af86bbf2,0x3ba8b4a53bedb062,0x37d1bafbb8f43a48,0x3bf62e46bbbeb40a,0x3bb3b4583bf2af86,0x3b0e378b3a6138d4,0x3afb37d1ba48b8f4,0x39133a2fb80cbae7
.quad 0x33783bc700003c00,0x34313bb8278a3bff,0xb378bbc700003c00,0xb8e4ba55368e3b4c,0x33783bc700003c00,0x3af137f439d2397d,0xb378bbc700003c00,0xbbefb0133b7a35af
.quad 0x33783bc700003c00,0x3bb8b4313bffa78a,0xb378bbc700003c00,0xba5538e43b4cb68e,0x33783bc700003c00,0x37f4baf1397db9d2,0xb378bbc700003c00,0xb0133bef35afbb7a
.quad 0x33783bc700003c00,0xb431bbb8a78abbff,0xb378bbc700003c00,0x38e43a55b68ebb4c,0x33783bc700003c00,0xbaf1b7f4b9d2b97d,0xb378bbc700003c00,0x3bef3013bb7ab5af
.quad 0x33783bc700003c00,0xbbb83431bbff278a,0xb378bbc700003c00,0x3a55b8e4bb4c368e,0x33783bc700003c00,0xb7f43af1b97d39d2,0xb378bbc700003c00,0x3013bbefb5af3b7a
.quad 0x34a53ba82b893bfc,0x35183b952da63bf8,0xbb0eb78b39fb3950,0xbbfbac653ba234cb,0x3ba8b4a53bfcab89,0x3720bb2a3923ba22,0xb78b3b0e3950b9fb,0x39413a08b767bb18
.quad 0xb4a5bba8ab89bbfc,0xbb953518bbf82da6,0x3b0e378bb9fbb950,0x2c65bbfbb4cb3ba2,0xbba834a5bbfc2b89,0x3b2a37203a223923,0x378bbb0eb95039fb,0xba0839413b18b767
.quad 0x34a53ba82b893bfc,0xb518bb95ada6bbf8,0xbb0eb78b39fb3950,0x3bfb2c65bba2b4cb,0x3ba8b4a53bfcab89,0xb7203b2ab9233a22,0xb78b3b0e3950b9fb,0xb941ba0837673b18
.quad 0xb4a5bba8ab89bbfc,0x3b95b5183bf8ada6,0x3b0e378bb9fbb950,0xac653bfb34cbbba2,0xbba834a5bbfc2b89,0xbb2ab720ba22b923,0x378bbb0eb95039fb,0x3a08b941bb183767
.quad 0x358a3b812f863bf2,0x35fa3b6c30b23bea,0xbb81358a3bf2af86,0xb9b6399a3addb81d,0xb58abb81af86bbf2,0xbb5cb645ba6db8c4,0x3b81b58abbf22f86,0x2107bc00b3c63bc3
.quad 0x358a3b812f863bf2,0x3b6cb5fa3beab0b2,0xbb81358a3bf2af86,0x399a39b6b81dbadd,0xb58abb81af86bbf2,0xb6453b5cb8c43a6d,0x3b81b58abbf22f86,0xbc00a1073bc333c6
.quad 0x358a3b812f863bf2,0xb5fabb6cb0b2bbea,0xbb81358a3bf2af86,0x39b6b99abadd381d,0xb58abb81af86bbf2,0x3b5c36453a6d38c4,0x3b81b58abbf22f86,0xa1073c0033c6bbc3
.quad 0x358a3b812f863bf2,0xbb6c35fabbea30b2,0xbb81358a3bf2af86,0xb99ab9b6381d3add,0xb58abb81af86bbf2,0x3645bb5c38c4ba6d,0x3b81b58abbf22f86,0x3c002107bbc3b3c6
.quad 0x36693b5431a03be0,0x36d73b3b328d3bd5,0xb5d53b733893ba90,0x2a483bfe31efbbdc,0xbb543669bbe031a0,0xb5643b88b8613ab2,0xbb73b5d53a903893,0xb95f39ed3a9cb882
.quad 0xb669bb54b1a0bbe0,0xbb3b36d7bbd5328d,0x35d5bb73b8933a90,0xbbfe2a483bdc31ef,0x3b54b6693be0b1a0,0xbb88b564bab2b861,0x3b7335d5ba90b893,0xb9edb95f38823a9c
.quad 0x36693b5431a03be0,0xb6d7bb3bb28dbbd5,0xb5d53b733893ba90,0xaa48bbfeb1ef3bdc,0xbb543669bbe031a0,0x3564bb883861bab2,0xbb73b5d53a903893,0x395fb9edba9c3882
.quad 0xb669bb54b1a0bbe0,0x3b3bb6d73bd5b28d,0x35d5bb73b8933a90,0x3bfeaa48bbdcb1ef,0x3b54b6693be0b1a0,0x3b8835643ab23861,0x3b7335d5ba90b893,0x39ed395fb882ba9c
.quad 0x34f23b9c00003c00,0x358a3b8129063bfe,0xb4f2bb9c00003c00,0xb96eb9e036b33b44,0x34f23b9c00003c00,0x3b4436b339e0396e,0xb4f2bb9c00003c00,0xbbfea9063b81358a
.quad 0x34f23b9c00003c00,0x3b81b58a3bfea906,0xb4f2bb9c00003c00,0xb9e0396e3b44b6b3,0x34f23b9c00003c00,0x36b3bb44396eb9e0,0xb4f2bb9c00003c00,0xa9063bfe358abb81
.quad 0x34f23b9c00003c00,0xb58abb81a906bbfe,0xb4f2bb9c00003c00,0x396e39e0b6b3bb44,0x34f23b9c00003c00,0xbb44b6b3b9e0b96e,0xb4f2bb9c00003c00,0x3bfe2906bb81b58a
.quad 0x34f23b9c00003c00,0xbb81358abbfe2906,0xb4f2bb9c00003c00,0x39e0b96ebb4436b3,0x34f23b9c00003c00,0xb6b33b44b96e39e0,0xb4f2bb9c00003c00,0x2906bbfeb58a3b81
.quad 0x361f3b642d053bfa,0x36b33b442f863bf2,0xbb64b61f3a153932,0xbbfe29063bb33458,0x3b64b61f3bfaad05,0x358abb8138f4ba48,0xb61f3b643932ba15,0x39e0396eb7d1bafb
.quad 0xb61fbb64ad05bbfa,0xbb4436b3bbf22f86,0x3b64361fba15b932,0xa906bbfeb4583bb3,0xbb64361fbbfa2d05,0x3b81358a3a4838f4,0x361fbb64b9323a15,0xb96e39e03afbb7d1
.quad 0x361f3b642d053bfa,0xb6b3bb44af86bbf2,0xbb64b61f3a153932,0x3bfea906bbb3b458,0x3b64b61f3bfaad05,0xb58a3b81b8f43a48,0xb61f3b643932ba15,0xb9e0b96e37d13afb
.quad 0xb61fbb64ad05bbfa,0x3b44b6b33bf2af86,0x3b64361fba15b932,0x29063bfe3458bbb3,0xbb64361fbbfa2d05,0xbb81b58aba48b8f4,0x361fbb64b9323a15,0x396eb9e0bafb37d1
.quad 0x37443b2131023be7,0x37d13afb323e3bd9,0xbb2137443be7b102,0xb8f43a483aa7b872,0xb744bb21b102bbe7,0xbbb3b458baa7b872,0x3b21b744bbe73102,0xaf86bbf2b23e3bd9
.quad 0x37443b2131023be7,0x3afbb7d13bd9b23e,0xbb2137443be7b102,0x3a4838f4b872baa7,0xb744bb21b102bbe7,0xb4583bb3b8723aa7,0x3b21b744bbe73102,0xbbf22f863bd9323e
.quad 0x37443b2131023be7,0xb7d1bafbb23ebbd9,0xbb2137443be7b102,0x38f4ba48baa73872,0xb744bb21b102bbe7,0x3bb334583aa73872,0x3b21b744bbe73102,0x2f863bf2323ebbd9
.quad 0x37443b2131023be7,0xbafb37d1bbd9323e,0xbb2137443be7b102,0xba48b8f438723aa7,0xb744bb21b102bbe7,0x3458bbb33872baa7,0x3b21b744bbe73102,0x3bf2af86bbd9b23e
.quad 0x382e3ad233783bc7,0x38723aa734583bb3,0xb3783bc7382ebad2,0x323e3bd92f86bbf2,0xbad2382ebbc73378,0xb23e3bd9b7d13afb,0xbbc7b3783ad2382e,0xb8723aa73a48b8f4
.quad 0xb82ebad2b378bbc7,0xbaa73872bbb33458,0x3378bbc7b82e3ad2,0xbbd9323e3bf22f86,0x3ad2b82e3bc7b378,0xbbd9b23ebafbb7d1,0x3bc73378bad2b82e,0xbaa7b87238f43a48
.quad 0x382e3ad233783bc7,0xb872baa7b458bbb3,0xb3783bc7382ebad2,0xb23ebbd9af863bf2,0xbad2382ebbc73378,0x323ebbd937d1bafb,0xbbc7b3783ad2382e,0x3872baa7ba4838f4
.quad 0xb82ebad2b378bbc7,0x3aa7b8723bb3b458,0x3378bbc7b82e3ad2,0x3bd9b23ebbf2af86,0x3ad2b82e3bc7b378,0x3bd9323e3afb37d1,0x3bc73378bad2b82e,0x3aa73872b8f4ba48
.quad 0x361f3b6400003c00,0x36d73b3b2a483bfe,0xb61fbb6400003c00,0xb9edb95f36d73b3b,0x361f3b6400003c00,0x3b88356439ed395f,0xb61fbb6400003c00,0xbbfe2a483b883564
.quad 0x361f3b6400003c00,0x3b3bb6d73bfeaa48,0xb61fbb6400003c00,0xb95f39ed3b3bb6d7,0x361f3b6400003c00,0x3564bb88395fb9ed,0xb61fbb6400003c00,0x2a483bfe3564bb88
.quad 0x361f3b6400003c00,0xb6d7bb3baa48bbfe,0xb61fbb6400003c00,0x39ed395fb6d7bb3b,0x361f3b6400003c00,0xbb88b564b9edb95f,0xb61fbb6400003c00,0x3bfeaa48bb88b564
.quad 0x361f3b6400003c00,0xbb3b36d7bbfe2a48,0xb61fbb6400003c00,0x395fb9edbb3b36d7,0x361f3b6400003c00,0xb5643b88b95f39ed,0xb61fbb6400003c00,0xaa48bbfeb5643b88
.quad 0x378b3b0e2e463bf6,0x381d3add30b23bea,0xbba8b4a53a2f3913,0xbbea30b23bc333c6,0x3b0eb78b3bf6ae46,0x33c6bbc338c4ba6d,0xb4a53ba83913ba2f,0x3a6d38c4b81dbadd
.quad 0xb78bbb0eae46bbf6,0xbadd381dbbea30b2,0x3ba834a5ba2fb913,0xb0b2bbeab3c63bc3,0xbb0e378bbbf62e46,0x3bc333c63a6d38c4,0x34a5bba8b9133a2f,0xb8c43a6d3addb81d
.quad 0x378b3b0e2e463bf6,0xb81dbaddb0b2bbea,0xbba8b4a53a2f3913,0x3beab0b2bbc3b3c6,0x3b0eb78b3bf6ae46,0xb3c63bc3b8c43a6d,0xb4a53ba83913ba2f,0xba6db8c4381d3add
.quad 0xb78bbb0eae46bbf6,0x3addb81d3beab0b2,0x3ba834a5ba2fb913,0x30b23bea33c6bbc3,0xbb0e378bbbf62e46,0xbbc3b3c6ba6db8c4,0x34a5bba8b9133a2f,0x38c4ba6dbadd381d
.quad 0x38723aa7323e3bd9,0x38c43a6d33c63bc3,0xbaa738723bd9b23e,0xb81d3add3a6db8c4,0xb872baa7b23ebbd9,0xbbeab0b2baddb81d,0x3aa7b872bbd9323e,0xb3c6bbc3b0b23bea
.quad 0x38723aa7323e3bd9,0x3a6db8c43bc3b3c6,0xbaa738723bd9b23e,0x3add381db8c4ba6d,0xb872baa7b23ebbd9,0xb0b23beab81d3add,0x3aa7b872bbd9323e,0xbbc333c63bea30b2
.quad 0x38723aa7323e3bd9,0xb8c4ba6db3c6bbc3,0xbaa738723bd9b23e,0x381dbaddba6d38c4,0xb872baa7b23ebbd9,0x3bea30b23add381d,0x3aa7b872bbd9323e,0x33c63bc330b2bbea
.quad 0x38723aa7323e3bd9,0xba6d38c4bbc333c6,0xbaa738723bd9b23e,0xbaddb81d38c43a6d,0xb872baa7b23ebbd9,0x30b2bbea381dbadd,0x3aa7b872bbd9323e,0x3bc3b3c6bbeab0b2
.quad 0x39133a2f34a53ba8,0x395f39ed35643b88,0xae463bf6378bbb0e,0x35643b882a48bbfe,0xba2f3913bba834a5,0xaa483bfeb6d73b3b,0xbbf6ae463b0e378b,0xb6d73b3b39edb95f
.quad 0xb913ba2fb4a5bba8,0xb9ed395fbb883564,0x2e46bbf6b78b3b0e,0xbb8835643bfe2a48,0x3a2fb9133ba8b4a5,0xbbfeaa48bb3bb6d7,0x3bf62e46bb0eb78b,0xbb3bb6d7395f39ed
.quad 0x39133a2f34a53ba8,0xb95fb9edb564bb88,0xae463bf6378bbb0e,0xb564bb88aa483bfe,0xba2f3913bba834a5,0x2a48bbfe36d7bb3b,0xbbf6ae463b0e378b,0x36d7bb3bb9ed395f
.quad 0xb913ba2fb4a5bba8,0x39edb95f3b88b564,0x2e46bbf6b78b3b0e,0x3b88b564bbfeaa48,0x3a2fb9133ba8b4a5,0x3bfe2a483b3b36d7,0x3bf62e46bb0eb78b,0x3b3b36d7b95fb9ed
.quad 0x37443b2100003c00,0x380c3ae72b893bfc,0xb744bb2100003c00,0xba61b8d436fc3b33,0x37443b2100003c00,0x3bbe340a39fb3950,0xb744bb2100003c00,0xbbed30623b8f353e
.quad 0x37443b2100003c00,0x3ae7b80c3bfcab89,0xb744bb2100003c00,0xb8d43a613b33b6fc,0x37443b2100003c00,0x340abbbe3950b9fb,0xb744bb2100003c00,0x30623bed353ebb8f
.quad 0x37443b2100003c00,0xb80cbae7ab89bbfc,0xb744bb2100003c00,0x3a6138d4b6fcbb33,0x37443b2100003c00,0xbbbeb40ab9fbb950,0xb744bb2100003c00,0x3bedb062bb8fb53e
.quad 0x37443b2100003c00,0xbae7380cbbfc2b89,0xb744bb2100003c00,0x38d4ba61bb3336fc,0x37443b2100003c00,0xb40a3bbeb95039fb,0xb744bb2100003c00,0xb062bbedb53e3b8f
.quad 0x38723aa72f863bf2,0x38d43a6131a03be0,0xbbd9b23e3a4838f4,0xbbbe340a3bd032dc,0x3aa7b8723bf2af86,0x3062bbed3893ba90,0xb23e3bd938f4ba48,0x3ae7380cb850babd
.quad 0xb872baa7af86bbf2,0xba6138d4bbe031a0,0x3bd9323eba48b8f4,0xb40abbbeb2dc3bd0,0xbaa73872bbf22f86,0x3bed30623a903893,0x323ebbd9b8f43a48,0xb80c3ae73abdb850
.quad 0x38723aa72f863bf2,0xb8d4ba61b1a0bbe0,0xbbd9b23e3a4838f4,0x3bbeb40abbd0b2dc,0x3aa7b8723bf2af86,0xb0623bedb8933a90,0xb23e3bd938f4ba48,0xbae7b80c38503abd
.quad 0xb872baa7af86bbf2,0x3a61b8d43be0b1a0,0x3bd9323eba48b8f4,0x340a3bbe32dcbbd0,0xbaa73872bbf22f86,0xbbedb062ba90b893,0x323ebbd9b8f43a48,0x380cbae7babd3850
.quad 0x39323a1533783bc7,0x398b39c434a53ba8,0xba1539323bc7b378,0xb6693b543a2fb913,0xb932ba15b378bbc7,0xbc00a507bb0eb78b,0x3a15b932bbc73378,0xb5d5bb73ae463bf6
.quad 0x39323a1533783bc7,0x39c4b98b3ba8b4a5,0xba1539323bc7b378,0x3b543669b913ba2f,0xb932ba15b378bbc7,0xa5073c00b78b3b0e,0x3a15b932bbc73378,0xbb7335d53bf62e46
.quad 0x39323a1533783bc7,0xb98bb9c4b4a5bba8,0xba1539323bc7b378,0x3669bb54ba2f3913,0xb932ba15b378bbc7,0x3c0025073b0e378b,0x3a15b932bbc73378,0x35d53b732e46bbf6
.quad 0x39323a1533783bc7,0xb9c4398bbba834a5,0xba1539323bc7b378,0xbb54b66939133a2f,0xb932ba15b378bbc7,0x2507bc00378bbb0e,0x3a15b932bbc73378,0x3b73b5d5bbf6ae46
.quad 0x39e0396e358a3b81,0x3a2f391336693b54,0x29063bfe36b3bb44,0x378b3b0ea507bc00,0xb96e39e0bb81358a,0x2e463bf6b5d53b73,0xbbfe29063b4436b3,0xb4a53ba8398bb9c4
.quad 0xb9e0b96eb58abb81,0xb9133a2fbb543669,0xa906bbfeb6b33b44,0xbb0e378b3c00a507,0x396eb9e03b81b58a,0xbbf62e46bb73b5d5,0x3bfea906bb44b6b3,0xbba8b4a539c4398b
.quad 0x39e0396e358a3b81,0xba2fb913b669bb54,0x29063bfe36b3bb44,0xb78bbb0e25073c00,0xb96e39e0bb81358a,0xae46bbf635d5bb73,0xbbfe29063b4436b3,0x34a5bba8b98b39c4
.quad 0xb9e0b96eb58abb81,0x3913ba2f3b54b669,0xa906bbfeb6b33b44,0x3b0eb78bbc002507,0x396eb9e03b81b58a,0x3bf6ae463b7335d5,0x3bfea906bb44b6b3,0x3ba834a5b9c4b98b
.quad 0x382e3ad200003c00,0x38a33a852c653bfb,0xb82ebad200003c00,0xbac8b83f37203b2a,0x382e3ad200003c00,0x3be431513a083941,0xb82ebad200003c00,0xbbcc332a3b953518
.quad 0x382e3ad200003c00,0x3a85b8a33bfbac65,0xb82ebad200003c00,0xb83f3ac83b2ab720,0x382e3ad200003c00,0x3151bbe43941ba08,0xb82ebad200003c00,0x332a3bcc3518bb95
.quad 0x382e3ad200003c00,0xb8a3ba85ac65bbfb,0xb82ebad200003c00,0x3ac8383fb720bb2a,0x382e3ad200003c00,0xbbe4b151ba08b941,0xb82ebad200003c00,0x3bccb32abb95b518
.quad 0x382e3ad200003c00,0xba8538a3bbfb2c65,0xb82ebad200003c00,0x383fbac8bb2a3720,0x382e3ad200003c00,0xb1513be4b9413a08,0xb82ebad200003c00,0xb32abbccb5183b95
.quad 0x39133a2f30623bed,0x397d39d2328d3bd5,0xbbf6ae463a6138d4,0xbb7a35af3bdc31ef,0x3a2fb9133bedb062,0x278abbff3861bab2,0xae463bf638d4ba61,0x3b4c368eb882ba9c
.quad 0xb913ba2fb062bbed,0xb9d2397dbbd5328d,0x3bf62e46ba61b8d4,0xb5afbb7ab1ef3bdc,0xba2f3913bbed3062,0x3bff278a3ab23861,0x2e46bbf6b8d43a61,0xb68e3b4c3a9cb882
.quad 0x39133a2f30623bed,0xb97db9d2b28dbbd5,0xbbf6ae463a6138d4,0x3b7ab5afbbdcb1ef,0x3a2fb9133bedb062,0xa78a3bffb8613ab2,0xae463bf638d4ba61,0xbb4cb68e38823a9c
.quad 0xb913ba2fb062bbed,0x39d2b97d3bd5b28d,0x3bf62e46ba61b8d4,0x35af3b7a31efbbdc,0xba2f3913bbed3062,0xbbffa78abab2b861,0x2e46bbf6b8d43a61,0x368ebb4cba9c3882
.quad 0x39e0396e34583bb3,0x3a3c390435643b88,0xb96e39e03bb3b458,0xb47e3bae39edb95f,0xb9e0b96eb458bbb3,0xbbf42ee6bb3bb6d7,0x396eb9e0bbb33458,0xb7aebb05aa483bfe
.quad 0x39e0396e34583bb3,0x3904ba3c3b88b564,0xb96e39e03bb3b458,0x3bae347eb95fb9ed,0xb9e0b96eb458bbb3,0x2ee63bf4b6d73b3b,0x396eb9e0bbb33458,0xbb0537ae3bfe2a48
.quad 0x39e0396e34583bb3,0xba3cb904b564bb88,0xb96e39e03bb3b458,0x347ebbaeb9ed395f,0xb9e0b96eb458bbb3,0x3bf4aee63b3b36d7,0x396eb9e0bbb33458,0x37ae3b052a48bbfe
.quad 0x39e0396e34583bb3,0xb9043a3cbb883564,0xb96e39e03bb3b458,0xbbaeb47e395f39ed,0xb9e0b96eb458bbb3,0xaee6bbf436d7bb3b,0x396eb9e0bbb33458,0x3b05b7aebbfeaa48
.quad 0x3a90389336693b54,0x3add381d37673b18,0x31a03be035d5bb73,0x38c43a6dada6bbf8,0xb8933a90bb543669,0x33c63bc3b4cb3ba2,0xbbe031a03b7335d5,0xb0b23bea3923ba22
.quad 0xba90b893b669bb54,0xb81d3addbb183767,0xb1a0bbe0b5d53b73,0xba6d38c43bf8ada6,0x3893ba903b54b669,0xbbc333c6bba2b4cb,0x3be0b1a0bb73b5d5,0xbbeab0b23a223923
.quad 0x3a90389336693b54,0xbaddb81db767bb18,0x31a03be035d5bb73,0xb8c4ba6d2da63bf8,0xb8933a90bb543669,0xb3c6bbc334cbbba2,0xbbe031a03b7335d5,0x30b2bbeab9233a22
.quad 0xba90b893b669bb54,0x381dbadd3b18b767,0xb1a0bbe0b5d53b73,0x3a6db8c4bbf82da6,0x3893ba903b54b669,0x3bc3b3c63ba234cb,0x3be0b1a0bb73b5d5,0x3bea30b2ba22b923
.quad 0x38b43a7900003c00,0x39323a152d053bfa,0xb8b4ba7900003c00,0xbb21b74437443b21,0x38b43a7900003c00,0x3bfa2d053a153932,0xb8b4ba7900003c00,0xbb9c34f23b9c34f2
.quad 0x38b43a7900003c00,0x3a15b9323bfaad05,0xb8b4ba7900003c00,0xb7443b213b21b744,0x38b43a7900003c00,0x2d05bbfa3932ba15,0xb8b4ba7900003c00,0x34f23b9c34f2bb9c
.quad 0x38b43a7900003c00,0xb932ba15ad05bbfa,0xb8b4ba7900003c00,0x3b213744b744bb21,0x38b43a7900003c00,0xbbfaad05ba15b932,0xb8b4ba7900003c00,0x3b9cb4f2bb9cb4f2
.quad 0x38b43a7900003c00,0xba153932bbfa2d05,0xb8b4ba7900003c00,0x3744bb21bb213744,0x38b43a7900003c00,0xad053bfab9323a15,0xb8b4ba7900003c00,0xb4f2bb9cb4f23b9c
.quad 0x39a839a831023be7,0x3a15393233783bc7,0xbc0080003a7938b4,0xbb2137443be73102,0x39a8b9a83be7b102,0xad05bbfa382ebad2,0x3c0038b4ba79,0x3b9c34f2b8b4ba79
.quad 0xb9a8b9a8b102bbe7,0xb9323a15bbc73378,0x3c000000ba79b8b4,0xb744bb21b1023be7,0xb9a839a8bbe73102,0x3bfaad053ad2382e,0xbc00b8b43a79,0xb4f23b9c3a79b8b4
.quad 0x39a839a831023be7,0xba15b932b378bbc7,0xbc0080003a7938b4,0x3b21b744bbe7b102,0x39a8b9a83be7b102,0x2d053bfab82e3ad2,0x3c0038b4ba79,0xbb9cb4f238b43a79
.quad 0xb9a8b9a8b102bbe7,0x3932ba153bc7b378,0x3c000000ba79b8b4,0x37443b213102bbe7,0xb9a839a8bbe73102,0xbbfa2d05bad2b82e,0xbc00b8b43a79,0x34f2bb9cba7938b4
.quad 0x3a7938b434f23b9c,0x3ad2382e361f3b64,0xb8b43a793b9cb4f2,0xb1023be739a8b9a8,0xba79b8b4b4f2bb9c,0xbbc73378bb64b61f,0x38b4ba79bb9c34f2,0xb8b4ba7900003c00
.quad 0x3a7938b434f23b9c,0x382ebad23b64b61f,0xb8b43a793b9cb4f2,0x3be73102b9a8b9a8,0xba79b8b4b4f2bb9c,0x33783bc7b61f3b64,0x38b4ba79bb9c34f2,0xba7938b43c000000
.quad 0x3a7938b434f23b9c,0xbad2b82eb61fbb64,0xb8b43a793b9cb4f2,0x3102bbe7b9a839a8,0xba79b8b4b4f2bb9c,0x3bc7b3783b64361f,0x38b4ba79bb9c34f2,0x38b43a790000bc00
.quad 0x3a7938b434f23b9c,0xb82e3ad2bb64361f,0xb8b43a793b9cb4f2,0xbbe7b10239a839a8,0xba79b8b4b4f2bb9c,0xb378bbc7361fbb64,0x38b4ba79bb9c34f2,0x3a79b8b4bc008000
.quad 0x3b21374437443b21,0x3b64361f382e3ad2,0x34f23b9c34f2bb9c,0x39a839a8b102bbe7,0xb7443b21bb213744,0x361f3b64b3783bc7,0xbb9c34f23b9c34f2,0x3c0038b4ba79
.quad 0xbb21b744b744bb21,0xb61f3b64bad2382e,0xb4f2bb9cb4f23b9c,0xb9a839a83be7b102,0x3744bb213b21b744,0xbb64361fbbc7b378,0x3b9cb4f2bb9cb4f2,0xbc0080003a7938b4
.quad 0x3b21374437443b21,0xbb64b61fb82ebad2,0x34f23b9c34f2bb9c,0xb9a8b9a831023be7,0xb7443b21bb213744,0xb61fbb643378bbc7,0xbb9c34f23b9c34f2,0xbc00b8b43a79
.quad 0xbb21b744b744bb21,0x361fbb643ad2b82e,0xb4f2bb9cb4f23b9c,0x39a8b9a8bbe73102,0x3744bb213b21b744,0x3b64b61f3bc73378,0x3b9cb4f2bb9cb4f2,0x3c000000ba79b8b4
.quad 0x39323a1500003c00,0x39b6399a2da63bf8,0xb932ba1500003c00,0xbb6cb5fa37673b18,0x39323a1500003c00,0x3c00a1073a223923,0xb932ba1500003c00,0xbb5c36453ba234cb
.quad 0x39323a1500003c00,0x399ab9b63bf8ada6,0xb932ba1500003c00,0xb5fa3b6c3b18b767,0x39323a1500003c00,0xa107bc003923ba22,0xb932ba1500003c00,0x36453b5c34cbbba2
.quad 0x39323a1500003c00,0xb9b6b99aada6bbf8,0xb932ba1500003c00,0x3b6c35fab767bb18,0x39323a1500003c00,0xbc002107ba22b923,0xb932ba1500003c00,0x3b5cb645bba2b4cb
.quad 0x39323a1500003c00,0xb99a39b6bbf82da6,0xb932ba1500003c00,0x35fabb6cbb183767,0x39323a1500003c00,0x21073c00b9233a22,0xb932ba1500003c00,0xb645bb5cb4cb3ba2
.quad 0x3a2f391331a03be0,0x3a9c388234313bb8,0xbbf62e463a903893,0xbab238613bef3013,0x3913ba2f3be0b1a0,0xb1efbbdc37f4baf1,0x2e463bf63893ba90,0x3bd5328db8e4ba55
.quad 0xba2fb913b1a0bbe0,0xb8823a9cbbb83431,0x3bf6ae46ba90b893,0xb861bab2b0133bef,0xb9133a2fbbe031a0,0x3bdcb1ef3af137f4,0xae46bbf6b8933a90,0xb28d3bd53a55b8e4
.quad 0x3a2f391331a03be0,0xba9cb882b431bbb8,0xbbf62e463a903893,0x3ab2b861bbefb013,0x3913ba2f3be0b1a0,0x31ef3bdcb7f43af1,0x2e463bf63893ba90,0xbbd5b28d38e43a55
.quad 0xba2fb913b1a0bbe0,0x3882ba9c3bb8b431,0x3bf6ae46ba90b893,0x38613ab23013bbef,0xb9133a2fbbe031a0,0xbbdc31efbaf1b7f4,0xae46bbf6b8933a90,0x328dbbd5ba5538e4
.quad 0x3afb37d1358a3b81,0x3b4c368e36d73b3b,0xb7d13afb3b81b58a,0xa78a3bff395fb9ed,0xbafbb7d1b58abb81,0xbb7a35afbb88b564,0x37d1bafbbb81358a,0xb97db9d22a483bfe
.quad 0x3afb37d1358a3b81,0x368ebb4c3b3bb6d7,0xb7d13afb3b81b58a,0x3bff278ab9edb95f,0xbafbb7d1b58abb81,0x35af3b7ab5643b88,0x37d1bafbbb81358a,0xb9d2397d3bfeaa48
.quad 0x3afb37d1358a3b81,0xbb4cb68eb6d7bb3b,0xb7d13afb3b81b58a,0x278abbffb95f39ed,0xbafbb7d1b58abb81,0x3b7ab5af3b883564,0x37d1bafbbb81358a,0x397d39d2aa48bbfe
.quad 0x3afb37d1358a3b81,0xb68e3b4cbb3b36d7,0xb7d13afb3b81b58a,0xbbffa78a39ed395f,0xbafbb7d1b58abb81,0xb5afbb7a3564bb88,0x37d1bafbbb81358a,0x39d2b97dbbfe2a48
.quad 0x3b8f353e380c3ae7,0x3bc333c638a33a85,0x36fc3b33340abbbe,0x3a6d38c4b32abbcc,0xb53e3b8fbae7380c,0x381d3addb1513be4,0xbb3336fc3bbe340a,0x30b23bea383fbac8
.quad 0xbb8fb53eb80cbae7,0xb3c63bc3ba8538a3,0xb6fcbb33b40a3bbe,0xb8c43a6d3bccb32a,0x353ebb8f3ae7b80c,0xbadd381dbbe4b151,0x3b33b6fcbbbeb40a,0xbbea30b23ac8383f
.quad 0x3b8f353e380c3ae7,0xbbc3b3c6b8a3ba85,0x36fc3b33340abbbe,0xba6db8c4332a3bcc,0xb53e3b8fbae7380c,0xb81dbadd3151bbe4,0xbb3336fc3bbe340a,0xb0b2bbeab83f3ac8
.quad 0xbb8fb53eb80cbae7,0x33c6bbc33a85b8a3,0xb6fcbb33b40a3bbe,0x38c4ba6dbbcc332a,0x353ebb8f3ae7b80c,0x3addb81d3be43151,0x3b33b6fcbbbeb40a,0x3beab0b2bac8b83f
.quad 0x39a839a800003c00,0x3a2f39132e463bf6,0xb9a8b9a800003c00,0xbba8b4a5378b3b0e,0x39a839a800003c00,0x3bf6ae463a2f3913,0xb9a8b9a800003c00,0xbb0e378b3ba834a5
.quad 0x39a839a800003c00,0x3913ba2f3bf6ae46,0xb9a8b9a800003c00,0xb4a53ba83b0eb78b,0x39a839a800003c00,0xae46bbf63913ba2f,0xb9a8b9a800003c00,0x378b3b0e34a5bba8
.quad 0x39a839a800003c00,0xba2fb913ae46bbf6,0xb9a8b9a800003c00,0x3ba834a5b78bbb0e,0x39a839a800003c00,0xbbf62e46ba2fb913,0xb9a8b9a800003c00,0x3b0eb78bbba8b4a5
.quad 0x39a839a800003c00,0xb9133a2fbbf62e46,0xb9a8b9a800003c00,0x34a5bba8bb0e378b,0x39a839a800003c00,0x2e463bf6b9133a2f,0xb9a8b9a800003c00,0xb78bbb0eb4a53ba8
.quad 0x3aa73872323e3bd9,0x3b0e378b34a53ba8,0xbbd9323e3aa73872,0xba2f39133bf62e46,0x3872baa73bd9b23e,0xb4a5bba8378bbb0e,0x323e3bd93872baa7,0x3bf62e46b913ba2f
.quad 0xbaa7b872b23ebbd9,0xb78b3b0ebba834a5,0x3bd9b23ebaa7b872,0xb913ba2fae463bf6,0xb8723aa7bbd9323e,0x3ba8b4a53b0e378b,0xb23ebbd9b8723aa7,0xae463bf63a2fb913
.quad 0x3aa73872323e3bd9,0xbb0eb78bb4a5bba8,0xbbd9323e3aa73872,0x3a2fb913bbf6ae46,0x3872baa73bd9b23e,0x34a53ba8b78b3b0e,0x323e3bd93872baa7,0xbbf6ae4639133a2f
.quad 0xbaa7b872b23ebbd9,0x378bbb0e3ba8b4a5,0x3bd9b23ebaa7b872,0x39133a2f2e46bbf6,0xb8723aa7bbd9323e,0xbba834a5bb0eb78b,0xb23ebbd9b8723aa7,0x2e46bbf6ba2f3913
.quad 0x3b64361f361f3b64,0x3ba834a5378b3b0e,0xb61f3b643b64b61f,0x2e463bf63913ba2f,0xbb64b61fb61fbb64,0xbb0e378bbba8b4a5,0x361fbb64bb64361f,0xba2fb9132e463bf6
.quad 0x3b64361f361f3b64,0x34a5bba83b0eb78b,0xb61f3b643b64b61f,0x3bf6ae46ba2fb913,0xbb64b61fb61fbb64,0x378b3b0eb4a53ba8,0x361fbb64bb64361f,0xb9133a2f3bf6ae46
.quad 0x3b64361f361f3b64,0xbba8b4a5b78bbb0e,0xb61f3b643b64b61f,0xae46bbf6b9133a2f,0xbb64b61fb61fbb64,0x3b0eb78b3ba834a5,0x361fbb64bb64361f,0x3a2f3913ae46bbf6
.quad 0x3b64361f361f3b64,0xb4a53ba8bb0e378b,0xb61f3b643b64b61f,0xbbf62e463a2f3913,0xbb64b61fb61fbb64,0xb78bbb0e34a5bba8,0x361fbb64bb64361f,0x3913ba2fbbf62e46
.quad 0x3bd9323e38723aa7,0x3bf62e4639133a2f,0x38723aa7323ebbd9,0x3b0e378bb4a5bba8,0xb23e3bd9baa73872,0x39133a2fae463bf6,0xbaa738723bd9323e,0x34a53ba8378bbb0e
.quad 0xbbd9b23eb872baa7,0xae463bf6ba2f3913,0xb872baa7b23e3bd9,0xb78b3b0e3ba8b4a5,0x323ebbd93aa7b872,0xba2f3913bbf6ae46,0x3aa7b872bbd9b23e,0xbba834a53b0e378b
.quad 0x3bd9323e38723aa7,0xbbf6ae46b913ba2f,0x38723aa7323ebbd9,0xbb0eb78b34a53ba8,0xb23e3bd9baa73872,0xb913ba2f2e46bbf6,0xbaa738723bd9323e,0xb4a5bba8b78b3b0e
.quad 0xbbd9b23eb872baa7,0x2e46bbf63a2fb913,0xb872baa7b23e3bd9,0x378bbb0ebba834a5,0x323ebbd93aa7b872,0x3a2fb9133bf62e46,0x3aa7b872bbd9b23e,0x3ba8b4a5bb0eb78b
.quad 0x3a15393200003c00,0x3a9c38822ee63bf4,0xba15b93200003c00,0xbbd5b28d37ae3b05,0x3a15393200003c00,0x3bdcb1ef3a3c3904,0xba15b93200003c00,0xbab238613bae347e
.quad 0x3a15393200003c00,0x3882ba9c3bf4aee6,0xba15b93200003c00,0xb28d3bd53b05b7ae,0x3a15393200003c00,0xb1efbbdc3904ba3c,0xba15b93200003c00,0x38613ab2347ebbae
.quad 0x3a15393200003c00,0xba9cb882aee6bbf4,0xba15b93200003c00,0x3bd5328db7aebb05,0x3a15393200003c00,0xbbdc31efba3cb904,0xba15b93200003c00,0x3ab2b861bbaeb47e
.quad 0x3a15393200003c00,0xb8823a9cbbf42ee6,0xba15b93200003c00,0x328dbbd5bb0537ae,0x3a15393200003c00,0x31ef3bdcb9043a3c,0xba15b93200003c00,0xb861bab2b47e3bae
.quad 0x3b0e378b32dc3bd0,0x3b6c35fa35183b95,0xbba834a53abd3850,0xb99a39b63bfb2c65,0x378bbb0e3bd0b2dc,0xb645bb5c3720bb2a,0x34a53ba83850babd,0x3c00a107b941ba08
.quad 0xbb0eb78bb2dcbbd0,0xb5fa3b6cbb953518,0x3ba8b4a5babdb850,0xb9b6b99aac653bfb,0xb78b3b0ebbd032dc,0x3b5cb6453b2a3720,0xb4a5bba8b8503abd,0x21073c003a08b941
.quad 0x3b0e378b32dc3bd0,0xbb6cb5fab518bb95,0xbba834a53abd3850,0x399ab9b6bbfbac65,0x378bbb0e3bd0b2dc,0x36453b5cb7203b2a,0x34a53ba83850babd,0xbc00210739413a08
.quad 0xbb0eb78bb2dcbbd0,0x35fabb6c3b95b518,0x3ba8b4a5babdb850,0x39b6399a2c65bbfb,0xb78b3b0ebbd032dc,0xbb5c3645bb2ab720,0xb4a5bba8b8503abd,0xa107bc00ba083941
.quad 0x3bb3345836b33b44,0x3be43151381d3add,0xb4583bb33b44b6b3,0x332a3bcc38c4ba6d,0xbbb3b458b6b3bb44,0xba8538a3bbc3b3c6,0x3458bbb3bb4436b3,0xbac8b83f30b23bea
.quad 0x3bb3345836b33b44,0x3151bbe43addb81d,0xb4583bb33b44b6b3,0x3bccb32aba6db8c4,0xbbb3b458b6b3bb44,0x38a33a85b3c63bc3,0x3458bbb3bb4436b3,0xb83f3ac83beab0b2
.quad 0x3bb3345836b33b44,0xbbe4b151b81dbadd,0xb4583bb33b44b6b3,0xb32abbccb8c43a6d,0xbbb3b458b6b3bb44,0x3a85b8a33bc333c6,0x3458bbb3bb4436b3,0x3ac8383fb0b2bbea
.quad 0x3bb3345836b33b44,0xb1513be4badd381d,0xb4583bb33b44b6b3,0xbbcc332a3a6d38c4,0xbbb3b458b6b3bb44,0xb8a3ba8533c6bbc3,0x3458bbb3bb4436b3,0x383fbac8bbea30b2
.quad 0x3bfc2b8938d43a61,0x3bfeaa48397d39d2,0x395039fb3062bbed,0x3b883564b5afbb7a,0xab893bfcba6138d4,0x39ed395fa78a3bff,0xb9fb39503bed3062,0x36d73b3b368ebb4c
.quad 0xbbfcab89b8d4ba61,0x2a483bfeb9d2397d,0xb950b9fbb0623bed,0xb5643b883b7ab5af,0x2b89bbfc3a61b8d4,0xb95f39edbbffa78a,0x39fbb950bbedb062,0xbb3b36d73b4c368e
.quad 0x3bfc2b8938d43a61,0xbbfe2a48b97db9d2,0x395039fb3062bbed,0xbb88b56435af3b7a,0xab893bfcba6138d4,0xb9edb95f278abbff,0xb9fb39503bed3062,0xb6d7bb3bb68e3b4c
.quad 0xbbfcab89b8d4ba61,0xaa48bbfe39d2b97d,0xb950b9fbb0623bed,0x3564bb88bb7a35af,0x2b89bbfc3a61b8d4,0x395fb9ed3bff278a,0x39fbb950bbedb062,0x3b3bb6d7bb4cb68e
.quad 0x3a7938b400003c00,0x3afb37d12f863bf2,0xba79b8b400003c00,0xbbf2af8637d13afb,0x3a7938b400003c00,0x3bb3b4583a4838f4,0xba79b8b400003c00,0xba4838f43bb33458
.quad 0x3a7938b400003c00,0x37d1bafb3bf2af86,0xba79b8b400003c00,0xaf863bf23afbb7d1,0x3a7938b400003c00,0xb458bbb338f4ba48,0xba79b8b400003c00,0x38f43a483458bbb3
.quad 0x3a7938b400003c00,0xbafbb7d1af86bbf2,0xba79b8b400003c00,0x3bf22f86b7d1bafb,0x3a7938b400003c00,0xbbb33458ba48b8f4,0xba79b8b400003c00,0x3a48b8f4bbb3b458
.quad 0x3a7938b400003c00,0xb7d13afbbbf22f86,0xba79b8b400003c00,0x2f86bbf2bafb37d1,0x3a7938b400003c00,0x34583bb3b8f43a48,0xba79b8b400003c00,0xb8f4ba48b4583bb3
.quad 0x3b64361f33783bc7,0x3bb33458358a3b81,0xbb64361f3ad2382e,0xb8f43a483bfe2906,0x361fbb643bc7b378,0xb7d1bafb36b3bb44,0x361f3b64382ebad2,0x3bf2af86b96eb9e0
.quad 0xbb64b61fb378bbc7,0xb4583bb3bb81358a,0x3b64b61fbad2b82e,0xba48b8f4a9063bfe,0xb61f3b64bbc73378,0x3afbb7d13b4436b3,0xb61fbb64b82e3ad2,0x2f863bf239e0b96e
.quad 0x3b64361f33783bc7,0xbbb3b458b58abb81,0xbb64361f3ad2382e,0x38f4ba48bbfea906,0x361fbb643bc7b378,0x37d13afbb6b33b44,0x361f3b64382ebad2,0xbbf22f86396e39e0
.quad 0xbb64b61fb378bbc7,0x3458bbb33b81b58a,0x3b64b61fbad2b82e,0x3a4838f42906bbfe,0xb61f3b64bbc73378,0xbafb37d1bb44b6b3,0xb61fbb64b82e3ad2,0xaf86bbf2b9e0396e
.quad 0x3be7310237443b21,0x3bfe290638723aa7,0xb1023be73b21b744,0x358a3b813872baa7,0xbbe7b102b744bb21,0xb9e0396ebbd9b23e,0x3102bbe7bb213744,0xbb44b6b3323e3bd9
.quad 0x3be7310237443b21,0x2906bbfe3aa7b872,0xb1023be73b21b744,0x3b81b58abaa7b872,0xbbe7b102b744bb21,0x396e39e0b23e3bd9,0x3102bbe7bb213744,0xb6b33b443bd9b23e
.quad 0x3be7310237443b21,0xbbfea906b872baa7,0xb1023be73b21b744,0xb58abb81b8723aa7,0xbbe7b102b744bb21,0x39e0b96e3bd9323e,0x3102bbe7bb213744,0x3b4436b3b23ebbd9
.quad 0x3be7310237443b21,0xa9063bfebaa73872,0xb1023be73b21b744,0xbb81358a3aa73872,0xbbe7b102b744bb21,0xb96eb9e0323ebbd9,0x3102bbe7bb213744,0x36b3bb44bbd9323e
.quad 0x3bfaad0539323a15,0x3bd9b23e39e0396e,0x3a1539322d05bbfa,0x3bd9323eb6b3bb44,0x2d053bfaba153932,0x3aa7387229063bfe,0xb9323a153bfa2d05,0x38723aa7358abb81
.quad 0xbbfa2d05b932ba15,0x323e3bd9b96e39e0,0xba15b932ad053bfa,0xb23e3bd93b44b6b3,0xad05bbfa3a15b932,0xb8723aa7bbfe2906,0x3932ba15bbfaad05,0xbaa738723b81358a
.quad 0x3bfaad0539323a15,0xbbd9323eb9e0b96e,0x3a1539322d05bbfa,0xbbd9b23e36b33b44,0x2d053bfaba153932,0xbaa7b872a906bbfe,0xb9323a153bfa2d05,0xb872baa7b58a3b81
.quad 0xbbfa2d05b932ba15,0xb23ebbd9396eb9e0,0xba15b932ad053bfa,0x323ebbd9bb4436b3,0xad05bbfa3a15b932,0x3872baa73bfea906,0x3932ba15bbfaad05,0x3aa7b872bb81b58a
.quad 0x3ad2382e00003c00,0x3b4c368e30133bef,0xbad2b82e00003c00,0xbbffa78a37f43af1,0x3ad2382e00003c00,0x3b7ab5af3a5538e4,0xbad2b82e00003c00,0xb9d2397d3bb83431
.quad 0x3ad2382e00003c00,0x368ebb4c3befb013,0xbad2b82e00003c00,0xa78a3bff3af1b7f4,0x3ad2382e00003c00,0xb5afbb7a38e4ba55,0xbad2b82e00003c00,0x397d39d23431bbb8
.quad 0x3ad2382e00003c00,0xbb4cb68eb013bbef,0xbad2b82e00003c00,0x3bff278ab7f4baf1,0x3ad2382e00003c00,0xbb7a35afba55b8e4,0xbad2b82e00003c00,0x39d2b97dbbb8b431
.quad 0x3ad2382e00003c00,0xb68e3b4cbbef3013,0xbad2b82e00003c00,0x278abbffbaf137f4,0x3ad2382e00003c00,0x35af3b7ab8e43a55,0xbad2b82e00003c00,0xb97db9d2b4313bb8
.quad 0x3ba834a5340a3bbe,0x3be4315135fa3b6c,0xbb0e378b3ae7380c,0xb83f3ac83c002107,0x34a5bba83bbeb40a,0xb8a3ba853645bb5c,0x378b3b0e380cbae7,0x3bccb32ab99ab9b6
.quad 0xbba8b4a5b40abbbe,0xb1513be4bb6c35fa,0x3b0eb78bbae7b80c,0xbac8b83fa1073c00,0xb4a53ba8bbbe340a,0x3a85b8a33b5c3645,0xb78bbb0eb80c3ae7,0x332a3bcc39b6b99a
.quad 0x3ba834a5340a3bbe,0xbbe4b151b5fabb6c,0xbb0e378b3ae7380c,0x383fbac8bc00a107,0x34a5bba83bbeb40a,0x38a33a85b6453b5c,0x378b3b0e380cbae7,0xbbcc332a399a39b6
.quad 0xbba8b4a5b40abbbe,0x3151bbe43b6cb5fa,0x3b0eb78bbae7b80c,0x3ac8383f2107bc00,0xb4a53ba8bbbe340a,0xba8538a3bb5cb645,0xb78bbb0eb80c3ae7,0xb32abbccb9b6399a
.quad 0x3bfe290637d13afb,0x3bf8ada638c43a6d,0xa9063bfe3afbb7d1,0x37673b18381dbadd,0xbbfea906b7d1bafb,0xb9233a22bbeab0b2,0x2906bbfebafb37d1,0xbba2b4cb33c63bc3
.quad 0x3bfe290637d13afb,0xada6bbf83a6db8c4,0xa9063bfe3afbb7d1,0x3b18b767baddb81d,0xbbfea906b7d1bafb,0x3a223923b0b23bea,0x2906bbfebafb37d1,0xb4cb3ba23bc3b3c6
.quad 0x3bfe290637d13afb,0xbbf82da6b8c4ba6d,0xa9063bfe3afbb7d1,0xb767bb18b81d3add,0xbbfea906b7d1bafb,0x3923ba223bea30b2,0x2906bbfebafb37d1,0x3ba234cbb3c6bbc3
.quad 0x3bfe290637d13afb,0x2da63bf8ba6d38c4,0xa9063bfe3afbb7d1,0xbb1837673add381d,0xbbfea906b7d1bafb,0xba22b92330b2bbea,0x2906bbfebafb37d1,0x34cbbba2bbc333c6
.quad 0x3bd0b2dc398b39c4,0x3b88b5643a3c3904,0x3abd38502507bc00,0x3bfe2a48b7aebb05,0x32dc3bd0b9c4398b,0x3b3b36d72ee63bf4,0xb8503abd3c002507,0x395f39ed347ebbae
.quad 0xbbd032dcb98bb9c4,0x35643b88b9043a3c,0xbabdb850a5073c00,0xaa483bfe3b05b7ae,0xb2dcbbd039c4b98b,0xb6d73b3bbbf42ee6,0x3850babdbc00a507,0xb9ed395f3bae347e
.quad 0x3bd0b2dc398b39c4,0xbb883564ba3cb904,0x3abd38502507bc00,0xbbfeaa4837ae3b05,0x32dc3bd0b9c4398b,0xbb3bb6d7aee6bbf4,0xb8503abd3c002507,0xb95fb9edb47e3bae
.quad 0xbbd032dcb98bb9c4,0xb564bb883904ba3c,0xbabdb850a5073c00,0x2a48bbfebb0537ae,0xb2dcbbd039c4b98b,0x36d7bb3b3bf4aee6,0x3850babdbc00a507,0x39edb95fbbaeb47e
.quad 0x3b21374400003c00,0x3b8f353e30623bed,0xbb21b74400003c00,0xbbfc2b89380c3ae7,0x3b21374400003c00,0x3b33b6fc3a6138d4,0xbb21b74400003c00,0xb95039fb3bbe340a
.quad 0x3b21374400003c00,0x353ebb8f3bedb062,0xbb21b74400003c00,0x2b893bfc3ae7b80c,0x3b21374400003c00,0xb6fcbb3338d4ba61,0xbb21b74400003c00,0x39fb3950340abbbe
.quad 0x3b21374400003c00,0xbb8fb53eb062bbed,0xbb21b74400003c00,0x3bfcab89b80cbae7,0x3b21374400003c00,0xbb3336fcba61b8d4,0xbb21b74400003c00,0x3950b9fbbbbeb40a
.quad 0x3b21374400003c00,0xb53e3b8fbbed3062,0xbb21b74400003c00,0xab89bbfcbae7380c,0x3b21374400003c00,0x36fc3b33b8d43a61,0xbb21b74400003c00,0xb9fbb950b40a3bbe
.quad 0x3bd9323e34583bb3,0x3bfc2b8936693b54,0xbaa738723afb37d1,0xb6fc3b333c00a507,0x323ebbd93bb3b458,0xb950b9fb35d5bb73,0x38723aa737d1bafb,0x3b8fb53eb9c4b98b
.quad 0xbbd9b23eb458bbb3,0xab893bfcbb543669,0x3aa7b872bafbb7d1,0xbb33b6fc25073c00,0xb23e3bd9bbb33458,0x39fbb9503b7335d5,0xb872baa7b7d13afb,0x353e3b8f398bb9c4
.quad 0x3bd9323e34583bb3,0xbbfcab89b669bb54,0xbaa738723afb37d1,0x36fcbb33bc002507,0x323ebbd93bb3b458,0x395039fbb5d53b73,0x38723aa737d1bafb,0xbb8f353e39c4398b
.quad 0xbbd9b23eb458bbb3,0x2b89bbfc3b54b669,0x3aa7b872bafbb7d1,0x3b3336fca507bc00,0xb23e3bd9bbb33458,0xb9fb3950bb73b5d5,0xb872baa7b7d13afb,0xb53ebb8fb98b39c4
.quad 0x3bfaad05382e3ad2,0x3bd0b2dc39133a2f,0x2d053bfa3ad2b82e,0x38933a90378bbb0e,0xbbfa2d05b82ebad2,0xb8503abdbbf6ae46,0xad05bbfabad2382e,0xbbe0b1a034a53ba8
.quad 0x3bfaad05382e3ad2,0xb2dcbbd03a2fb913,0x2d053bfa3ad2b82e,0x3a90b893bb0eb78b,0xbbfa2d05b82ebad2,0x3abd3850ae463bf6,0xad05bbfabad2382e,0xb1a03be03ba8b4a5
.quad 0x3bfaad05382e3ad2,0xbbd032dcb913ba2f,0x2d053bfa3ad2b82e,0xb893ba90b78b3b0e,0xbbfa2d05b82ebad2,0x3850babd3bf62e46,0xad05bbfabad2382e,0x3be031a0b4a5bba8
.quad 0x3bfaad05382e3ad2,0x32dc3bd0ba2f3913,0x2d053bfa3ad2b82e,0xba9038933b0e378b,0xbbfa2d05b82ebad2,0xbabdb8502e46bbf6,0xad05bbfabad2382e,0x31a0bbe0bba834a5
.quad 0x3b81b58a39e0396e,0x3b0eb78b3a903893,0x3b4436b3a906bbfe,0x3bf6ae46b850babd,0x358a3b81b96e39e0,0x3ba834a531a03be0,0xb6b33b443bfea906,0x3a2f391332dcbbd0
.quad 0xbb81358ab9e0b96e,0x378b3b0eb8933a90,0xbb44b6b329063bfe,0x2e463bf63abdb850,0xb58abb81396eb9e0,0xb4a53ba8bbe031a0,0x36b3bb44bbfe2906,0xb9133a2f3bd032dc
.quad 0x3b81b58a39e0396e,0xbb0e378bba90b893,0x3b4436b3a906bbfe,0xbbf62e4638503abd,0x358a3b81b96e39e0,0xbba8b4a5b1a0bbe0,0xb6b33b443bfea906,0xba2fb913b2dc3bd0
.quad 0xbb81358ab9e0b96e,0xb78bbb0e3893ba90,0xbb44b6b329063bfe,0xae46bbf6babd3850,0xb58abb81396eb9e0,0x34a5bba83be0b1a0,0x36b3bb44bbfe2906,0x3913ba2fbbd0b2dc
.quad 0x3b64361f00003c00,0x3bc333c630b23bea,0xbb64b61f00003c00,0xbbea30b2381d3add,0x3b64361f00003c00,0x3addb81d3a6d38c4,0xbb64b61f00003c00,0xb8c43a6d3bc333c6
.quad 0x3b64361f00003c00,0x33c6bbc33beab0b2,0xbb64b61f00003c00,0x30b23bea3addb81d,0x3b64361f00003c00,0xb81dbadd38c4ba6d,0xbb64b61f00003c00,0x3a6d38c433c6bbc3
.quad 0x3b64361f00003c00,0xbbc3b3c6b0b2bbea,0xbb64b61f00003c00,0x3beab0b2b81dbadd,0x3b64361f00003c00,0xbadd381dba6db8c4,0xbb64b61f00003c00,0x38c4ba6dbbc3b3c6
.quad 0x3b64361f00003c00,0xb3c63bc3bbea30b2,0xbb64b61f00003c00,0xb0b2bbeabadd381d,0x3b64361f00003c00,0x381d3addb8c43a6d,0xbb64b61f00003c00,0xba6db8c4b3c63bc3
.quad 0x3bf62e4634a53ba8,0x3bfeaa4836d73b3b,0xba2f39133b0e378b,0xb5643b883bfeaa48,0x2e46bbf63ba8b4a5,0xb9edb95f3564bb88,0x39133a2f378bbb0e,0x3b3bb6d7b9edb95f
.quad 0xbbf6ae46b4a5bba8,0x2a483bfebb3b36d7,0x3a2fb913bb0eb78b,0xbb88b5642a483bfe,0xae463bf6bba834a5,0x395fb9ed3b883564,0xb913ba2fb78b3b0e,0x36d73b3b395fb9ed
.quad 0x3bf62e4634a53ba8,0xbbfe2a48b6d7bb3b,0xba2f39133b0e378b,0x3564bb88bbfe2a48,0x2e46bbf63ba8b4a5,0x39ed395fb5643b88,0x39133a2f378bbb0e,0xbb3b36d739ed395f
.quad 0xbbf6ae46b4a5bba8,0xaa48bbfe3b3bb6d7,0x3a2fb913bb0eb78b,0x3b883564aa48bbfe,0xae463bf6bba834a5,0xb95f39edbb88b564,0xb913ba2fb78b3b0e,0xb6d7bb3bb95f39ed
.quad 0x3bd9b23e38723aa7,0x3b88b564395f39ed,0x323e3bd93aa7b872,0x395f39ed36d7bb3b,0xbbd9323eb872baa7,0xb6d73b3bbbfeaa48,0xb23ebbd9baa73872,0xbbfeaa4835643b88
.quad 0x3bd9b23e38723aa7,0xb564bb8839edb95f,0x323e3bd93aa7b872,0x39edb95fbb3bb6d7,0xbbd9323eb872baa7,0x3b3b36d7aa483bfe,0xb23ebbd9baa73872,0xaa483bfe3b88b564
.quad 0x3bd9b23e38723aa7,0xbb883564b95fb9ed,0x323e3bd93aa7b872,0xb95fb9edb6d73b3b,0xbbd9323eb872baa7,0x36d7bb3b3bfe2a48,0xb23ebbd9baa73872,0x3bfe2a48b564bb88
.quad 0x3bd9b23e38723aa7,0x35643b88b9ed395f,0x323e3bd93aa7b872,0xb9ed395f3b3b36d7,0xbbd9323eb872baa7,0xbb3bb6d72a48bbfe,0xb23ebbd9baa73872,0x2a48bbfebb883564
.quad 0x3b0eb78b3a2f3913,0x3a6db8c43add381d,0x3ba834a5ae46bbf6,0x3bc3b3c6b8c4ba6d,0x378b3b0eb9133a2f,0x3bea30b233c63bc3,0xb4a53ba83bf6ae46,0x3add381d30b2bbea
.quad 0xbb0e378bba2fb913,0x38c43a6db81d3add,0xbba8b4a52e463bf6,0x33c63bc33a6db8c4,0xb78bbb0e3913ba2f,0xb0b23beabbc333c6,0x34a5bba8bbf62e46,0xb81d3add3bea30b2
.quad 0x3b0eb78b3a2f3913,0xba6d38c4baddb81d,0x3ba834a5ae46bbf6,0xbbc333c638c43a6d,0x378b3b0eb9133a2f,0xbbeab0b2b3c6bbc3,0xb4a53ba83bf6ae46,0xbaddb81db0b23bea
.quad 0xbb0e378bba2fb913,0xb8c4ba6d381dbadd,0xbba8b4a52e463bf6,0xb3c6bbc3ba6d38c4,0xb78bbb0e3913ba2f,0x30b2bbea3bc3b3c6,0x34a5bba8bbf62e46,0x381dbaddbbeab0b2
.quad 0x3b9c34f200003c00,0x3be7310231023be7,0xbb9cb4f200003c00,0xbbc73378382e3ad2,0x3b9c34f200003c00,0x3a79b8b43a7938b4,0xbb9cb4f200003c00,0xb82e3ad23bc73378
.quad 0x3b9c34f200003c00,0x3102bbe73be7b102,0xbb9cb4f200003c00,0x33783bc73ad2b82e,0x3b9c34f200003c00,0xb8b4ba7938b4ba79,0xbb9cb4f200003c00,0x3ad2382e3378bbc7
.quad 0x3b9c34f200003c00,0xbbe7b102b102bbe7,0xbb9cb4f200003c00,0x3bc7b378b82ebad2,0x3b9c34f200003c00,0xba7938b4ba79b8b4,0xbb9cb4f200003c00,0x382ebad2bbc7b378
.quad 0x3b9c34f200003c00,0xb1023be7bbe73102,0xbb9cb4f200003c00,0xb378bbc7bad2382e,0x3b9c34f200003c00,0x38b43a79b8b43a79,0xbb9cb4f200003c00,0xbad2b82eb3783bc7
.quad 0x3c00000034f23b9c,0x3be7b10237443b21,0xb9a839a83b213744,0xb3783bc73bfaad05,0xbc003b9cb4f2,0xba79b8b434f2bb9c,0x39a839a83744bb21,0x3ad2b82eba15b932
.quad 0xbc008000b4f2bb9c,0x31023be7bb213744,0x39a8b9a8bb21b744,0xbbc7b3782d053bfa,0x3c00bb9c34f2,0x38b4ba793b9c34f2,0xb9a8b9a8b7443b21,0x382e3ad23932ba15
.quad 0x3c00000034f23b9c,0xbbe73102b744bb21,0xb9a839a83b213744,0x3378bbc7bbfa2d05,0xbc003b9cb4f2,0x3a7938b4b4f23b9c,0x39a839a83744bb21,0xbad2382e3a153932
.quad 0xbc008000b4f2bb9c,0xb102bbe73b21b744,0x39a8b9a8bb21b744,0x3bc73378ad05bbfa,0x3c00bb9c34f2,0xb8b43a79bb9cb4f2,0xb9a8b9a8b7443b21,0xb82ebad2b9323a15
.quad 0x3b9cb4f238b43a79,0x3b21b74439a839a8,0x34f23b9c3a79b8b4,0x3a153932361fbb64,0xbb9c34f2b8b4ba79,0xb4f23b9cbc008000,0xb4f2bb9cba7938b4,0xbbfa2d05361f3b64
.quad 0x3b9cb4f238b43a79,0xb744bb2139a8b9a8,0x34f23b9c3a79b8b4,0x3932ba15bb64b61f,0xbb9c34f2b8b4ba79,0x3b9c34f200003c00,0xb4f2bb9cba7938b4,0x2d053bfa3b64b61f
.quad 0x3b9cb4f238b43a79,0xbb213744b9a8b9a8,0x34f23b9c3a79b8b4,0xba15b932b61f3b64,0xbb9c34f2b8b4ba79,0x34f2bb9c3c000000,0xb4f2bb9cba7938b4,0x3bfaad05b61fbb64
.quad 0x3b9cb4f238b43a79,0x37443b21b9a839a8,0x34f23b9c3a79b8b4,0xb9323a153b64361f,0xbb9c34f2b8b4ba79,0xbb9cb4f20000bc00,0xb4f2bb9cba7938b4,0xad05bbfabb64361f
.quad 0x3a79b8b43a7938b4,0x39a8b9a83b213744,0x3be73102b102bbe7,0x3b64b61fb932ba15,0x38b43a79b8b43a79,0x3c00000034f23b9c,0xb1023be73be7b102,0x3b64361f2d05bbfa
.quad 0xba7938b4ba79b8b4,0x39a839a8b7443b21,0xbbe7b10231023be7,0x361f3b643a15b932,0xb8b4ba7938b4ba79,0x3c00bb9c34f2,0x3102bbe7bbe73102,0xb61f3b643bfa2d05
.quad 0x3a79b8b43a7938b4,0xb9a839a8bb21b744,0x3be73102b102bbe7,0xbb64361f39323a15,0x38b43a79b8b43a79,0xbc008000b4f2bb9c,0xb1023be73be7b102,0xbb64b61fad053bfa
.quad 0xba7938b4ba79b8b4,0xb9a8b9a83744bb21,0xbbe7b10231023be7,0xb61fbb64ba153932,0xb8b4ba7938b4ba79,0xbc003b9cb4f2,0x3102bbe7bbe73102,0x361fbb64bbfaad05
.quad 0x3bc7337800003c00,0x3bfb2c6531513be4,0xbbc7b37800003c00,0xbb953518383f3ac8,0x3bc7337800003c00,0x3a08b9413a8538a3,0xbbc7b37800003c00,0xb7203b2a3bcc332a
.quad 0x3bc7337800003c00,0x2c65bbfb3be4b151,0xbbc7b37800003c00,0x35183b953ac8b83f,0x3bc7337800003c00,0xb941ba0838a3ba85,0xbbc7b37800003c00,0x3b2a3720332abbcc
.quad 0x3bc7337800003c00,0xbbfbac65b151bbe4,0xbbc7b37800003c00,0x3b95b518b83fbac8,0x3bc7337800003c00,0xba083941ba85b8a3,0xbbc7b37800003c00,0x3720bb2abbccb32a
.quad 0x3bc7337800003c00,0xac653bfbbbe43151,0xbbc7b37800003c00,0xb518bb95bac8383f,0x3bc7337800003c00,0x39413a08b8a33a85,0xbbc7b37800003c00,0xbb2ab720b32a3bcc
.quad 0x3bf6ae46353e3b8f,0x3bb8b43137ae3b05,0xb9133a2f3b3336fc,0xb0133bef3bf4aee6,0xae46bbf63b8fb53e,0xbaf1b7f4347ebbae,0x3a2f391336fcbb33,0x3a55b8e4ba3cb904
.quad 0xbbf62e46b53ebb8f,0x34313bb8bb0537ae,0x3913ba2fbb33b6fc,0xbbefb0132ee63bf4,0x2e463bf6bb8f353e,0x37f4baf13bae347e,0xba2fb913b6fc3b33,0x38e43a553904ba3c
.quad 0x3bf6ae46353e3b8f,0xbbb83431b7aebb05,0xb9133a2f3b3336fc,0x3013bbefbbf42ee6,0xae46bbf63b8fb53e,0x3af137f4b47e3bae,0x3a2f391336fcbb33,0xba5538e43a3c3904
.quad 0xbbf62e46b53ebb8f,0xb431bbb83b05b7ae,0x3913ba2fbb33b6fc,0x3bef3013aee6bbf4,0x2e463bf6bb8f353e,0xb7f43af1bbaeb47e,0xba2fb913b6fc3b33,0xb8e4ba55b9043a3c
.quad 0x3b44b6b338f43a48,0x3a9cb88239ed395f,0x36b33b443a48b8f4,0x3ab238613564bb88,0xbb4436b3b8f4ba48,0xb1ef3bdcbbfe2a48,0xb6b3bb44ba4838f4,0xbbd5328d36d73b3b
.quad 0x3b44b6b338f43a48,0xb882ba9c395fb9ed,0x36b33b443a48b8f4,0x3861bab2bb88b564,0xbb4436b3b8f4ba48,0x3bdc31ef2a483bfe,0xb6b3bb44ba4838f4,0x328d3bd53b3bb6d7
.quad 0x3b44b6b338f43a48,0xba9c3882b9edb95f,0x36b33b443a48b8f4,0xbab2b861b5643b88,0xbb4436b3b8f4ba48,0x31efbbdc3bfeaa48,0xb6b3bb44ba4838f4,0x3bd5b28db6d7bb3b
.quad 0x3b44b6b338f43a48,0x38823a9cb95f39ed,0x36b33b443a48b8f4,0xb8613ab23b883564,0xbb4436b3b8f4ba48,0xbbdcb1efaa48bbfe,0xb6b3bb44ba4838f4,0xb28dbbd5bb3b36d7
.quad 0x39c4b98b3abd3850,0x38c4ba6d3b5c3645,0x3c002507b2dcbbd0,0x3addb81db99ab9b6,0x398b39c4b8503abd,0x3beab0b235fa3b6c,0xa5073c003bd0b2dc,0x3bc333c62107bc00
.quad 0xb9c4398bbabdb850,0x3a6d38c4b6453b5c,0xbc00a50732dc3bd0,0x381d3add39b6b99a,0xb98bb9c43850babd,0x30b23beabb6c35fa,0x2507bc00bbd032dc,0xb3c63bc33c002107
.quad 0x39c4b98b3abd3850,0xb8c43a6dbb5cb645,0x3c002507b2dcbbd0,0xbadd381d399a39b6,0x398b39c4b8503abd,0xbbea30b2b5fabb6c,0xa5073c003bd0b2dc,0xbbc3b3c6a1073c00
.quad 0xb9c4398bbabdb850,0xba6db8c43645bb5c,0xbc00a50732dc3bd0,0xb81dbaddb9b6399a,0xb98bb9c43850babd,0xb0b2bbea3b6cb5fa,0x2507bc00bbd032dc,0x33c6bbc3bc00a107
.quad 0x3be7310200003c00,0x3c00a50731a03be0,0xbbe7b10200003c00,0xbb54366938503abd,0x3be7310200003c00,0x398bb9c43a903893,0xbbe7b10200003c00,0xb5d53b733bd032dc
.quad 0x3be7310200003c00,0xa507bc003be0b1a0,0xbbe7b10200003c00,0x36693b543abdb850,0x3be7310200003c00,0xb9c4b98b3893ba90,0xbbe7b10200003c00,0x3b7335d532dcbbd0
.quad 0x3be7310200003c00,0xbc002507b1a0bbe0,0xbbe7b10200003c00,0x3b54b669b850babd,0x3be7310200003c00,0xb98b39c4ba90b893,0xbbe7b10200003c00,0x35d5bb73bbd0b2dc
.quad 0x3be7310200003c00,0x25073c00bbe031a0,0xbbe7b10200003c00,0xb669bb54babd3850,0x3be7310200003c00,0x39c4398bb8933a90,0xbbe7b10200003c00,0xbb73b5d5b2dc3bd0
.quad 0x3bd9b23e358a3b81,0x3b73b5d5380c3ae7,0xb8723aa73b4436b3,0xa5073c003bedb062,0xb23ebbd93b81b58a,0xbb54b669340abbbe,0x3aa7387236b3bb44,0x39c4b98bba61b8d4
.quad 0xbbd9323eb58abb81,0x35d53b73bae7380c,0x3872baa7bb44b6b3,0xbc00a50730623bed,0x323e3bd9bb81358a,0x3669bb543bbe340a,0xbaa7b872b6b33b44,0x398b39c438d4ba61
.quad 0x3bd9b23e358a3b81,0xbb7335d5b80cbae7,0xb8723aa73b4436b3,0x2507bc00bbed3062,0xb23ebbd93b81b58a,0x3b543669b40a3bbe,0x3aa7387236b3bb44,0xb9c4398b3a6138d4
.quad 0xbbd9323eb58abb81,0xb5d5bb733ae7b80c,0x3872baa7bb44b6b3,0x3c002507b062bbed,0x323e3bd9bb81358a,0xb6693b54bbbeb40a,0xbaa7b872b6b33b44,0xb98bb9c4b8d43a61
.quad 0x3ad2b82e39323a15,0x39fbb9503a2f3913,0x382e3ad23a15b932,0x3b3336fc34a5bba8,0xbad2382eb932ba15,0xab893bfcbbf62e46,0xb82ebad2ba153932,0xbb8f353e378b3b0e
.quad 0x3ad2b82e39323a15,0xb950b9fb3913ba2f,0x382e3ad23a15b932,0x36fcbb33bba8b4a5,0xbad2382eb932ba15,0x3bfc2b892e463bf6,0xb82ebad2ba153932,0x353e3b8f3b0eb78b
.quad 0x3ad2b82e39323a15,0xb9fb3950ba2fb913,0x382e3ad23a15b932,0xbb33b6fcb4a53ba8,0xbad2382eb932ba15,0x2b89bbfc3bf6ae46,0xb82ebad2ba153932,0x3b8fb53eb78bbb0e
.quad 0x3ad2b82e39323a15,0x395039fbb9133a2f,0x382e3ad23a15b932,0xb6fc3b333ba834a5,0xbad2382eb932ba15,0xbbfcab89ae46bbf6,0xb82ebad2ba153932,0xb53ebb8fbb0e378b
.quad 0x38f4ba483afb37d1,0x378bbb0e3b8f353e,0x3bf2af86b458bbb3,0x3a2fb913b9fbb950,0x3a4838f4b7d13afb,0x3ba8b4a536fc3b33,0x2f863bf23bb3b458,0x3bf62e46ab89bbfc
.quad 0xb8f43a48bafbb7d1,0x3b0e378bb53e3b8f,0xbbf22f8634583bb3,0x39133a2f3950b9fb,0xba48b8f437d1bafb,0x34a53ba8bb3336fc,0xaf86bbf2bbb33458,0xae463bf63bfcab89
.quad 0x38f4ba483afb37d1,0xb78b3b0ebb8fb53e,0x3bf2af86b458bbb3,0xba2f391339fb3950,0x3a4838f4b7d13afb,0xbba834a5b6fcbb33,0x2f863bf23bb3b458,0xbbf6ae462b893bfc
.quad 0xb8f43a48bafbb7d1,0xbb0eb78b353ebb8f,0xbbf22f8634583bb3,0xb913ba2fb95039fb,0xba48b8f437d1bafb,0xb4a5bba83b33b6fc,0xaf86bbf2bbb33458,0x2e46bbf6bbfc2b89
.quad 0x3bfa2d0500003c00,0x3bf4aee631ef3bdc,0xbbfaad0500003c00,0xbb0537ae38613ab2,0x3bfa2d0500003c00,0x3904ba3c3a9c3882,0xbbfaad0500003c00,0xb47e3bae3bd5328d
.quad 0x3bfa2d0500003c00,0xaee6bbf43bdcb1ef,0xbbfaad0500003c00,0x37ae3b053ab2b861,0x3bfa2d0500003c00,0xba3cb9043882ba9c,0xbbfaad0500003c00,0x3bae347e328dbbd5
.quad 0x3bfa2d0500003c00,0xbbf42ee6b1efbbdc,0xbbfaad0500003c00,0x3b05b7aeb861bab2,0x3bfa2d0500003c00,0xb9043a3cba9cb882,0xbbfaad0500003c00,0x347ebbaebbd5b28d
.quad 0x3bfa2d0500003c00,0x2ee63bf4bbdc31ef,0xbbfaad0500003c00,0xb7aebb05bab23861,0x3bfa2d0500003c00,0x3a3c3904b8823a9c,0xbbfaad0500003c00,0xbbaeb47eb28d3bd5
.quad 0x3ba8b4a535d53b73,0x3b18b767383f3ac8,0xb78b3b0e3b543669,0x2da63bf83be4b151,0xb4a5bba83b73b5d5,0xbba2b4cb332abbcc,0x3b0e378b3669bb54,0x3923ba22ba85b8a3
.quad 0xbba834a5b5d5bb73,0x37673b18bac8383f,0x378bbb0ebb54b669,0xbbf82da631513be4,0x34a53ba8bb7335d5,0x34cbbba23bcc332a,0xbb0eb78bb6693b54,0x3a22392338a3ba85
.quad 0x3ba8b4a535d53b73,0xbb183767b83fbac8,0xb78b3b0e3b543669,0xada6bbf8bbe43151,0xb4a5bba83b73b5d5,0x3ba234cbb32a3bcc,0x3b0e378b3669bb54,0xb9233a223a8538a3
.quad 0xbba834a5b5d5bb73,0xb767bb183ac8b83f,0x378bbb0ebb54b669,0x3bf8ada6b151bbe4,0x34a53ba8bb7335d5,0xb4cb3ba2bbccb32a,0xbb0eb78bb6693b54,0xba22b923b8a33a85
.quad 0x3a48b8f4396e39e0,0x3941ba083a6d38c4,0x38f43a4839e0b96e,0x3b95351833c6bbc3,0xba4838f4b96eb9e0,0x2c653bfbbbea30b2,0xb8f4ba48b9e0396e,0xbb2a3720381d3add
.quad 0x3a48b8f4396e39e0,0xba08b94138c4ba6d,0x38f43a4839e0b96e,0x3518bb95bbc3b3c6,0xba4838f4b96eb9e0,0x3bfbac6530b23bea,0xb8f4ba48b9e0396e,0x37203b2a3addb81d
.quad 0x3a48b8f4396e39e0,0xb9413a08ba6db8c4,0x38f43a4839e0b96e,0xbb95b518b3c63bc3,0xba4838f4b96eb9e0,0xac65bbfb3beab0b2,0xb8f4ba48b9e0396e,0x3b2ab720b81dbadd
.quad 0x3a48b8f4396e39e0,0x3a083941b8c43a6d,0x38f43a4839e0b96e,0xb5183b953bc333c6,0xba4838f4b96eb9e0,0xbbfb2c65b0b2bbea,0xb8f4ba48b9e0396e,0xb720bb2abadd381d
.quad 0x380cbae73b3336fc,0x3564bb883bb83431,0x3bbeb40ab53ebb8f,0x395fb9edba55b8e4,0x3ae7380cb6fc3b33,0x3b3bb6d737f43af1,0x340a3bbe3b8fb53e,0x3bfeaa48b013bbef
.quad 0xb80c3ae7bb33b6fc,0x3b883564b4313bb8,0xbbbe340a353e3b8f,0x39ed395f38e4ba55,0xbae7b80c36fcbb33,0x36d73b3bbaf137f4,0xb40abbbebb8f353e,0x2a483bfe3befb013
.quad 0x380cbae73b3336fc,0xb5643b88bbb8b431,0x3bbeb40ab53ebb8f,0xb95f39ed3a5538e4,0x3ae7380cb6fc3b33,0xbb3b36d7b7f4baf1,0x340a3bbe3b8fb53e,0xbbfe2a4830133bef
.quad 0xb80c3ae7bb33b6fc,0xbb88b5643431bbb8,0xbbbe340a353e3b8f,0xb9edb95fb8e43a55,0xbae7b80c36fcbb33,0xb6d7bb3b3af1b7f4,0xb40abbbebb8f353e,0xaa48bbfebbef3013
.quad 0x3c00000000003c00,0x3bd9b23e323e3bd9,0xbc00800000003c00,0xbaa7387238723aa7,0x3c00000000003c00,0x3872baa73aa73872,0xbc00800000003c00,0xb23e3bd93bd9323e
.quad 0x3c00000000003c00,0xb23ebbd93bd9b23e,0xbc00800000003c00,0x38723aa73aa7b872,0x3c00000000003c00,0xbaa7b8723872baa7,0xbc00800000003c00,0x3bd9323e323ebbd9
.quad 0x3c00000000003c00,0xbbd9323eb23ebbd9,0xbc00800000003c00,0x3aa7b872b872baa7,0x3c00000000003c00,0xb8723aa7baa7b872,0xbc00800000003c00,0x323ebbd9bbd9b23e
.quad 0x3c00000000003c00,0x323e3bd9bbd9323e,0xbc00800000003c00,0xb872baa7baa73872,0x3c00000000003c00,0x3aa73872b8723aa7,0xbc00800000003c00,0xbbd9b23eb23e3bd9
.quad 0x3b64b61f361f3b64,0x3aa7b87238723aa7,0xb61f3b643b64361f,0x323e3bd93bd9b23e,0xb61fbb643b64b61f,0xbbd9b23e323ebbd9,0x3b64361f361fbb64,0x3872baa7baa7b872
.quad 0xbb64361fb61fbb64,0x38723aa7baa73872,0x361fbb64bb64b61f,0xbbd9323e323e3bd9,0x361f3b64bb64361f,0x323ebbd93bd9323e,0xbb64b61fb61f3b64,0x3aa738723872baa7
.quad 0x3b64b61f361f3b64,0xbaa73872b872baa7,0xb61f3b643b64361f,0xb23ebbd9bbd9323e,0xb61fbb643b64b61f,0x3bd9323eb23e3bd9,0x3b64361f361fbb64,0xb8723aa73aa73872
.quad 0xbb64361fb61fbb64,0xb872baa73aa7b872,0x361fbb64bb64b61f,0x3bd9b23eb23ebbd9,0x361f3b64bb64361f,0xb23e3bd9bbd9b23e,0xbb64b61fb61f3b64,0xbaa7b872b8723aa7
.quad 0x39a8b9a839a839a8,0x3872baa73aa73872,0x39a839a839a8b9a8,0x3bd9323e323ebbd9,0xb9a839a8b9a8b9a8,0x323e3bd9bbd9323e,0xb9a8b9a8b9a839a8,0xbaa7387238723aa7
.quad 0x39a8b9a839a839a8,0xbaa7b8723872baa7,0x39a839a839a8b9a8,0x323ebbd9bbd9b23e,0xb9a839a8b9a8b9a8,0x3bd9b23e323e3bd9,0xb9a8b9a8b9a839a8,0x38723aa73aa7b872
.quad 0x39a8b9a839a839a8,0xb8723aa7baa7b872,0x39a839a839a8b9a8,0xbbd9b23eb23e3bd9,0xb9a839a8b9a8b9a8,0xb23ebbd93bd9b23e,0xb9a8b9a8b9a839a8,0x3aa7b872b872baa7
.quad 0x39a8b9a839a839a8,0x3aa73872b8723aa7,0x39a839a839a8b9a8,0xb23e3bd93bd9323e,0xb9a839a8b9a8b9a8,0xbbd9323eb23ebbd9,0xb9a8b9a8b9a839a8,0xb872baa7baa73872
.quad 0x361fbb643b64361f,0x323ebbd93bd9323e,0x3b64b61fb61fbb64,0x3872baa7baa7b872,0x3b64361fb61f3b64,0x3aa7b87238723aa7,0x361f3b643b64b61f,0x3bd9b23eb23ebbd9
.quad 0xb61f3b64bb64b61f,0x3bd9323eb23e3bd9,0xbb64361f361f3b64,0x3aa738723872baa7,0xbb64b61f361fbb64,0x38723aa7baa73872,0xb61fbb64bb64361f,0x323e3bd93bd9b23e
.quad 0x361fbb643b64361f,0xb23e3bd9bbd9b23e,0x3b64b61fb61fbb64,0xb8723aa73aa73872,0x3b64361fb61f3b64,0xbaa73872b872baa7,0x361f3b643b64b61f,0xbbd9323e323e3bd9
.quad 0xb61f3b64bb64b61f,0xbbd9b23e323ebbd9,0xbb64361f361f3b64,0xbaa7b872b8723aa7,0xbb64b61f361fbb64,0xb872baa73aa7b872,0xb61fbb64bb64361f,0xb23ebbd9bbd9323e
.quad 0xbbfaad0580003c00,0xbbaeb47eb28d3bd5,0x3bfa2d0580003c00,0x3a3c3904b8823a9c,0xbbfaad0580003c00,0xb7aebb05bab23861,0x3bfa2d0580003c00,0x2ee63bf4bbdc31ef
.quad 0xbbfaad0580003c00,0x347ebbaebbd5b28d,0x3bfa2d0580003c00,0xb9043a3cba9cb882,0xbbfaad0580003c00,0x3b05b7aeb861bab2,0x3bfa2d0580003c00,0xbbf42ee6b1efbbdc
.quad 0xbbfaad0580003c00,0x3bae347e328dbbd5,0x3bfa2d0580003c00,0xba3cb9043882ba9c,0xbbfaad0580003c00,0x37ae3b053ab2b861,0x3bfa2d0580003c00,0xaee6bbf43bdcb1ef
.quad 0xbbfaad0580003c00,0xb47e3bae3bd5328d,0x3bfa2d0580003c00,0x3904ba3c3a9c3882,0xbbfaad0580003c00,0xbb0537ae38613ab2,0x3bfa2d0580003c00,0x3bf4aee631ef3bdc
.quad 0xbb0eb78bb6693b54,0xba22b923b8a33a85,0x34a53ba8bb7335d5,0xb4cb3ba2bbccb32a,0x378bbb0ebb54b669,0x3bf8ada6b151bbe4,0xbba834a5b5d5bb73,0xb767bb183ac8b83f
.quad 0x3b0e378b3669bb54,0xb9233a223a8538a3,0xb4a5bba83b73b5d5,0x3ba234cbb32a3bcc,0xb78b3b0e3b543669,0xada6bbf8bbe43151,0x3ba8b4a535d53b73,0xbb183767b83fbac8
.quad 0xbb0eb78bb6693b54,0x3a22392338a3ba85,0x34a53ba8bb7335d5,0x34cbbba23bcc332a,0x378bbb0ebb54b669,0xbbf82da631513be4,0xbba834a5b5d5bb73,0x37673b18bac8383f
.quad 0x3b0e378b3669bb54,0x3923ba22ba85b8a3,0xb4a5bba83b73b5d5,0xbba2b4cb332abbcc,0xb78b3b0e3b543669,0x2da63bf83be4b151,0x3ba8b4a535d53b73,0x3b18b767383f3ac8
.quad 0xb8f4ba48b9e0396e,0xb720bb2abadd381d,0xba4838f4b96eb9e0,0xbbfb2c65b0b2bbea,0x38f43a4839e0b96e,0xb5183b953bc333c6,0x3a48b8f4396e39e0,0x3a083941b8c43a6d
.quad 0xb8f4ba48b9e0396e,0x3b2ab720b81dbadd,0xba4838f4b96eb9e0,0xac65bbfb3beab0b2,0x38f43a4839e0b96e,0xbb95b518b3c63bc3,0x3a48b8f4396e39e0,0xb9413a08ba6db8c4
.quad 0xb8f4ba48b9e0396e,0x37203b2a3addb81d,0xba4838f4b96eb9e0,0x3bfbac6530b23bea,0x38f43a4839e0b96e,0x3518bb95bbc3b3c6,0x3a48b8f4396e39e0,0xba08b94138c4ba6d
.quad 0xb8f4ba48b9e0396e,0xbb2a3720381d3add,0xba4838f4b96eb9e0,0x2c653bfbbbea30b2,0x38f43a4839e0b96e,0x3b95351833c6bbc3,0x3a48b8f4396e39e0,0x3941ba083a6d38c4
.quad 0xb40abbbebb8f353e,0xaa48bbfebbef3013,0xbae7b80c36fcbb33,0xb6d7bb3b3af1b7f4,0xbbbe340a353e3b8f,0xb9edb95fb8e43a55,0xb80c3ae7bb33b6fc,0xbb88b5643431bbb8
.quad 0x340a3bbe3b8fb53e,0xbbfe2a4830133bef,0x3ae7380cb6fc3b33,0xbb3b36d7b7f4baf1,0x3bbeb40ab53ebb8f,0xb95f39ed3a5538e4,0x380cbae73b3336fc,0xb5643b88bbb8b431
.quad 0xb40abbbebb8f353e,0x2a483bfe3befb013,0xbae7b80c36fcbb33,0x36d73b3bbaf137f4,0xbbbe340a353e3b8f,0x39ed395f38e4ba55,0xb80c3ae7bb33b6fc,0x3b883564b4313bb8
.quad 0x340a3bbe3b8fb53e,0x3bfeaa48b013bbef,0x3ae7380cb6fc3b33,0x3b3bb6d737f43af1,0x3bbeb40ab53ebb8f,0x395fb9edba55b8e4,0x380cbae73b3336fc,0x3564bb883bb83431
.quad 0xbbe7b10280003c00,0xbb73b5d5b2dc3bd0,0x3be7310280003c00,0x39c4398bb8933a90,0xbbe7b10280003c00,0xb669bb54babd3850,0x3be7310280003c00,0x25073c00bbe031a0
.quad 0xbbe7b10280003c00,0x35d5bb73bbd0b2dc,0x3be7310280003c00,0xb98b39c4ba90b893,0xbbe7b10280003c00,0x3b54b669b850babd,0x3be7310280003c00,0xbc002507b1a0bbe0
.quad 0xbbe7b10280003c00,0x3b7335d532dcbbd0,0x3be7310280003c00,0xb9c4b98b3893ba90,0xbbe7b10280003c00,0x36693b543abdb850,0x3be7310280003c00,0xa507bc003be0b1a0
.quad 0xbbe7b10280003c00,0xb5d53b733bd032dc,0x3be7310280003c00,0x398bb9c43a903893,0xbbe7b10280003c00,0xbb54366938503abd,0x3be7310280003c00,0x3c00a50731a03be0
.quad 0xbaa7b872b6b33b44,0xb98bb9c4b8d43a61,0x323e3bd9bb81358a,0xb6693b54bbbeb40a,0x3872baa7bb44b6b3,0x3c002507b062bbed,0xbbd9323eb58abb81,0xb5d5bb733ae7b80c
.quad 0x3aa7387236b3bb44,0xb9c4398b3a6138d4,0xb23ebbd93b81b58a,0x3b543669b40a3bbe,0xb8723aa73b4436b3,0x2507bc00bbed3062,0x3bd9b23e358a3b81,0xbb7335d5b80cbae7
.quad 0xbaa7b872b6b33b44,0x398b39c438d4ba61,0x323e3bd9bb81358a,0x3669bb543bbe340a,0x3872baa7bb44b6b3,0xbc00a50730623bed,0xbbd9323eb58abb81,0x35d53b73bae7380c
.quad 0x3aa7387236b3bb44,0x39c4b98bba61b8d4,0xb23ebbd93b81b58a,0xbb54b669340abbbe,0xb8723aa73b4436b3,0xa5073c003bedb062,0x3bd9b23e358a3b81,0x3b73b5d5380c3ae7
.quad 0xb82ebad2ba153932,0xb53ebb8fbb0e378b,0xbad2382eb932ba15,0xbbfcab89ae46bbf6,0x382e3ad23a15b932,0xb6fc3b333ba834a5,0x3ad2b82e39323a15,0x395039fbb9133a2f
.quad 0xb82ebad2ba153932,0x3b8fb53eb78bbb0e,0xbad2382eb932ba15,0x2b89bbfc3bf6ae46,0x382e3ad23a15b932,0xbb33b6fcb4a53ba8,0x3ad2b82e39323a15,0xb9fb3950ba2fb913
.quad 0xb82ebad2ba153932,0x353e3b8f3b0eb78b,0xbad2382eb932ba15,0x3bfc2b892e463bf6,0x382e3ad23a15b932,0x36fcbb33bba8b4a5,0x3ad2b82e39323a15,0xb950b9fb3913ba2f
.quad 0xb82ebad2ba153932,0xbb8f353e378b3b0e,0xbad2382eb932ba15,0xab893bfcbbf62e46,0x382e3ad23a15b932,0x3b3336fc34a5bba8,0x3ad2b82e39323a15,0x39fbb9503a2f3913
.quad 0xaf86bbf2bbb33458,0x2e46bbf6bbfc2b89,0xba48b8f437d1bafb,0xb4a5bba83b33b6fc,0xbbf22f8634583bb3,0xb913ba2fb95039fb,0xb8f43a48bafbb7d1,0xbb0eb78b353ebb8f
.quad 0x2f863bf23bb3b458,0xbbf6ae462b893bfc,0x3a4838f4b7d13afb,0xbba834a5b6fcbb33,0x3bf2af86b458bbb3,0xba2f391339fb3950,0x38f4ba483afb37d1,0xb78b3b0ebb8fb53e
.quad 0xaf86bbf2bbb33458,0xae463bf63bfcab89,0xba48b8f437d1bafb,0x34a53ba8bb3336fc,0xbbf22f8634583bb3,0x39133a2f3950b9fb,0xb8f43a48bafbb7d1,0x3b0e378bb53e3b8f
.quad 0x2f863bf23bb3b458,0x3bf62e46ab89bbfc,0x3a4838f4b7d13afb,0x3ba8b4a536fc3b33,0x3bf2af86b458bbb3,0x3a2fb913b9fbb950,0x38f4ba483afb37d1,0x378bbb0e3b8f353e
.quad 0xbbc7b37880003c00,0xbb2ab720b32a3bcc,0x3bc7337880003c00,0x39413a08b8a33a85,0xbbc7b37880003c00,0xb518bb95bac8383f,0x3bc7337880003c00,0xac653bfbbbe43151
.quad 0xbbc7b37880003c00,0x3720bb2abbccb32a,0x3bc7337880003c00,0xba083941ba85b8a3,0xbbc7b37880003c00,0x3b95b518b83fbac8,0x3bc7337880003c00,0xbbfbac65b151bbe4
.quad 0xbbc7b37880003c00,0x3b2a3720332abbcc,0x3bc7337880003c00,0xb941ba0838a3ba85,0xbbc7b37880003c00,0x35183b953ac8b83f,0x3bc7337880003c00,0x2c65bbfb3be4b151
.quad 0xbbc7b37880003c00,0xb7203b2a3bcc332a,0x3bc7337880003c00,0x3a08b9413a8538a3,0xbbc7b37880003c00,0xbb953518383f3ac8,0x3bc7337880003c00,0x3bfb2c6531513be4
.quad 0xba2fb913b6fc3b33,0xb8e4ba55b9043a3c,0x2e463bf6bb8f353e,0xb7f43af1bbaeb47e,0x3913ba2fbb33b6fc,0x3bef3013aee6bbf4,0xbbf62e46b53ebb8f,0xb431bbb83b05b7ae
.quad 0x3a2f391336fcbb33,0xba5538e43a3c3904,0xae46bbf63b8fb53e,0x3af137f4b47e3bae,0xb9133a2f3b3336fc,0x3013bbefbbf42ee6,0x3bf6ae46353e3b8f,0xbbb83431b7aebb05
.quad 0xba2fb913b6fc3b33,0x38e43a553904ba3c,0x2e463bf6bb8f353e,0x37f4baf13bae347e,0x3913ba2fbb33b6fc,0xbbefb0132ee63bf4,0xbbf62e46b53ebb8f,0x34313bb8bb0537ae
.quad 0x3a2f391336fcbb33,0x3a55b8e4ba3cb904,0xae46bbf63b8fb53e,0xbaf1b7f4347ebbae,0xb9133a2f3b3336fc,0xb0133bef3bf4aee6,0x3bf6ae46353e3b8f,0x3bb8b43137ae3b05
.quad 0xb6b3bb44ba4838f4,0xb28dbbd5bb3b36d7,0xbb4436b3b8f4ba48,0xbbdcb1efaa48bbfe,0x36b33b443a48b8f4,0xb8613ab23b883564,0x3b44b6b338f43a48,0x38823a9cb95f39ed
.quad 0xb6b3bb44ba4838f4,0x3bd5b28db6d7bb3b,0xbb4436b3b8f4ba48,0x31efbbdc3bfeaa48,0x36b33b443a48b8f4,0xbab2b861b5643b88,0x3b44b6b338f43a48,0xba9c3882b9edb95f
.quad 0xb6b3bb44ba4838f4,0x328d3bd53b3bb6d7,0xbb4436b3b8f4ba48,0x3bdc31ef2a483bfe,0x36b33b443a48b8f4,0x3861bab2bb88b564,0x3b44b6b338f43a48,0xb882ba9c395fb9ed
.quad 0xb6b3bb44ba4838f4,0xbbd5328d36d73b3b,0xbb4436b3b8f4ba48,0xb1ef3bdcbbfe2a48,0x36b33b443a48b8f4,0x3ab238613564bb88,0x3b44b6b338f43a48,0x3a9cb88239ed395f
.quad 0x2507bc00bbd032dc,0x33c6bbc3bc00a107,0xb98bb9c43850babd,0xb0b2bbea3b6cb5fa,0xbc00a50732dc3bd0,0xb81dbaddb9b6399a,0xb9c4398bbabdb850,0xba6db8c43645bb5c
.quad 0xa5073c003bd0b2dc,0xbbc3b3c6a1073c00,0x398b39c4b8503abd,0xbbea30b2b5fabb6c,0x3c002507b2dcbbd0,0xbadd381d399a39b6,0x39c4b98b3abd3850,0xb8c43a6dbb5cb645
.quad 0x2507bc00bbd032dc,0xb3c63bc33c002107,0xb98bb9c43850babd,0x30b23beabb6c35fa,0xbc00a50732dc3bd0,0x381d3add39b6b99a,0xb9c4398bbabdb850,0x3a6d38c4b6453b5c
.quad 0xa5073c003bd0b2dc,0x3bc333c62107bc00,0x398b39c4b8503abd,0x3beab0b235fa3b6c,0x3c002507b2dcbbd0,0x3addb81db99ab9b6,0x39c4b98b3abd3850,0x38c4ba6d3b5c3645
.quad 0xbb9cb4f280003c00,0xbad2b82eb3783bc7,0x3b9c34f280003c00,0x38b43a79b8b43a79,0xbb9cb4f280003c00,0xb378bbc7bad2382e,0x3b9c34f280003c00,0xb1023be7bbe73102
.quad 0xbb9cb4f280003c00,0x382ebad2bbc7b378,0x3b9c34f280003c00,0xba7938b4ba79b8b4,0xbb9cb4f280003c00,0x3bc7b378b82ebad2,0x3b9c34f280003c00,0xbbe7b102b102bbe7
.quad 0xbb9cb4f280003c00,0x3ad2382e3378bbc7,0x3b9c34f280003c00,0xb8b4ba7938b4ba79,0xbb9cb4f280003c00,0x33783bc73ad2b82e,0x3b9c34f280003c00,0x3102bbe73be7b102
.quad 0xbb9cb4f280003c00,0xb82e3ad23bc73378,0x3b9c34f280003c00,0x3a79b8b43a7938b4,0xbb9cb4f280003c00,0xbbc73378382e3ad2,0x3b9c34f280003c00,0x3be7310231023be7
.quad 0xb9a8b9a8b7443b21,0xb82ebad2b9323a15,0x80003c00bb9c34f2,0xb8b43a79bb9cb4f2,0x39a8b9a8bb21b744,0x3bc73378ad05bbfa,0xbc000000b4f2bb9c,0xb102bbe73b21b744
.quad 0x39a839a83744bb21,0xbad2382e3a153932,0x8000bc003b9cb4f2,0x3a7938b4b4f23b9c,0xb9a839a83b213744,0x3378bbc7bbfa2d05,0x3c00800034f23b9c,0xbbe73102b744bb21
.quad 0xb9a8b9a8b7443b21,0x382e3ad23932ba15,0x80003c00bb9c34f2,0x38b4ba793b9c34f2,0x39a8b9a8bb21b744,0xbbc7b3782d053bfa,0xbc000000b4f2bb9c,0x31023be7bb213744
.quad 0x39a839a83744bb21,0x3ad2b82eba15b932,0x8000bc003b9cb4f2,0xba79b8b434f2bb9c,0xb9a839a83b213744,0xb3783bc73bfaad05,0x3c00800034f23b9c,0x3be7b10237443b21
.quad 0xb4f2bb9cba7938b4,0xad05bbfabb64361f,0xbb9c34f2b8b4ba79,0xbb9cb4f28000bc00,0x34f23b9c3a79b8b4,0xb9323a153b64361f,0x3b9cb4f238b43a79,0x37443b21b9a839a8
.quad 0xb4f2bb9cba7938b4,0x3bfaad05b61fbb64,0xbb9c34f2b8b4ba79,0x34f2bb9c3c008000,0x34f23b9c3a79b8b4,0xba15b932b61f3b64,0x3b9cb4f238b43a79,0xbb213744b9a8b9a8
.quad 0xb4f2bb9cba7938b4,0x2d053bfa3b64b61f,0xbb9c34f2b8b4ba79,0x3b9c34f280003c00,0x34f23b9c3a79b8b4,0x3932ba15bb64b61f,0x3b9cb4f238b43a79,0xb744bb2139a8b9a8
.quad 0xb4f2bb9cba7938b4,0xbbfa2d05361f3b64,0xbb9c34f2b8b4ba79,0xb4f23b9cbc000000,0x34f23b9c3a79b8b4,0x3a153932361fbb64,0x3b9cb4f238b43a79,0x3b21b74439a839a8
.quad 0x3102bbe7bbe73102,0x361fbb64bbfaad05,0xb8b4ba7938b4ba79,0x8000bc003b9cb4f2,0xbbe7b10231023be7,0xb61fbb64ba153932,0xba7938b4ba79b8b4,0xb9a8b9a83744bb21
.quad 0xb1023be73be7b102,0xbb64b61fad053bfa,0x38b43a79b8b43a79,0xbc000000b4f2bb9c,0x3be73102b102bbe7,0xbb64361f39323a15,0x3a79b8b43a7938b4,0xb9a839a8bb21b744
.quad 0x3102bbe7bbe73102,0xb61f3b643bfa2d05,0xb8b4ba7938b4ba79,0x80003c00bb9c34f2,0xbbe7b10231023be7,0x361f3b643a15b932,0xba7938b4ba79b8b4,0x39a839a8b7443b21
.quad 0xb1023be73be7b102,0x3b64361f2d05bbfa,0x38b43a79b8b43a79,0x3c00800034f23b9c,0x3be73102b102bbe7,0x3b64b61fb932ba15,0x3a79b8b43a7938b4,0x39a8b9a83b213744
.quad 0xbb64b61f80003c00,0xba6db8c4b3c63bc3,0x3b64361f80003c00,0x381d3addb8c43a6d,0xbb64b61f80003c00,0xb0b2bbeabadd381d,0x3b64361f80003c00,0xb3c63bc3bbea30b2
.quad 0xbb64b61f80003c00,0x38c4ba6dbbc3b3c6,0x3b64361f80003c00,0xbadd381dba6db8c4,0xbb64b61f80003c00,0x3beab0b2b81dbadd,0x3b64361f80003c00,0xbbc3b3c6b0b2bbea
.quad 0xbb64b61f80003c00,0x3a6d38c433c6bbc3,0x3b64361f80003c00,0xb81dbadd38c4ba6d,0xbb64b61f80003c00,0x30b23bea3addb81d,0x3b64361f80003c00,0x33c6bbc33beab0b2
.quad 0xbb64b61f80003c00,0xb8c43a6d3bc333c6,0x3b64361f80003c00,0x3addb81d3a6d38c4,0xbb64b61f80003c00,0xbbea30b2381d3add,0x3b64361f80003c00,0x3bc333c630b23bea
.quad 0xb913ba2fb78b3b0e,0xb6d7bb3bb95f39ed,0xae463bf6bba834a5,0xb95f39edbb88b564,0x3a2fb913bb0eb78b,0x3b883564aa48bbfe,0xbbf6ae46b4a5bba8,0xaa48bbfe3b3bb6d7
.quad 0x39133a2f378bbb0e,0xbb3b36d739ed395f,0x2e46bbf63ba8b4a5,0x39ed395fb5643b88,0xba2f39133b0e378b,0x3564bb88bbfe2a48,0x3bf62e4634a53ba8,0xbbfe2a48b6d7bb3b
.quad 0xb913ba2fb78b3b0e,0x36d73b3b395fb9ed,0xae463bf6bba834a5,0x395fb9ed3b883564,0x3a2fb913bb0eb78b,0xbb88b5642a483bfe,0xbbf6ae46b4a5bba8,0x2a483bfebb3b36d7
.quad 0x39133a2f378bbb0e,0x3b3bb6d7b9edb95f,0x2e46bbf63ba8b4a5,0xb9edb95f3564bb88,0xba2f39133b0e378b,0xb5643b883bfeaa48,0x3bf62e4634a53ba8,0x3bfeaa4836d73b3b
.quad 0xb23ebbd9baa73872,0x2a48bbfebb883564,0xbbd9323eb872baa7,0xbb3bb6d72a48bbfe,0x323e3bd93aa7b872,0xb9ed395f3b3b36d7,0x3bd9b23e38723aa7,0x35643b88b9ed395f
.quad 0xb23ebbd9baa73872,0x3bfe2a48b564bb88,0xbbd9323eb872baa7,0x36d7bb3b3bfe2a48,0x323e3bd93aa7b872,0xb95fb9edb6d73b3b,0x3bd9b23e38723aa7,0xbb883564b95fb9ed
.quad 0xb23ebbd9baa73872,0xaa483bfe3b88b564,0xbbd9323eb872baa7,0x3b3b36d7aa483bfe,0x323e3bd93aa7b872,0x39edb95fbb3bb6d7,0x3bd9b23e38723aa7,0xb564bb8839edb95f
.quad 0xb23ebbd9baa73872,0xbbfeaa4835643b88,0xbbd9323eb872baa7,0xb6d73b3bbbfeaa48,0x323e3bd93aa7b872,0x395f39ed36d7bb3b,0x3bd9b23e38723aa7,0x3b88b564395f39ed
.quad 0x34a5bba8bbf62e46,0x381dbaddbbeab0b2,0xb78bbb0e3913ba2f,0x30b2bbea3bc3b3c6,0xbba8b4a52e463bf6,0xb3c6bbc3ba6d38c4,0xbb0e378bba2fb913,0xb8c4ba6d381dbadd
.quad 0xb4a53ba83bf6ae46,0xbaddb81db0b23bea,0x378b3b0eb9133a2f,0xbbeab0b2b3c6bbc3,0x3ba834a5ae46bbf6,0xbbc333c638c43a6d,0x3b0eb78b3a2f3913,0xba6d38c4baddb81d
.quad 0x34a5bba8bbf62e46,0xb81d3add3bea30b2,0xb78bbb0e3913ba2f,0xb0b23beabbc333c6,0xbba8b4a52e463bf6,0x33c63bc33a6db8c4,0xbb0e378bba2fb913,0x38c43a6db81d3add
.quad 0xb4a53ba83bf6ae46,0x3add381d30b2bbea,0x378b3b0eb9133a2f,0x3bea30b233c63bc3,0x3ba834a5ae46bbf6,0x3bc3b3c6b8c4ba6d,0x3b0eb78b3a2f3913,0x3a6db8c43add381d
.quad 0xbb21b74480003c00,0xb9fbb950b40a3bbe,0x3b21374480003c00,0x36fc3b33b8d43a61,0xbb21b74480003c00,0xab89bbfcbae7380c,0x3b21374480003c00,0xb53e3b8fbbed3062
.quad 0xbb21b74480003c00,0x3950b9fbbbbeb40a,0x3b21374480003c00,0xbb3336fcba61b8d4,0xbb21b74480003c00,0x3bfcab89b80cbae7,0x3b21374480003c00,0xbb8fb53eb062bbed
.quad 0xbb21b74480003c00,0x39fb3950340abbbe,0x3b21374480003c00,0xb6fcbb3338d4ba61,0xbb21b74480003c00,0x2b893bfc3ae7b80c,0x3b21374480003c00,0x353ebb8f3bedb062
.quad 0xbb21b74480003c00,0xb95039fb3bbe340a,0x3b21374480003c00,0x3b33b6fc3a6138d4,0xbb21b74480003c00,0xbbfc2b89380c3ae7,0x3b21374480003c00,0x3b8f353e30623bed
.quad 0xb872baa7b7d13afb,0xb53ebb8fb98b39c4,0xb23e3bd9bbb33458,0xb9fb3950bb73b5d5,0x3aa7b872bafbb7d1,0x3b3336fca507bc00,0xbbd9b23eb458bbb3,0x2b89bbfc3b54b669
.quad 0x38723aa737d1bafb,0xbb8f353e39c4398b,0x323ebbd93bb3b458,0x395039fbb5d53b73,0xbaa738723afb37d1,0x36fcbb33bc002507,0x3bd9323e34583bb3,0xbbfcab89b669bb54
.quad 0xb872baa7b7d13afb,0x353e3b8f398bb9c4,0xb23e3bd9bbb33458,0x39fbb9503b7335d5,0x3aa7b872bafbb7d1,0xbb33b6fc25073c00,0xbbd9b23eb458bbb3,0xab893bfcbb543669
.quad 0x38723aa737d1bafb,0x3b8fb53eb9c4b98b,0x323ebbd93bb3b458,0xb950b9fb35d5bb73,0xbaa738723afb37d1,0xb6fc3b333c00a507,0x3bd9323e34583bb3,0x3bfc2b8936693b54
.quad 0xad05bbfabad2382e,0x31a0bbe0bba834a5,0xbbfa2d05b82ebad2,0xbabdb8502e46bbf6,0x2d053bfa3ad2b82e,0xba9038933b0e378b,0x3bfaad05382e3ad2,0x32dc3bd0ba2f3913
.quad 0xad05bbfabad2382e,0x3be031a0b4a5bba8,0xbbfa2d05b82ebad2,0x3850babd3bf62e46,0x2d053bfa3ad2b82e,0xb893ba90b78b3b0e,0x3bfaad05382e3ad2,0xbbd032dcb913ba2f
.quad 0xad05bbfabad2382e,0xb1a03be03ba8b4a5,0xbbfa2d05b82ebad2,0x3abd3850ae463bf6,0x2d053bfa3ad2b82e,0x3a90b893bb0eb78b,0x3bfaad05382e3ad2,0xb2dcbbd03a2fb913
.quad 0xad05bbfabad2382e,0xbbe0b1a034a53ba8,0xbbfa2d05b82ebad2,0xb8503abdbbf6ae46,0x2d053bfa3ad2b82e,0x38933a90378bbb0e,0x3bfaad05382e3ad2,0x3bd0b2dc39133a2f
.quad 0x36b3bb44bbfe2906,0x3913ba2fbbd0b2dc,0xb58abb81396eb9e0,0x34a5bba83be0b1a0,0xbb44b6b329063bfe,0xae46bbf6babd3850,0xbb81358ab9e0b96e,0xb78bbb0e3893ba90
.quad 0xb6b33b443bfea906,0xba2fb913b2dc3bd0,0x358a3b81b96e39e0,0xbba8b4a5b1a0bbe0,0x3b4436b3a906bbfe,0xbbf62e4638503abd,0x3b81b58a39e0396e,0xbb0e378bba90b893
.quad 0x36b3bb44bbfe2906,0xb9133a2f3bd032dc,0xb58abb81396eb9e0,0xb4a53ba8bbe031a0,0xbb44b6b329063bfe,0x2e463bf63abdb850,0xbb81358ab9e0b96e,0x378b3b0eb8933a90
.quad 0xb6b33b443bfea906,0x3a2f391332dcbbd0,0x358a3b81b96e39e0,0x3ba834a531a03be0,0x3b4436b3a906bbfe,0x3bf6ae46b850babd,0x3b81b58a39e0396e,0x3b0eb78b3a903893
.quad 0xbad2b82e80003c00,0xb97db9d2b4313bb8,0x3ad2382e80003c00,0x35af3b7ab8e43a55,0xbad2b82e80003c00,0x278abbffbaf137f4,0x3ad2382e80003c00,0xb68e3b4cbbef3013
.quad 0xbad2b82e80003c00,0x39d2b97dbbb8b431,0x3ad2382e80003c00,0xbb7a35afba55b8e4,0xbad2b82e80003c00,0x3bff278ab7f4baf1,0x3ad2382e80003c00,0xbb4cb68eb013bbef
.quad 0xbad2b82e80003c00,0x397d39d23431bbb8,0x3ad2382e80003c00,0xb5afbb7a38e4ba55,0xbad2b82e80003c00,0xa78a3bff3af1b7f4,0x3ad2382e80003c00,0x368ebb4c3befb013
.quad 0xbad2b82e80003c00,0xb9d2397d3bb83431,0x3ad2382e80003c00,0x3b7ab5af3a5538e4,0xbad2b82e80003c00,0xbbffa78a37f43af1,0x3ad2382e80003c00,0x3b4c368e30133bef
.quad 0xb78bbb0eb80c3ae7,0xb32abbccb9b6399a,0xb4a53ba8bbbe340a,0xba8538a3bb5cb645,0x3b0eb78bbae7b80c,0x3ac8383f2107bc00,0xbba8b4a5b40abbbe,0x3151bbe43b6cb5fa
.quad 0x378b3b0e380cbae7,0xbbcc332a399a39b6,0x34a5bba83bbeb40a,0x38a33a85b6453b5c,0xbb0e378b3ae7380c,0x383fbac8bc00a107,0x3ba834a5340a3bbe,0xbbe4b151b5fabb6c
.quad 0xb78bbb0eb80c3ae7,0x332a3bcc39b6b99a,0xb4a53ba8bbbe340a,0x3a85b8a33b5c3645,0x3b0eb78bbae7b80c,0xbac8b83fa1073c00,0xbba8b4a5b40abbbe,0xb1513be4bb6c35fa
.quad 0x378b3b0e380cbae7,0x3bccb32ab99ab9b6,0x34a5bba83bbeb40a,0xb8a3ba853645bb5c,0xbb0e378b3ae7380c,0xb83f3ac83c002107,0x3ba834a5340a3bbe,0x3be4315135fa3b6c
.quad 0x2906bbfebafb37d1,0x34cbbba2bbc333c6,0xbbfea906b7d1bafb,0xba22b92330b2bbea,0xa9063bfe3afbb7d1,0xbb1837673add381d,0x3bfe290637d13afb,0x2da63bf8ba6d38c4
.quad 0x2906bbfebafb37d1,0x3ba234cbb3c6bbc3,0xbbfea906b7d1bafb,0x3923ba223bea30b2,0xa9063bfe3afbb7d1,0xb767bb18b81d3add,0x3bfe290637d13afb,0xbbf82da6b8c4ba6d
.quad 0x2906bbfebafb37d1,0xb4cb3ba23bc3b3c6,0xbbfea906b7d1bafb,0x3a223923b0b23bea,0xa9063bfe3afbb7d1,0x3b18b767baddb81d,0x3bfe290637d13afb,0xada6bbf83a6db8c4
.quad 0x2906bbfebafb37d1,0xbba2b4cb33c63bc3,0xbbfea906b7d1bafb,0xb9233a22bbeab0b2,0xa9063bfe3afbb7d1,0x37673b18381dbadd,0x3bfe290637d13afb,0x3bf8ada638c43a6d
.quad 0x3850babdbc00a507,0x39edb95fbbaeb47e,0xb2dcbbd039c4b98b,0x36d7bb3b3bf4aee6,0xbabdb850a5073c00,0x2a48bbfebb0537ae,0xbbd032dcb98bb9c4,0xb564bb883904ba3c
.quad 0xb8503abd3c002507,0xb95fb9edb47e3bae,0x32dc3bd0b9c4398b,0xbb3bb6d7aee6bbf4,0x3abd38502507bc00,0xbbfeaa4837ae3b05,0x3bd0b2dc398b39c4,0xbb883564ba3cb904
.quad 0x3850babdbc00a507,0xb9ed395f3bae347e,0xb2dcbbd039c4b98b,0xb6d73b3bbbf42ee6,0xbabdb850a5073c00,0xaa483bfe3b05b7ae,0xbbd032dcb98bb9c4,0x35643b88b9043a3c
.quad 0xb8503abd3c002507,0x395f39ed347ebbae,0x32dc3bd0b9c4398b,0x3b3b36d72ee63bf4,0x3abd38502507bc00,0x3bfe2a48b7aebb05,0x3bd0b2dc398b39c4,0x3b88b5643a3c3904
.quad 0xba79b8b480003c00,0xb8f4ba48b4583bb3,0x3a7938b480003c00,0x34583bb3b8f43a48,0xba79b8b480003c00,0x2f86bbf2bafb37d1,0x3a7938b480003c00,0xb7d13afbbbf22f86
.quad 0xba79b8b480003c00,0x3a48b8f4bbb3b458,0x3a7938b480003c00,0xbbb33458ba48b8f4,0xba79b8b480003c00,0x3bf22f86b7d1bafb,0x3a7938b480003c00,0xbafbb7d1af86bbf2
.quad 0xba79b8b480003c00,0x38f43a483458bbb3,0x3a7938b480003c00,0xb458bbb338f4ba48,0xba79b8b480003c00,0xaf863bf23afbb7d1,0x3a7938b480003c00,0x37d1bafb3bf2af86
.quad 0xba79b8b480003c00,0xba4838f43bb33458,0x3a7938b480003c00,0x3bb3b4583a4838f4,0xba79b8b480003c00,0xbbf2af8637d13afb,0x3a7938b480003c00,0x3afb37d12f863bf2
.quad 0xb61fbb64b82e3ad2,0xaf86bbf2b9e0396e,0xb61f3b64bbc73378,0xbafb37d1bb44b6b3,0x3b64b61fbad2b82e,0x3a4838f42906bbfe,0xbb64b61fb378bbc7,0x3458bbb33b81b58a
.quad 0x361f3b64382ebad2,0xbbf22f86396e39e0,0x361fbb643bc7b378,0x37d13afbb6b33b44,0xbb64361f3ad2382e,0x38f4ba48bbfea906,0x3b64361f33783bc7,0xbbb3b458b58abb81
.quad 0xb61fbb64b82e3ad2,0x2f863bf239e0b96e,0xb61f3b64bbc73378,0x3afbb7d13b4436b3,0x3b64b61fbad2b82e,0xba48b8f4a9063bfe,0xbb64b61fb378bbc7,0xb4583bb3bb81358a
.quad 0x361f3b64382ebad2,0x3bf2af86b96eb9e0,0x361fbb643bc7b378,0xb7d1bafb36b3bb44,0xbb64361f3ad2382e,0xb8f43a483bfe2906,0x3b64361f33783bc7,0x3bb33458358a3b81
.quad 0x3102bbe7bb213744,0x36b3bb44bbd9323e,0xbbe7b102b744bb21,0xb96eb9e0323ebbd9,0xb1023be73b21b744,0xbb81358a3aa73872,0x3be7310237443b21,0xa9063bfebaa73872
.quad 0x3102bbe7bb213744,0x3b4436b3b23ebbd9,0xbbe7b102b744bb21,0x39e0b96e3bd9323e,0xb1023be73b21b744,0xb58abb81b8723aa7,0x3be7310237443b21,0xbbfea906b872baa7
.quad 0x3102bbe7bb213744,0xb6b33b443bd9b23e,0xbbe7b102b744bb21,0x396e39e0b23e3bd9,0xb1023be73b21b744,0x3b81b58abaa7b872,0x3be7310237443b21,0x2906bbfe3aa7b872
.quad 0x3102bbe7bb213744,0xbb44b6b3323e3bd9,0xbbe7b102b744bb21,0xb9e0396ebbd9b23e,0xb1023be73b21b744,0x358a3b813872baa7,0x3be7310237443b21,0x3bfe290638723aa7
.quad 0x3932ba15bbfaad05,0x3aa7b872bb81b58a,0xad05bbfa3a15b932,0x3872baa73bfea906,0xba15b932ad053bfa,0x323ebbd9bb4436b3,0xbbfa2d05b932ba15,0xb23ebbd9396eb9e0
.quad 0xb9323a153bfa2d05,0xb872baa7b58a3b81,0x2d053bfaba153932,0xbaa7b872a906bbfe,0x3a1539322d05bbfa,0xbbd9b23e36b33b44,0x3bfaad0539323a15,0xbbd9323eb9e0b96e
.quad 0x3932ba15bbfaad05,0xbaa738723b81358a,0xad05bbfa3a15b932,0xb8723aa7bbfe2906,0xba15b932ad053bfa,0xb23e3bd93b44b6b3,0xbbfa2d05b932ba15,0x323e3bd9b96e39e0
.quad 0xb9323a153bfa2d05,0x38723aa7358abb81,0x2d053bfaba153932,0x3aa7387229063bfe,0x3a1539322d05bbfa,0x3bd9323eb6b3bb44,0x3bfaad0539323a15,0x3bd9b23e39e0396e
.quad 0xba15b93280003c00,0xb861bab2b47e3bae,0x3a15393280003c00,0x31ef3bdcb9043a3c,0xba15b93280003c00,0x328dbbd5bb0537ae,0x3a15393280003c00,0xb8823a9cbbf42ee6
.quad 0xba15b93280003c00,0x3ab2b861bbaeb47e,0x3a15393280003c00,0xbbdc31efba3cb904,0xba15b93280003c00,0x3bd5328db7aebb05,0x3a15393280003c00,0xba9cb882aee6bbf4
.quad 0xba15b93280003c00,0x38613ab2347ebbae,0x3a15393280003c00,0xb1efbbdc3904ba3c,0xba15b93280003c00,0xb28d3bd53b05b7ae,0x3a15393280003c00,0x3882ba9c3bf4aee6
.quad 0xba15b93280003c00,0xbab238613bae347e,0x3a15393280003c00,0x3bdcb1ef3a3c3904,0xba15b93280003c00,0xbbd5b28d37ae3b05,0x3a15393280003c00,0x3a9c38822ee63bf4
.quad 0xb4a5bba8b8503abd,0xa107bc00ba083941,0xb78b3b0ebbd032dc,0xbb5c3645bb2ab720,0x3ba8b4a5babdb850,0x39b6399a2c65bbfb,0xbb0eb78bb2dcbbd0,0x35fabb6c3b95b518
.quad 0x34a53ba83850babd,0xbc00210739413a08,0x378bbb0e3bd0b2dc,0x36453b5cb7203b2a,0xbba834a53abd3850,0x399ab9b6bbfbac65,0x3b0e378b32dc3bd0,0xbb6cb5fab518bb95
.quad 0xb4a5bba8b8503abd,0x21073c003a08b941,0xb78b3b0ebbd032dc,0x3b5cb6453b2a3720,0x3ba8b4a5babdb850,0xb9b6b99aac653bfb,0xbb0eb78bb2dcbbd0,0xb5fa3b6cbb953518
.quad 0x34a53ba83850babd,0x3c00a107b941ba08,0x378bbb0e3bd0b2dc,0xb645bb5c3720bb2a,0xbba834a53abd3850,0xb99a39b63bfb2c65,0x3b0e378b32dc3bd0,0x3b6c35fa35183b95
.quad 0x3458bbb3bb4436b3,0x383fbac8bbea30b2,0xbbb3b458b6b3bb44,0xb8a3ba8533c6bbc3,0xb4583bb33b44b6b3,0xbbcc332a3a6d38c4,0x3bb3345836b33b44,0xb1513be4badd381d
.quad 0x3458bbb3bb4436b3,0x3ac8383fb0b2bbea,0xbbb3b458b6b3bb44,0x3a85b8a33bc333c6,0xb4583bb33b44b6b3,0xb32abbccb8c43a6d,0x3bb3345836b33b44,0xbbe4b151b81dbadd
.quad 0x3458bbb3bb4436b3,0xb83f3ac83beab0b2,0xbbb3b458b6b3bb44,0x38a33a85b3c63bc3,0xb4583bb33b44b6b3,0x3bccb32aba6db8c4,0x3bb3345836b33b44,0x3151bbe43addb81d
.quad 0x3458bbb3bb4436b3,0xbac8b83f30b23bea,0xbbb3b458b6b3bb44,0xba8538a3bbc3b3c6,0xb4583bb33b44b6b3,0x332a3bcc38c4ba6d,0x3bb3345836b33b44,0x3be43151381d3add
.quad 0x39fbb950bbedb062,0x3b3bb6d7bb4cb68e,0x2b89bbfc3a61b8d4,0x395fb9ed3bff278a,0xb950b9fbb0623bed,0x3564bb88bb7a35af,0xbbfcab89b8d4ba61,0xaa48bbfe39d2b97d
.quad 0xb9fb39503bed3062,0xb6d7bb3bb68e3b4c,0xab893bfcba6138d4,0xb9edb95f278abbff,0x395039fb3062bbed,0xbb88b56435af3b7a,0x3bfc2b8938d43a61,0xbbfe2a48b97db9d2
.quad 0x39fbb950bbedb062,0xbb3b36d73b4c368e,0x2b89bbfc3a61b8d4,0xb95f39edbbffa78a,0xb950b9fbb0623bed,0xb5643b883b7ab5af,0xbbfcab89b8d4ba61,0x2a483bfeb9d2397d
.quad 0xb9fb39503bed3062,0x36d73b3b368ebb4c,0xab893bfcba6138d4,0x39ed395fa78a3bff,0x395039fb3062bbed,0x3b883564b5afbb7a,0x3bfc2b8938d43a61,0x3bfeaa48397d39d2
.quad 0xb9a8b9a880003c00,0xb78bbb0eb4a53ba8,0x39a839a880003c00,0x2e463bf6b9133a2f,0xb9a8b9a880003c00,0x34a5bba8bb0e378b,0x39a839a880003c00,0xb9133a2fbbf62e46
.quad 0xb9a8b9a880003c00,0x3b0eb78bbba8b4a5,0x39a839a880003c00,0xbbf62e46ba2fb913,0xb9a8b9a880003c00,0x3ba834a5b78bbb0e,0x39a839a880003c00,0xba2fb913ae46bbf6
.quad 0xb9a8b9a880003c00,0x378b3b0e34a5bba8,0x39a839a880003c00,0xae46bbf63913ba2f,0xb9a8b9a880003c00,0xb4a53ba83b0eb78b,0x39a839a880003c00,0x3913ba2f3bf6ae46
.quad 0xb9a8b9a880003c00,0xbb0e378b3ba834a5,0x39a839a880003c00,0x3bf6ae463a2f3913,0xb9a8b9a880003c00,0xbba8b4a5378b3b0e,0x39a839a880003c00,0x3a2f39132e463bf6
.quad 0xb23ebbd9b8723aa7,0x2e46bbf6ba2f3913,0xb8723aa7bbd9323e,0xbba834a5bb0eb78b,0x3bd9b23ebaa7b872,0x39133a2f2e46bbf6,0xbaa7b872b23ebbd9,0x378bbb0e3ba8b4a5
.quad 0x323e3bd93872baa7,0xbbf6ae4639133a2f,0x3872baa73bd9b23e,0x34a53ba8b78b3b0e,0xbbd9323e3aa73872,0x3a2fb913bbf6ae46,0x3aa73872323e3bd9,0xbb0eb78bb4a5bba8
.quad 0xb23ebbd9b8723aa7,0xae463bf63a2fb913,0xb8723aa7bbd9323e,0x3ba8b4a53b0e378b,0x3bd9b23ebaa7b872,0xb913ba2fae463bf6,0xbaa7b872b23ebbd9,0xb78b3b0ebba834a5
.quad 0x323e3bd93872baa7,0x3bf62e46b913ba2f,0x3872baa73bd9b23e,0xb4a5bba8378bbb0e,0xbbd9323e3aa73872,0xba2f39133bf62e46,0x3aa73872323e3bd9,0x3b0e378b34a53ba8
.quad 0x361fbb64bb64361f,0x3913ba2fbbf62e46,0xbb64b61fb61fbb64,0xb78bbb0e34a5bba8,0xb61f3b643b64b61f,0xbbf62e463a2f3913,0x3b64361f361f3b64,0xb4a53ba8bb0e378b
.quad 0x361fbb64bb64361f,0x3a2f3913ae46bbf6,0xbb64b61fb61fbb64,0x3b0eb78b3ba834a5,0xb61f3b643b64b61f,0xae46bbf6b9133a2f,0x3b64361f361f3b64,0xbba8b4a5b78bbb0e
.quad 0x361fbb64bb64361f,0xb9133a2f3bf6ae46,0xbb64b61fb61fbb64,0x378b3b0eb4a53ba8,0xb61f3b643b64b61f,0x3bf6ae46ba2fb913,0x3b64361f361f3b64,0x34a5bba83b0eb78b
.quad 0x361fbb64bb64361f,0xba2fb9132e463bf6,0xbb64b61fb61fbb64,0xbb0e378bbba8b4a5,0xb61f3b643b64b61f,0x2e463bf63913ba2f,0x3b64361f361f3b64,0x3ba834a5378b3b0e
.quad 0x3aa7b872bbd9b23e,0x3ba8b4a5bb0eb78b,0x323ebbd93aa7b872,0x3a2fb9133bf62e46,0xb872baa7b23e3bd9,0x378bbb0ebba834a5,0xbbd9b23eb872baa7,0x2e46bbf63a2fb913
.quad 0xbaa738723bd9323e,0xb4a5bba8b78b3b0e,0xb23e3bd9baa73872,0xb913ba2f2e46bbf6,0x38723aa7323ebbd9,0xbb0eb78b34a53ba8,0x3bd9323e38723aa7,0xbbf6ae46b913ba2f
.quad 0x3aa7b872bbd9b23e,0xbba834a53b0e378b,0x323ebbd93aa7b872,0xba2f3913bbf6ae46,0xb872baa7b23e3bd9,0xb78b3b0e3ba8b4a5,0xbbd9b23eb872baa7,0xae463bf6ba2f3913
.quad 0xbaa738723bd9323e,0x34a53ba8378bbb0e,0xb23e3bd9baa73872,0x39133a2fae463bf6,0x38723aa7323ebbd9,0x3b0e378bb4a5bba8,0x3bd9323e38723aa7,0x3bf62e4639133a2f
.quad 0xb932ba1580003c00,0xb645bb5cb4cb3ba2,0x39323a1580003c00,0x21073c00b9233a22,0xb932ba1580003c00,0x35fabb6cbb183767,0x39323a1580003c00,0xb99a39b6bbf82da6
.quad 0xb932ba1580003c00,0x3b5cb645bba2b4cb,0x39323a1580003c00,0xbc002107ba22b923,0xb932ba1580003c00,0x3b6c35fab767bb18,0x39323a1580003c00,0xb9b6b99aada6bbf8
.quad 0xb932ba1580003c00,0x36453b5c34cbbba2,0x39323a1580003c00,0xa107bc003923ba22,0xb932ba1580003c00,0xb5fa3b6c3b18b767,0x39323a1580003c00,0x399ab9b63bf8ada6
.quad 0xb932ba1580003c00,0xbb5c36453ba234cb,0x39323a1580003c00,0x3c00a1073a223923,0xb932ba1580003c00,0xbb6cb5fa37673b18,0x39323a1580003c00,0x39b6399a2da63bf8
.quad 0xae46bbf6b8933a90,0x328dbbd5ba5538e4,0xb9133a2fbbe031a0,0xbbdc31efbaf1b7f4,0x3bf6ae46ba90b893,0x38613ab23013bbef,0xba2fb913b1a0bbe0,0x3882ba9c3bb8b431
.quad 0x2e463bf63893ba90,0xbbd5b28d38e43a55,0x3913ba2f3be0b1a0,0x31ef3bdcb7f43af1,0xbbf62e463a903893,0x3ab2b861bbefb013,0x3a2f391331a03be0,0xba9cb882b431bbb8
.quad 0xae46bbf6b8933a90,0xb28d3bd53a55b8e4,0xb9133a2fbbe031a0,0x3bdcb1ef3af137f4,0x3bf6ae46ba90b893,0xb861bab2b0133bef,0xba2fb913b1a0bbe0,0xb8823a9cbbb83431
.quad 0x2e463bf63893ba90,0x3bd5328db8e4ba55,0x3913ba2f3be0b1a0,0xb1efbbdc37f4baf1,0xbbf62e463a903893,0xbab238613bef3013,0x3a2f391331a03be0,0x3a9c388234313bb8
.quad 0x37d1bafbbb81358a,0x39d2b97dbbfe2a48,0xbafbb7d1b58abb81,0xb5afbb7a3564bb88,0xb7d13afb3b81b58a,0xbbffa78a39ed395f,0x3afb37d1358a3b81,0xb68e3b4cbb3b36d7
.quad 0x37d1bafbbb81358a,0x397d39d2aa48bbfe,0xbafbb7d1b58abb81,0x3b7ab5af3b883564,0xb7d13afb3b81b58a,0x278abbffb95f39ed,0x3afb37d1358a3b81,0xbb4cb68eb6d7bb3b
.quad 0x37d1bafbbb81358a,0xb9d2397d3bfeaa48,0xbafbb7d1b58abb81,0x35af3b7ab5643b88,0xb7d13afb3b81b58a,0x3bff278ab9edb95f,0x3afb37d1358a3b81,0x368ebb4c3b3bb6d7
.quad 0x37d1bafbbb81358a,0xb97db9d22a483bfe,0xbafbb7d1b58abb81,0xbb7a35afbb88b564,0xb7d13afb3b81b58a,0xa78a3bff395fb9ed,0x3afb37d1358a3b81,0x3b4c368e36d73b3b
.quad 0x3b33b6fcbbbeb40a,0x3beab0b2bac8b83f,0x353ebb8f3ae7b80c,0x3addb81d3be43151,0xb6fcbb33b40a3bbe,0x38c4ba6dbbcc332a,0xbb8fb53eb80cbae7,0x33c6bbc33a85b8a3
.quad 0xbb3336fc3bbe340a,0xb0b2bbeab83f3ac8,0xb53e3b8fbae7380c,0xb81dbadd3151bbe4,0x36fc3b33340abbbe,0xba6db8c4332a3bcc,0x3b8f353e380c3ae7,0xbbc3b3c6b8a3ba85
.quad 0x3b33b6fcbbbeb40a,0xbbea30b23ac8383f,0x353ebb8f3ae7b80c,0xbadd381dbbe4b151,0xb6fcbb33b40a3bbe,0xb8c43a6d3bccb32a,0xbb8fb53eb80cbae7,0xb3c63bc3ba8538a3
.quad 0xbb3336fc3bbe340a,0x30b23bea383fbac8,0xb53e3b8fbae7380c,0x381d3addb1513be4,0x36fc3b33340abbbe,0x3a6d38c4b32abbcc,0x3b8f353e380c3ae7,0x3bc333c638a33a85
.quad 0xb8b4ba7980003c00,0xb4f2bb9cb4f23b9c,0x38b43a7980003c00,0xad053bfab9323a15,0xb8b4ba7980003c00,0x3744bb21bb213744,0x38b43a7980003c00,0xba153932bbfa2d05
.quad 0xb8b4ba7980003c00,0x3b9cb4f2bb9cb4f2,0x38b43a7980003c00,0xbbfaad05ba15b932,0xb8b4ba7980003c00,0x3b213744b744bb21,0x38b43a7980003c00,0xb932ba15ad05bbfa
.quad 0xb8b4ba7980003c00,0x34f23b9c34f2bb9c,0x38b43a7980003c00,0x2d05bbfa3932ba15,0xb8b4ba7980003c00,0xb7443b213b21b744,0x38b43a7980003c00,0x3a15b9323bfaad05
.quad 0xb8b4ba7980003c00,0xbb9c34f23b9c34f2,0x38b43a7980003c00,0x3bfa2d053a153932,0xb8b4ba7980003c00,0xbb21b74437443b21,0x38b43a7980003c00,0x39323a152d053bfa
.quad 0x8000bc00b8b43a79,0x34f2bb9cba7938b4,0xb9a839a8bbe73102,0xbbfa2d05bad2b82e,0x3c008000ba79b8b4,0x37443b213102bbe7,0xb9a8b9a8b102bbe7,0x3932ba153bc7b378
.quad 0x80003c0038b4ba79,0xbb9cb4f238b43a79,0x39a8b9a83be7b102,0x2d053bfab82e3ad2,0xbc0000003a7938b4,0x3b21b744bbe7b102,0x39a839a831023be7,0xba15b932b378bbc7
.quad 0x8000bc00b8b43a79,0xb4f23b9c3a79b8b4,0xb9a839a8bbe73102,0x3bfaad053ad2382e,0x3c008000ba79b8b4,0xb744bb21b1023be7,0xb9a8b9a8b102bbe7,0xb9323a15bbc73378
.quad 0x80003c0038b4ba79,0x3b9c34f2b8b4ba79,0x39a8b9a83be7b102,0xad05bbfa382ebad2,0xbc0000003a7938b4,0xbb2137443be73102,0x39a839a831023be7,0x3a15393233783bc7
.quad 0x38b4ba79bb9c34f2,0x3a79b8b4bc000000,0xba79b8b4b4f2bb9c,0xb378bbc7361fbb64,0xb8b43a793b9cb4f2,0xbbe7b10239a839a8,0x3a7938b434f23b9c,0xb82e3ad2bb64361f
.quad 0x38b4ba79bb9c34f2,0x38b43a798000bc00,0xba79b8b4b4f2bb9c,0x3bc7b3783b64361f,0xb8b43a793b9cb4f2,0x3102bbe7b9a839a8,0x3a7938b434f23b9c,0xbad2b82eb61fbb64
.quad 0x38b4ba79bb9c34f2,0xba7938b43c008000,0xba79b8b4b4f2bb9c,0x33783bc7b61f3b64,0xb8b43a793b9cb4f2,0x3be73102b9a8b9a8,0x3a7938b434f23b9c,0x382ebad23b64b61f
.quad 0x38b4ba79bb9c34f2,0xb8b4ba7980003c00,0xba79b8b4b4f2bb9c,0xbbc73378bb64b61f,0xb8b43a793b9cb4f2,0xb1023be739a8b9a8,0x3a7938b434f23b9c,0x3ad2382e361f3b64
.quad 0x3b9cb4f2bb9cb4f2,0x3c008000ba79b8b4,0x3744bb213b21b744,0x3b64b61f3bc73378,0xb4f2bb9cb4f23b9c,0x39a8b9a8bbe73102,0xbb21b744b744bb21,0x361fbb643ad2b82e
.quad 0xbb9c34f23b9c34f2,0x8000bc00b8b43a79,0xb7443b21bb213744,0xb61fbb643378bbc7,0x34f23b9c34f2bb9c,0xb9a8b9a831023be7,0x3b21374437443b21,0xbb64b61fb82ebad2
.quad 0x3b9cb4f2bb9cb4f2,0xbc0000003a7938b4,0x3744bb213b21b744,0xbb64361fbbc7b378,0xb4f2bb9cb4f23b9c,0xb9a839a83be7b102,0xbb21b744b744bb21,0xb61f3b64bad2382e
.quad 0xbb9c34f23b9c34f2,0x80003c0038b4ba79,0xb7443b21bb213744,0x361f3b64b3783bc7,0x34f23b9c34f2bb9c,0x39a839a8b102bbe7,0x3b21374437443b21,0x3b64361f382e3ad2
.quad 0xb82ebad280003c00,0xb32abbccb5183b95,0x382e3ad280003c00,0xb1513be4b9413a08,0xb82ebad280003c00,0x383fbac8bb2a3720,0x382e3ad280003c00,0xba8538a3bbfb2c65
.quad 0xb82ebad280003c00,0x3bccb32abb95b518,0x382e3ad280003c00,0xbbe4b151ba08b941,0xb82ebad280003c00,0x3ac8383fb720bb2a,0x382e3ad280003c00,0xb8a3ba85ac65bbfb
.quad 0xb82ebad280003c00,0x332a3bcc3518bb95,0x382e3ad280003c00,0x3151bbe43941ba08,0xb82ebad280003c00,0xb83f3ac83b2ab720,0x382e3ad280003c00,0x3a85b8a33bfbac65
.quad 0xb82ebad280003c00,0xbbcc332a3b953518,0x382e3ad280003c00,0x3be431513a083941,0xb82ebad280003c00,0xbac8b83f37203b2a,0x382e3ad280003c00,0x38a33a852c653bfb
.quad 0x2e46bbf6b8d43a61,0x368ebb4cba9c3882,0xba2f3913bbed3062,0xbbffa78abab2b861,0x3bf62e46ba61b8d4,0x35af3b7a31efbbdc,0xb913ba2fb062bbed,0x39d2b97d3bd5b28d
.quad 0xae463bf638d4ba61,0xbb4cb68e38823a9c,0x3a2fb9133bedb062,0xa78a3bffb8613ab2,0xbbf6ae463a6138d4,0x3b7ab5afbbdcb1ef,0x39133a2f30623bed,0xb97db9d2b28dbbd5
.quad 0x2e46bbf6b8d43a61,0xb68e3b4c3a9cb882,0xba2f3913bbed3062,0x3bff278a3ab23861,0x3bf62e46ba61b8d4,0xb5afbb7ab1ef3bdc,0xb913ba2fb062bbed,0xb9d2397dbbd5328d
.quad 0xae463bf638d4ba61,0x3b4c368eb882ba9c,0x3a2fb9133bedb062,0x278abbff3861bab2,0xbbf6ae463a6138d4,0xbb7a35af3bdc31ef,0x39133a2f30623bed,0x397d39d2328d3bd5
.quad 0x396eb9e0bbb33458,0x3b05b7aebbfeaa48,0xb9e0b96eb458bbb3,0xaee6bbf436d7bb3b,0xb96e39e03bb3b458,0xbbaeb47e395f39ed,0x39e0396e34583bb3,0xb9043a3cbb883564
.quad 0x396eb9e0bbb33458,0x37ae3b052a48bbfe,0xb9e0b96eb458bbb3,0x3bf4aee63b3b36d7,0xb96e39e03bb3b458,0x347ebbaeb9ed395f,0x39e0396e34583bb3,0xba3cb904b564bb88
.quad 0x396eb9e0bbb33458,0xbb0537ae3bfe2a48,0xb9e0b96eb458bbb3,0x2ee63bf4b6d73b3b,0xb96e39e03bb3b458,0x3bae347eb95fb9ed,0x39e0396e34583bb3,0x3904ba3c3b88b564
.quad 0x396eb9e0bbb33458,0xb7aebb05aa483bfe,0xb9e0b96eb458bbb3,0xbbf42ee6bb3bb6d7,0xb96e39e03bb3b458,0xb47e3bae39edb95f,0x39e0396e34583bb3,0x3a3c390435643b88
.quad 0x3be0b1a0bb73b5d5,0x3bea30b2ba22b923,0x3893ba903b54b669,0x3bc3b3c63ba234cb,0xb1a0bbe0b5d53b73,0x3a6db8c4bbf82da6,0xba90b893b669bb54,0x381dbadd3b18b767
.quad 0xbbe031a03b7335d5,0x30b2bbeab9233a22,0xb8933a90bb543669,0xb3c6bbc334cbbba2,0x31a03be035d5bb73,0xb8c4ba6d2da63bf8,0x3a90389336693b54,0xbaddb81db767bb18
.quad 0x3be0b1a0bb73b5d5,0xbbeab0b23a223923,0x3893ba903b54b669,0xbbc333c6bba2b4cb,0xb1a0bbe0b5d53b73,0xba6d38c43bf8ada6,0xba90b893b669bb54,0xb81d3addbb183767
.quad 0xbbe031a03b7335d5,0xb0b23bea3923ba22,0xb8933a90bb543669,0x33c63bc3b4cb3ba2,0x31a03be035d5bb73,0x38c43a6dada6bbf8,0x3a90389336693b54,0x3add381d37673b18
.quad 0xb744bb2180003c00,0xb062bbedb53e3b8f,0x37443b2180003c00,0xb40a3bbeb95039fb,0xb744bb2180003c00,0x38d4ba61bb3336fc,0x37443b2180003c00,0xbae7380cbbfc2b89
.quad 0xb744bb2180003c00,0x3bedb062bb8fb53e,0x37443b2180003c00,0xbbbeb40ab9fbb950,0xb744bb2180003c00,0x3a6138d4b6fcbb33,0x37443b2180003c00,0xb80cbae7ab89bbfc
.quad 0xb744bb2180003c00,0x30623bed353ebb8f,0x37443b2180003c00,0x340abbbe3950b9fb,0xb744bb2180003c00,0xb8d43a613b33b6fc,0x37443b2180003c00,0x3ae7b80c3bfcab89
.quad 0xb744bb2180003c00,0xbbed30623b8f353e,0x37443b2180003c00,0x3bbe340a39fb3950,0xb744bb2180003c00,0xba61b8d436fc3b33,0x37443b2180003c00,0x380c3ae72b893bfc
.quad 0x323ebbd9b8f43a48,0x380cbae7babd3850,0xbaa73872bbf22f86,0xbbedb062ba90b893,0x3bd9323eba48b8f4,0x340a3bbe32dcbbd0,0xb872baa7af86bbf2,0x3a61b8d43be0b1a0
.quad 0xb23e3bd938f4ba48,0xbae7b80c38503abd,0x3aa7b8723bf2af86,0xb0623bedb8933a90,0xbbd9b23e3a4838f4,0x3bbeb40abbd0b2dc,0x38723aa72f863bf2,0xb8d4ba61b1a0bbe0
.quad 0x323ebbd9b8f43a48,0xb80c3ae73abdb850,0xbaa73872bbf22f86,0x3bed30623a903893,0x3bd9323eba48b8f4,0xb40abbbeb2dc3bd0,0xb872baa7af86bbf2,0xba6138d4bbe031a0
.quad 0xb23e3bd938f4ba48,0x3ae7380cb850babd,0x3aa7b8723bf2af86,0x3062bbed3893ba90,0xbbd9b23e3a4838f4,0xbbbe340a3bd032dc,0x38723aa72f863bf2,0x38d43a6131a03be0
.quad 0x3a15b932bbc73378,0x3b73b5d5bbf6ae46,0xb932ba15b378bbc7,0x2507bc00378bbb0e,0xba1539323bc7b378,0xbb54b66939133a2f,0x39323a1533783bc7,0xb9c4398bbba834a5
.quad 0x3a15b932bbc73378,0x35d53b732e46bbf6,0xb932ba15b378bbc7,0x3c0025073b0e378b,0xba1539323bc7b378,0x3669bb54ba2f3913,0x39323a1533783bc7,0xb98bb9c4b4a5bba8
.quad 0x3a15b932bbc73378,0xbb7335d53bf62e46,0xb932ba15b378bbc7,0xa5073c00b78b3b0e,0xba1539323bc7b378,0x3b543669b913ba2f,0x39323a1533783bc7,0x39c4b98b3ba8b4a5
.quad 0x3a15b932bbc73378,0xb5d5bb73ae463bf6,0xb932ba15b378bbc7,0xbc00a507bb0eb78b,0xba1539323bc7b378,0xb6693b543a2fb913,0x39323a1533783bc7,0x398b39c434a53ba8
.quad 0x3bfea906bb44b6b3,0x3ba834a5b9c4b98b,0x396eb9e03b81b58a,0x3bf6ae463b7335d5,0xa906bbfeb6b33b44,0x3b0eb78bbc002507,0xb9e0b96eb58abb81,0x3913ba2f3b54b669
.quad 0xbbfe29063b4436b3,0x34a5bba8b98b39c4,0xb96e39e0bb81358a,0xae46bbf635d5bb73,0x29063bfe36b3bb44,0xb78bbb0e25073c00,0x39e0396e358a3b81,0xba2fb913b669bb54
.quad 0x3bfea906bb44b6b3,0xbba8b4a539c4398b,0x396eb9e03b81b58a,0xbbf62e46bb73b5d5,0xa906bbfeb6b33b44,0xbb0e378b3c00a507,0xb9e0b96eb58abb81,0xb9133a2fbb543669
.quad 0xbbfe29063b4436b3,0xb4a53ba8398bb9c4,0xb96e39e0bb81358a,0x2e463bf6b5d53b73,0x29063bfe36b3bb44,0x378b3b0ea507bc00,0x39e0396e358a3b81,0x3a2f391336693b54
.quad 0xb61fbb6480003c00,0xaa48bbfeb5643b88,0x361f3b6480003c00,0xb5643b88b95f39ed,0xb61fbb6480003c00,0x395fb9edbb3b36d7,0x361f3b6480003c00,0xbb3b36d7bbfe2a48
.quad 0xb61fbb6480003c00,0x3bfeaa48bb88b564,0x361f3b6480003c00,0xbb88b564b9edb95f,0xb61fbb6480003c00,0x39ed395fb6d7bb3b,0x361f3b6480003c00,0xb6d7bb3baa48bbfe
.quad 0xb61fbb6480003c00,0x2a483bfe3564bb88,0x361f3b6480003c00,0x3564bb88395fb9ed,0xb61fbb6480003c00,0xb95f39ed3b3bb6d7,0x361f3b6480003c00,0x3b3bb6d73bfeaa48
.quad 0xb61fbb6480003c00,0xbbfe2a483b883564,0x361f3b6480003c00,0x3b88356439ed395f,0xb61fbb6480003c00,0xb9edb95f36d73b3b,0x361f3b6480003c00,0x36d73b3b2a483bfe
.quad 0x34a5bba8b9133a2f,0x38c4ba6dbadd381d,0xbb0e378bbbf62e46,0xbbc3b3c6ba6db8c4,0x3ba834a5ba2fb913,0x30b23bea33c6bbc3,0xb78bbb0eae46bbf6,0x3addb81d3beab0b2
.quad 0xb4a53ba83913ba2f,0xba6db8c4381d3add,0x3b0eb78b3bf6ae46,0xb3c63bc3b8c43a6d,0xbba8b4a53a2f3913,0x3beab0b2bbc3b3c6,0x378b3b0e2e463bf6,0xb81dbaddb0b2bbea
.quad 0x34a5bba8b9133a2f,0xb8c43a6d3addb81d,0xbb0e378bbbf62e46,0x3bc333c63a6d38c4,0x3ba834a5ba2fb913,0xb0b2bbeab3c63bc3,0xb78bbb0eae46bbf6,0xbadd381dbbea30b2
.quad 0xb4a53ba83913ba2f,0x3a6d38c4b81dbadd,0x3b0eb78b3bf6ae46,0x33c6bbc338c4ba6d,0xbba8b4a53a2f3913,0xbbea30b23bc333c6,0x378b3b0e2e463bf6,0x381d3add30b23bea
.quad 0x3aa7b872bbd9323e,0x3bc3b3c6bbeab0b2,0xb872baa7b23ebbd9,0x30b2bbea381dbadd,0xbaa738723bd9b23e,0xbaddb81d38c43a6d,0x38723aa7323e3bd9,0xba6d38c4bbc333c6
.quad 0x3aa7b872bbd9323e,0x33c63bc330b2bbea,0xb872baa7b23ebbd9,0x3bea30b23add381d,0xbaa738723bd9b23e,0x381dbaddba6d38c4,0x38723aa7323e3bd9,0xb8c4ba6db3c6bbc3
.quad 0x3aa7b872bbd9323e,0xbbc333c63bea30b2,0xb872baa7b23ebbd9,0xb0b23beab81d3add,0xbaa738723bd9b23e,0x3add381db8c4ba6d,0x38723aa7323e3bd9,0x3a6db8c43bc3b3c6
.quad 0x3aa7b872bbd9323e,0xb3c6bbc3b0b23bea,0xb872baa7b23ebbd9,0xbbeab0b2baddb81d,0xbaa738723bd9b23e,0xb81d3add3a6db8c4,0x38723aa7323e3bd9,0x38c43a6d33c63bc3
.quad 0x3bf62e46bb0eb78b,0x3b3b36d7b95fb9ed,0x3a2fb9133ba8b4a5,0x3bfe2a483b3b36d7,0x2e46bbf6b78b3b0e,0x3b88b564bbfeaa48,0xb913ba2fb4a5bba8,0x39edb95f3b88b564
.quad 0xbbf6ae463b0e378b,0x36d7bb3bb9ed395f,0xba2f3913bba834a5,0x2a48bbfe36d7bb3b,0xae463bf6378bbb0e,0xb564bb88aa483bfe,0x39133a2f34a53ba8,0xb95fb9edb564bb88
.quad 0x3bf62e46bb0eb78b,0xbb3bb6d7395f39ed,0x3a2fb9133ba8b4a5,0xbbfeaa48bb3bb6d7,0x2e46bbf6b78b3b0e,0xbb8835643bfe2a48,0xb913ba2fb4a5bba8,0xb9ed395fbb883564
.quad 0xbbf6ae463b0e378b,0xb6d73b3b39edb95f,0xba2f3913bba834a5,0xaa483bfeb6d73b3b,0xae463bf6378bbb0e,0x35643b882a48bbfe,0x39133a2f34a53ba8,0x395f39ed35643b88
.quad 0xb4f2bb9c80003c00,0x2906bbfeb58a3b81,0x34f23b9c80003c00,0xb6b33b44b96e39e0,0xb4f2bb9c80003c00,0x39e0b96ebb4436b3,0x34f23b9c80003c00,0xbb81358abbfe2906
.quad 0xb4f2bb9c80003c00,0x3bfe2906bb81b58a,0x34f23b9c80003c00,0xbb44b6b3b9e0b96e,0xb4f2bb9c80003c00,0x396e39e0b6b3bb44,0x34f23b9c80003c00,0xb58abb81a906bbfe
.quad 0xb4f2bb9c80003c00,0xa9063bfe358abb81,0x34f23b9c80003c00,0x36b3bb44396eb9e0,0xb4f2bb9c80003c00,0xb9e0396e3b44b6b3,0x34f23b9c80003c00,0x3b81b58a3bfea906
.quad 0xb4f2bb9c80003c00,0xbbfea9063b81358a,0x34f23b9c80003c00,0x3b4436b339e0396e,0xb4f2bb9c80003c00,0xb96eb9e036b33b44,0x34f23b9c80003c00,0x358a3b8129063bfe
.quad 0x361fbb64b9323a15,0x396eb9e0bafb37d1,0xbb64361fbbfa2d05,0xbb81b58aba48b8f4,0x3b64361fba15b932,0x29063bfe3458bbb3,0xb61fbb64ad05bbfa,0x3b44b6b33bf2af86
.quad 0xb61f3b643932ba15,0xb9e0b96e37d13afb,0x3b64b61f3bfaad05,0xb58a3b81b8f43a48,0xbb64b61f3a153932,0x3bfea906bbb3b458,0x361f3b642d053bfa,0xb6b3bb44af86bbf2
.quad 0x361fbb64b9323a15,0xb96e39e03afbb7d1,0xbb64361fbbfa2d05,0x3b81358a3a4838f4,0x3b64361fba15b932,0xa906bbfeb4583bb3,0xb61fbb64ad05bbfa,0xbb4436b3bbf22f86
.quad 0xb61f3b643932ba15,0x39e0396eb7d1bafb,0x3b64b61f3bfaad05,0x358abb8138f4ba48,0xbb64b61f3a153932,0xbbfe29063bb33458,0x361f3b642d053bfa,0x36b33b442f863bf2
.quad 0x3b21b744bbe73102,0x3bf2af86bbd9b23e,0xb744bb21b102bbe7,0x3458bbb33872baa7,0xbb2137443be7b102,0xba48b8f438723aa7,0x37443b2131023be7,0xbafb37d1bbd9323e
.quad 0x3b21b744bbe73102,0x2f863bf2323ebbd9,0xb744bb21b102bbe7,0x3bb334583aa73872,0xbb2137443be7b102,0x38f4ba48baa73872,0x37443b2131023be7,0xb7d1bafbb23ebbd9
.quad 0x3b21b744bbe73102,0xbbf22f863bd9323e,0xb744bb21b102bbe7,0xb4583bb3b8723aa7,0xbb2137443be7b102,0x3a4838f4b872baa7,0x37443b2131023be7,0x3afbb7d13bd9b23e
.quad 0x3b21b744bbe73102,0xaf86bbf2b23e3bd9,0xb744bb21b102bbe7,0xbbb3b458baa7b872,0xbb2137443be7b102,0xb8f43a483aa7b872,0x37443b2131023be7,0x37d13afb323e3bd9
.quad 0x3bc73378bad2b82e,0x3aa73872b8f4ba48,0x3ad2b82e3bc7b378,0x3bd9323e3afb37d1,0x3378bbc7b82e3ad2,0x3bd9b23ebbf2af86,0xb82ebad2b378bbc7,0x3aa7b8723bb3b458
.quad 0xbbc7b3783ad2382e,0x3872baa7ba4838f4,0xbad2382ebbc73378,0x323ebbd937d1bafb,0xb3783bc7382ebad2,0xb23ebbd9af863bf2,0x382e3ad233783bc7,0xb872baa7b458bbb3
.quad 0x3bc73378bad2b82e,0xbaa7b87238f43a48,0x3ad2b82e3bc7b378,0xbbd9b23ebafbb7d1,0x3378bbc7b82e3ad2,0xbbd9323e3bf22f86,0xb82ebad2b378bbc7,0xbaa73872bbb33458
.quad 0xbbc7b3783ad2382e,0xb8723aa73a48b8f4,0xbad2382ebbc73378,0xb23e3bd9b7d13afb,0xb3783bc7382ebad2,0x323e3bd92f86bbf2,0x382e3ad233783bc7,0x38723aa734583bb3
.quad 0xb378bbc780003c00,0x3013bbefb5af3b7a,0x33783bc780003c00,0xb7f43af1b97d39d2,0xb378bbc780003c00,0x3a55b8e4bb4c368e,0x33783bc780003c00,0xbbb83431bbff278a
.quad 0xb378bbc780003c00,0x3bef3013bb7ab5af,0x33783bc780003c00,0xbaf1b7f4b9d2b97d,0xb378bbc780003c00,0x38e43a55b68ebb4c,0x33783bc780003c00,0xb431bbb8a78abbff
.quad 0xb378bbc780003c00,0xb0133bef35afbb7a,0x33783bc780003c00,0x37f4baf1397db9d2,0xb378bbc780003c00,0xba5538e43b4cb68e,0x33783bc780003c00,0x3bb8b4313bffa78a
.quad 0xb378bbc780003c00,0xbbefb0133b7a35af,0x33783bc780003c00,0x3af137f439d2397d,0xb378bbc780003c00,0xb8e4ba55368e3b4c,0x33783bc780003c00,0x34313bb8278a3bff
.quad 0x378bbb0eb95039fb,0x3a08b941bb183767,0xbba834a5bbfc2b89,0xbb2ab720ba22b923,0x3b0e378bb9fbb950,0xac653bfb34cbbba2,0xb4a5bba8ab89bbfc,0x3b95b5183bf8ada6
.quad 0xb78b3b0e3950b9fb,0xb941ba0837673b18,0x3ba8b4a53bfcab89,0xb7203b2ab9233a22,0xbb0eb78b39fb3950,0x3bfb2c65bba2b4cb,0x34a53ba82b893bfc,0xb518bb95ada6bbf8
.quad 0x378bbb0eb95039fb,0xba0839413b18b767,0xbba834a5bbfc2b89,0x3b2a37203a223923,0x3b0e378bb9fbb950,0x2c65bbfbb4cb3ba2,0xb4a5bba8ab89bbfc,0xbb953518bbf82da6
.quad 0xb78b3b0e3950b9fb,0x39413a08b767bb18,0x3ba8b4a53bfcab89,0x3720bb2a3923ba22,0xbb0eb78b39fb3950,0xbbfbac653ba234cb,0x34a53ba82b893bfc,0x35183b952da63bf8
.quad 0x3b81b58abbf22f86,0x3c002107bbc3b3c6,0xb58abb81af86bbf2,0x3645bb5c38c4ba6d,0xbb81358a3bf2af86,0xb99ab9b6381d3add,0x358a3b812f863bf2,0xbb6c35fabbea30b2
.quad 0x3b81b58abbf22f86,0xa1073c0033c6bbc3,0xb58abb81af86bbf2,0x3b5c36453a6d38c4,0xbb81358a3bf2af86,0x39b6b99abadd381d,0x358a3b812f863bf2,0xb5fabb6cb0b2bbea
.quad 0x3b81b58abbf22f86,0xbc00a1073bc333c6,0xb58abb81af86bbf2,0xb6453b5cb8c43a6d,0xbb81358a3bf2af86,0x399a39b6b81dbadd,0x358a3b812f863bf2,0x3b6cb5fa3beab0b2
.quad 0x3b81b58abbf22f86,0x2107bc00b3c63bc3,0xb58abb81af86bbf2,0xbb5cb645ba6db8c4,0xbb81358a3bf2af86,0xb9b6399a3addb81d,0x358a3b812f863bf2,0x35fa3b6c30b23bea
.quad 0x3b7335d5ba90b893,0x39ed395fb882ba9c,0x3b54b6693be0b1a0,0x3b8835643ab23861,0x35d5bb73b8933a90,0x3bfeaa48bbdcb1ef,0xb669bb54b1a0bbe0,0x3b3bb6d73bd5b28d
.quad 0xbb73b5d53a903893,0x395fb9edba9c3882,0xbb543669bbe031a0,0x3564bb883861bab2,0xb5d53b733893ba90,0xaa48bbfeb1ef3bdc,0x36693b5431a03be0,0xb6d7bb3bb28dbbd5
.quad 0x3b7335d5ba90b893,0xb9edb95f38823a9c,0x3b54b6693be0b1a0,0xbb88b564bab2b861,0x35d5bb73b8933a90,0xbbfe2a483bdc31ef,0xb669bb54b1a0bbe0,0xbb3b36d7bbd5328d
.quad 0xbb73b5d53a903893,0xb95f39ed3a9cb882,0xbb543669bbe031a0,0xb5643b88b8613ab2,0xb5d53b733893ba90,0x2a483bfe31efbbdc,0x36693b5431a03be0,0x36d73b3b328d3bd5
.quad 0xb102bbe780003c00,0x32dcbbd0b5d53b73,0x31023be780003c00,0xb8933a90b98b39c4,0xb102bbe780003c00,0x3abdb850bb543669,0x31023be780003c00,0xbbe031a0bc002507
.quad 0xb102bbe780003c00,0x3bd032dcbb73b5d5,0x31023be780003c00,0xba90b893b9c4b98b,0xb102bbe780003c00,0x38503abdb669bb54,0x31023be780003c00,0xb1a0bbe0a507bc00
.quad 0xb102bbe780003c00,0xb2dc3bd035d5bb73,0x31023be780003c00,0x3893ba90398bb9c4,0xb102bbe780003c00,0xbabd38503b54b669,0x31023be780003c00,0x3be0b1a03c00a507
.quad 0xb102bbe780003c00,0xbbd0b2dc3b7335d5,0x31023be780003c00,0x3a90389339c4398b,0xb102bbe780003c00,0xb850babd36693b54,0x31023be780003c00,0x31a03be025073c00
.quad 0x3872baa7b96e39e0,0x3a90b893bb3336fc,0xbbd9323ebbfe2906,0xbabdb850b9fbb950,0x3aa73872b9e0b96e,0xb1a03be0353ebb8f,0xb23ebbd9a906bbfe,0x3bd0b2dc3bfcab89
.quad 0xb8723aa7396eb9e0,0xb893ba9036fc3b33,0x3bd9b23e3bfea906,0xb8503abdb95039fb,0xbaa7b87239e0396e,0x3be031a0bb8fb53e,0x323e3bd929063bfe,0xb2dcbbd0ab89bbfc
.quad 0x3872baa7b96e39e0,0xba9038933b33b6fc,0xbbd9323ebbfe2906,0x3abd385039fb3950,0x3aa73872b9e0b96e,0x31a0bbe0b53e3b8f,0xb23ebbd9a906bbfe,0xbbd032dcbbfc2b89
.quad 0xb8723aa7396eb9e0,0x38933a90b6fcbb33,0x3bd9b23e3bfea906,0x3850babd3950b9fb,0xbaa7b87239e0396e,0xbbe0b1a03b8f353e,0x323e3bd929063bfe,0x32dc3bd02b893bfc
.quad 0x3bc7b378bbfa2d05,0x3bed3062bba8b4a5,0xb378bbc7ad05bbfa,0x380cbae73913ba2f,0xbbc733783bfaad05,0xb8d4ba61378b3b0e,0x33783bc72d053bfa,0xbbbe340abbf62e46
.quad 0x3bc7b378bbfa2d05,0xb0623bed34a5bba8,0xb378bbc7ad05bbfa,0x3ae7380c3a2f3913,0xbbc733783bfaad05,0x3a61b8d4bb0e378b,0x33783bc72d053bfa,0xb40abbbeae46bbf6
.quad 0x3bc7b378bbfa2d05,0xbbedb0623ba834a5,0xb378bbc7ad05bbfa,0xb80c3ae7b9133a2f,0xbbc733783bfaad05,0x38d43a61b78bbb0e,0x33783bc72d053bfa,0x3bbeb40a3bf6ae46
.quad 0x3bc7b378bbfa2d05,0x3062bbedb4a53ba8,0xb378bbc7ad05bbfa,0xbae7b80cba2fb913,0xbbc733783bfaad05,0xba6138d43b0eb78b,0x33783bc72d053bfa,0x340a3bbe2e463bf6
.quad 0x3afb37d1ba48b8f4,0x39133a2fb80cbae7,0x3bb3b4583bf2af86,0x3b0e378b3a6138d4,0x37d1bafbb8f43a48,0x3bf62e46bbbeb40a,0xb458bbb3af86bbf2,0x3ba8b4a53bedb062
.quad 0xbafbb7d13a4838f4,0x3a2fb913bae7380c,0xbbb33458bbf22f86,0x378bbb0e38d4ba61,0xb7d13afb38f4ba48,0x2e46bbf6b40a3bbe,0x34583bb32f863bf2,0xb4a5bba8b062bbed
.quad 0x3afb37d1ba48b8f4,0xb913ba2f380c3ae7,0x3bb3b4583bf2af86,0xbb0eb78bba61b8d4,0x37d1bafbb8f43a48,0xbbf6ae463bbe340a,0xb458bbb3af86bbf2,0xbba834a5bbed3062
.quad 0xbafbb7d13a4838f4,0xba2f39133ae7b80c,0xbbb33458bbf22f86,0xb78b3b0eb8d43a61,0xb7d13afb38f4ba48,0xae463bf6340abbbe,0x34583bb32f863bf2,0x34a53ba830623bed
.quad 0xad05bbfa80003c00,0x34cbbba2b5fa3b6c,0x2d053bfa80003c00,0xb9233a22b99a39b6,0xad05bbfa80003c00,0x3b18b767bb5c3645,0x2d053bfa80003c00,0xbbf82da6bc002107
.quad 0xad05bbfa80003c00,0x3ba234cbbb6cb5fa,0x2d053bfa80003c00,0xba22b923b9b6b99a,0xad05bbfa80003c00,0x37673b18b645bb5c,0x2d053bfa80003c00,0xada6bbf8a107bc00
.quad 0xad05bbfa80003c00,0xb4cb3ba235fabb6c,0x2d053bfa80003c00,0x3923ba22399ab9b6,0xad05bbfa80003c00,0xbb1837673b5cb645,0x2d053bfa80003c00,0x3bf8ada63c00a107
.quad 0xad05bbfa80003c00,0xbba2b4cb3b6c35fa,0x2d053bfa80003c00,0x3a22392339b6399a,0xad05bbfa80003c00,0xb767bb1836453b5c,0x2d053bfa80003c00,0x2da63bf821073c00
.quad 0x3913ba2fb98b39c4,0x3b05b7aebb4c368e,0xbbf62e46bc002507,0xba3cb904b9d2b97d,0x3a2f3913b9c4b98b,0xb47e3bae35afbb7a,0xae46bbf6a507bc00,0x3bf4aee63bffa78a
.quad 0xb9133a2f398bb9c4,0xb7aebb05368e3b4c,0x3bf6ae463c00a507,0xb9043a3cb97d39d2,0xba2fb91339c4398b,0x3bae347ebb7ab5af,0x2e463bf625073c00,0xaee6bbf4a78abbff
.quad 0x3913ba2fb98b39c4,0xbb0537ae3b4cb68e,0xbbf62e46bc002507,0x3a3c390439d2397d,0x3a2f3913b9c4b98b,0x347ebbaeb5af3b7a,0xae46bbf6a507bc00,0xbbf42ee6bbff278a
.quad 0xb9133a2f398bb9c4,0x37ae3b05b68ebb4c,0x3bf6ae463c00a507,0x3904ba3c397db9d2,0xba2fb91339c4398b,0xbbaeb47e3b7a35af,0x2e463bf625073c00,0x2ee63bf4278a3bff
.quad 0x3bf2af86bbfe2906,0x3bb83431bb88b564,0xaf86bbf2a906bbfe,0x38e4ba55395fb9ed,0xbbf22f863bfea906,0xb7f4baf136d73b3b,0x2f863bf229063bfe,0xbbef3013bbfe2a48
.quad 0x3bf2af86bbfe2906,0xb4313bb83564bb88,0xaf86bbf2a906bbfe,0x3a5538e439ed395f,0xbbf22f863bfea906,0x3af1b7f4bb3b36d7,0x2f863bf229063bfe,0xb013bbefaa48bbfe
.quad 0x3bf2af86bbfe2906,0xbbb8b4313b883564,0xaf86bbf2a906bbfe,0xb8e43a55b95f39ed,0xbbf22f863bfea906,0x37f43af1b6d7bb3b,0x2f863bf229063bfe,0x3befb0133bfeaa48
.quad 0x3bf2af86bbfe2906,0x3431bbb8b5643b88,0xaf86bbf2a906bbfe,0xba55b8e4b9edb95f,0xbbf22f863bfea906,0xbaf137f43b3bb6d7,0x2f863bf229063bfe,0x30133bef2a483bfe
.quad 0x3a6138d4b9fbb950,0x381d3addb720bb2a,0x3bedb0623bfcab89,0x3a6d38c43a083941,0x38d4ba61b95039fb,0x3bc333c6bb95b518,0xb062bbedab89bbfc,0x3beab0b23bfbac65
.quad 0xba61b8d439fb3950,0x3addb81dbb2a3720,0xbbed3062bbfc2b89,0x38c4ba6d3941ba08,0xb8d43a613950b9fb,0x33c6bbc3b5183b95,0x30623bed2b893bfc,0xb0b2bbeaac65bbfb
.quad 0x3a6138d4b9fbb950,0xb81dbadd37203b2a,0x3bedb0623bfcab89,0xba6db8c4ba08b941,0x38d4ba61b95039fb,0xbbc3b3c63b953518,0xb062bbedab89bbfc,0xbbea30b2bbfb2c65
.quad 0xba61b8d439fb3950,0xbadd381d3b2ab720,0xbbed3062bbfc2b89,0xb8c43a6db9413a08,0xb8d43a613950b9fb,0xb3c63bc33518bb95,0x30623bed2b893bfc,0x30b23bea2c653bfb
.size dft_tbl, 47104
```
